```python
import torch

def _softmax(x, axis=-1):
    return torch.softmax(x, dim=axis)
def _gelu(x):
    return torch.nn.functional.gelu(x, approximate="tanh")
def _silu(x):
    return torch.nn.functional.silu(x)
def _sigmoid(x):
    return torch.sigmoid(x)
def _layernorm(x, axis=-1, eps=1e-5):
    m = x.mean(dim=axis, keepdim=True)
    v = x.var(dim=axis, keepdim=True, unbiased=False)
    return (x - m) / torch.sqrt(v + eps)
def _scatter_add(tgt, idx, src, axis=0):
    return tgt.clone().index_add_(axis, idx, src)
def _segment_sum(src, seg, n):
    out = torch.zeros((n,) + src.shape[1:], dtype=src.dtype)
    return out.index_add_(0, seg, src)
def _pad(x, pw):
    flat = tuple(v for pair in reversed(pw) for v in pair)
    return torch.nn.functional.pad(x, flat)

kernel_name = 'parallel_sum__grouped_kv_mqa__dense_activation_relu__prompt'

def setup_inputs():

    _w = (lambda a: (lambda t: t.to(torch.bfloat16) if t.is_floating_point() else t)(torch.as_tensor(a)))
    def _A_setup():
        B, S, D, H = 1, 2048, 512, 32
        Dh = D // H
        return {
            "x": _w((lambda *s: torch.randn(*s, dtype=torch.bfloat16) * 0.05)(B, S, D)),
            "wq": _w((lambda *s: torch.randn(*s, dtype=torch.bfloat16) * 0.2)(D, H * Dh)),
            "wk": _w((lambda *s: torch.randn(*s, dtype=torch.bfloat16) * 0.2)(D, Dh)),
            "wv": _w((lambda *s: torch.randn(*s, dtype=torch.bfloat16) * 0.1)(D, Dh)),
            "wo": _w((lambda *s: torch.randn(*s, dtype=torch.bfloat16) * 0.1)(H * Dh, D)),
        }
    _A_in = _A_setup()

    def _B_setup():
        B, S, D, Dff = 1, 2048, 512, 1376
        return {
            "x": _w((lambda *s: torch.randn(*s, dtype=torch.bfloat16) * 0.05)(B, S, D)),
            "w1": _w((lambda *s: torch.randn(*s, dtype=torch.bfloat16) * 0.1)(D, Dff)),
            "w2": _w((lambda *s: torch.randn(*s, dtype=torch.bfloat16) * 0.1)(Dff, D)),
        }
    _B_in = _B_setup()

    return {
        "A_x": _A_in["x"],
        "A_wq": _A_in["wq"],
        "A_wk": _A_in["wk"],
        "A_wv": _A_in["wv"],
        "A_wo": _A_in["wo"],
        "B_x": _B_in["x"],
        "B_w1": _B_in["w1"],
        "B_w2": _B_in["w2"],
    }

def reference(A_x, A_wq, A_wk, A_wv, A_wo, B_x, B_w1, B_w2):
    def _A_ref(x, wq, wk, wv, wo):
        B, S, D = x.shape
        H = 32
        Dh = D // H
        q = (lambda x, *d: x.permute(*d))((x @ wq).reshape(B, S, H, Dh), 0, 2, 1, 3)
        k = x @ wk
        v = x @ wv
        scores = torch.einsum("bhqd,bkd->bhqk", q, k) * (Dh ** -0.5)
        p = _softmax(scores, axis=-1)
        o = torch.einsum("bhqk,bkd->bhqd", p, v)
        return (lambda x, *d: x.permute(*d))(o, 0, 2, 1, 3).reshape(B, S, H * Dh) @ wo

    def _B_ref(x, w1, w2):
        h = torch.einsum("bsd,df->bsf", x, w1)
        zero = torch.zeros_like(h)
        h = torch.maximum(h, zero)
        return torch.einsum("bsf,fd->bsd", h, w2)

    x = A_x
    xn = _layernorm(x, axis=-1)
    return x + _A_ref(xn, A_wq, A_wk, A_wv, A_wo) + _B_ref(xn, B_w1, B_w2)
```

```asm
; @launch grid=(256,1,1) block=(512,1,1) lds=161792
.amdgcn_target "amdgcn-amd-amdhsa--gfx950"
.text
.globl parallel_sum__grouped_kv_mqa__dense_activation_relu__prompt_kernel
.p2align 8
.type parallel_sum__grouped_kv_mqa__dense_activation_relu__prompt_kernel,@function
parallel_sum__grouped_kv_mqa__dense_activation_relu__prompt_kernel:
    s_cmp_ge_u32 s2, 256
    s_cbranch_scc1 K_exit
    s_load_dwordx16 s[8:23], s[0:1], 0
    s_load_dwordx4 s[24:27], s[0:1], 64
    s_load_dwordx2 s[28:29], s[0:1], 80
    v_lshrrev_b32 v1, 6, v0
    s_nop 0
    v_readfirstlane_b32 s3, v1
    s_cmp_lt_u32 s3, 4
    s_cbranch_scc1 A_start
    s_cmp_lt_u32 s3, 7
    s_cbranch_scc1 G_start
    s_setprio 3
    s_and_b32 s6, s2, 7
    s_lshl_b32 s6, s6, 2
    s_lshr_b32 s6, 0x14735260, s6
    s_and_b32 s6, s6, 7
    s_lshr_b32 s7, s2, 3
    s_and_b32 s5, s7, 3
    s_and_b32 s4, s6, 1
    s_lshl2_add_u32 s5, s4, s5
    s_lshr_b32 s6, s6, 1
    s_lshr_b32 s7, s7, 2
    s_lshl3_add_u32 s4, s6, s7
    s_lshl3_add_u32 s30, s4, s5
    v_and_b32 v1, 63, v0
    v_lshlrev_b32 v5, 4, v1
    v_lshrrev_b32 v12, 4, v1
    v_and_b32 v13, 15, v1
    v_lshlrev_b32 v11, 10, v13
    v_lshl_add_u32 v11, v12, 4, v11
    s_and_b32 s57, s5, 3
    s_lshl_b32 s60, s4, 16
    s_lshl_b32 s6, s57, 14
    s_add_u32 s60, s60, s6
    s_waitcnt lgkmcnt(0)
    s_mov_b32 s32, s8
    s_and_b32 s33, s9, 0xffff
    s_mov_b32 s34, 2097152
    s_mov_b32 s35, 0x20000
    buffer_load_dwordx4 v[64:67], v11, s[32:35], s60 offen offset:0
    buffer_load_dwordx4 v[68:71], v11, s[32:35], s60 offen offset:64
    buffer_load_dwordx4 v[72:75], v11, s[32:35], s60 offen offset:128
    buffer_load_dwordx4 v[76:79], v11, s[32:35], s60 offen offset:192
    buffer_load_dwordx4 v[80:83], v11, s[32:35], s60 offen offset:256
    buffer_load_dwordx4 v[84:87], v11, s[32:35], s60 offen offset:320
    buffer_load_dwordx4 v[88:91], v11, s[32:35], s60 offen offset:384
    buffer_load_dwordx4 v[92:95], v11, s[32:35], s60 offen offset:448
    buffer_load_dwordx4 v[96:99], v11, s[32:35], s60 offen offset:512
    buffer_load_dwordx4 v[100:103], v11, s[32:35], s60 offen offset:576
    buffer_load_dwordx4 v[104:107], v11, s[32:35], s60 offen offset:640
    buffer_load_dwordx4 v[108:111], v11, s[32:35], s60 offen offset:704
    buffer_load_dwordx4 v[112:115], v11, s[32:35], s60 offen offset:768
    buffer_load_dwordx4 v[116:119], v11, s[32:35], s60 offen offset:832
    buffer_load_dwordx4 v[120:123], v11, s[32:35], s60 offen offset:896
    buffer_load_dwordx4 v[124:127], v11, s[32:35], s60 offen offset:960
    s_cmp_lt_u32 s5, 4
    s_cselect_b32 s6, s14, s12
    s_cselect_b32 s7, s15, s13
    s_mov_b32 s40, s6
    s_and_b32 s41, s7, 0xffff
    s_mov_b32 s42, 16384
    s_mov_b32 s43, 0x20000
    s_movk_i32 s6, 0
    buffer_load_dwordx4 v[128:131], v5, s[40:43], s6 offen offset:0
    buffer_load_dwordx4 v[132:135], v5, s[40:43], s6 offen offset:1024
    buffer_load_dwordx4 v[136:139], v5, s[40:43], s6 offen offset:2048
    buffer_load_dwordx4 v[140:143], v5, s[40:43], s6 offen offset:3072
    s_movk_i32 s6, 4096
    buffer_load_dwordx4 v[144:147], v5, s[40:43], s6 offen offset:0
    buffer_load_dwordx4 v[148:151], v5, s[40:43], s6 offen offset:1024
    buffer_load_dwordx4 v[152:155], v5, s[40:43], s6 offen offset:2048
    buffer_load_dwordx4 v[156:159], v5, s[40:43], s6 offen offset:3072
    s_movk_i32 s6, 8192
    buffer_load_dwordx4 v[160:163], v5, s[40:43], s6 offen offset:0
    buffer_load_dwordx4 v[164:167], v5, s[40:43], s6 offen offset:1024
    buffer_load_dwordx4 v[168:171], v5, s[40:43], s6 offen offset:2048
    buffer_load_dwordx4 v[172:175], v5, s[40:43], s6 offen offset:3072
    s_movk_i32 s6, 12288
    buffer_load_dwordx4 v[176:179], v5, s[40:43], s6 offen offset:0
    buffer_load_dwordx4 v[180:183], v5, s[40:43], s6 offen offset:1024
    buffer_load_dwordx4 v[184:187], v5, s[40:43], s6 offen offset:2048
    buffer_load_dwordx4 v[188:191], v5, s[40:43], s6 offen offset:3072
    s_waitcnt lgkmcnt(0)
    s_barrier
    s_add_u32 s6, s28, 3317760
    s_addc_u32 s7, s29, 0
    s_load_dwordx2 s[52:53], s[6:7], 0
    s_cmp_lt_u32 s5, 4
    s_cbranch_scc1 V_start
    s_mov_b32 s44, s28
    s_and_b32 s45, s29, 0xffff
    s_mov_b32 s46, 16777216
    s_mov_b32 s47, 0x20000
    s_mov_b32 s31, 3
    v_mov_b32 v2, 160768
    v_mov_b32 v3, 1
    v_add_u32 v6, 144384, v5
    v_bfe_u32 v14, v1, 2, 2
    v_lshl_add_u32 v14, v12, 3, v14
    v_and_b32 v15, 3, v1
    v_lshlrev_b32 v15, 3, v15
    v_lshl_add_u32 v7, v14, 5, v15
    v_add_u32 v7, 144384, v7
    v_and_b32 v14, 1, v12
    v_lshrrev_b32 v15, 1, v12
    v_lshlrev_b32 v13, 4, v13
    v_lshl_add_u32 v18, v14, 9, v13
    v_lshl_add_u32 v18, v15, 3, v18
    s_lshr_b32 s7, s57, 1
    s_lshl1_add_u32 s7, s4, s7
    s_lshl_b32 s7, s7, 10
    s_and_b32 s6, s57, 1
    s_lshl_b32 s58, s6, 8
    s_add_u32 s58, s58, s7
    s_add_u32 s58, s58, 3145728
    v_mul_u32_u24 v16, 70656, v1
    s_and_b32 s6, s2, 7
    s_lshr_b32 s7, s6, 0
    s_mul_i32 s62, s7, 70656
    s_add_u32 s62, s62, 3407872
    s_lshr_b32 s7, s2, 3
    s_mul_i32 s6, s6, 640
    s_lshl2_add_u32 s6, s7, s6
    v_lshrrev_b32 v14, 3, v1
    v_mul_u32_u24 v14, 640, v14
    v_and_b32 v15, 7, v1
    v_lshl_add_u32 v10, v15, 4, v14
    s_add_u32 s61, s6, 3407872
    v_mov_b32 v32, 0x3f803f80
    v_mov_b32 v33, 0x3f803f80
    v_mov_b32 v34, 0x3f803f80
    v_mov_b32 v35, 0x3f803f80
    v_mov_b32 v36, 0
    v_mov_b32 v37, 0
    s_waitcnt vmcnt(31)
    v_mfma_f32_16x16x32_bf16 v[24:27], v[32:35], v[64:67], 0
    v_mfma_f32_16x16x32_bf16 v[60:63], v[64:67], v[64:67], 0
    s_waitcnt vmcnt(30)
    v_mfma_f32_16x16x32_bf16 v[24:27], v[32:35], v[68:71], v[24:27]
    v_mfma_f32_16x16x32_bf16 v[60:63], v[68:71], v[68:71], v[60:63]
    s_waitcnt vmcnt(29)
    v_mfma_f32_16x16x32_bf16 v[24:27], v[32:35], v[72:75], v[24:27]
    v_mfma_f32_16x16x32_bf16 v[60:63], v[72:75], v[72:75], v[60:63]
    s_waitcnt vmcnt(28)
    v_mfma_f32_16x16x32_bf16 v[24:27], v[32:35], v[76:79], v[24:27]
    v_mfma_f32_16x16x32_bf16 v[60:63], v[76:79], v[76:79], v[60:63]
    s_waitcnt vmcnt(27)
    v_mfma_f32_16x16x32_bf16 v[24:27], v[32:35], v[80:83], v[24:27]
    v_mfma_f32_16x16x32_bf16 v[60:63], v[80:83], v[80:83], v[60:63]
    s_waitcnt vmcnt(26)
    v_mfma_f32_16x16x32_bf16 v[24:27], v[32:35], v[84:87], v[24:27]
    v_mfma_f32_16x16x32_bf16 v[60:63], v[84:87], v[84:87], v[60:63]
    s_waitcnt vmcnt(25)
    v_mfma_f32_16x16x32_bf16 v[24:27], v[32:35], v[88:91], v[24:27]
    v_mfma_f32_16x16x32_bf16 v[60:63], v[88:91], v[88:91], v[60:63]
    s_waitcnt vmcnt(24)
    v_mfma_f32_16x16x32_bf16 v[24:27], v[32:35], v[92:95], v[24:27]
    v_mfma_f32_16x16x32_bf16 v[60:63], v[92:95], v[92:95], v[60:63]
    s_waitcnt vmcnt(23)
    v_mfma_f32_16x16x32_bf16 v[24:27], v[32:35], v[96:99], v[24:27]
    v_mfma_f32_16x16x32_bf16 v[60:63], v[96:99], v[96:99], v[60:63]
    s_waitcnt vmcnt(22)
    v_mfma_f32_16x16x32_bf16 v[24:27], v[32:35], v[100:103], v[24:27]
    v_mfma_f32_16x16x32_bf16 v[60:63], v[100:103], v[100:103], v[60:63]
    s_waitcnt vmcnt(21)
    v_mfma_f32_16x16x32_bf16 v[24:27], v[32:35], v[104:107], v[24:27]
    v_mfma_f32_16x16x32_bf16 v[60:63], v[104:107], v[104:107], v[60:63]
    s_waitcnt vmcnt(20)
    v_mfma_f32_16x16x32_bf16 v[24:27], v[32:35], v[108:111], v[24:27]
    v_mfma_f32_16x16x32_bf16 v[60:63], v[108:111], v[108:111], v[60:63]
    s_waitcnt vmcnt(19)
    v_mfma_f32_16x16x32_bf16 v[24:27], v[32:35], v[112:115], v[24:27]
    v_mfma_f32_16x16x32_bf16 v[60:63], v[112:115], v[112:115], v[60:63]
    s_waitcnt vmcnt(18)
    v_mfma_f32_16x16x32_bf16 v[24:27], v[32:35], v[116:119], v[24:27]
    v_mfma_f32_16x16x32_bf16 v[60:63], v[116:119], v[116:119], v[60:63]
    s_waitcnt vmcnt(17)
    v_mfma_f32_16x16x32_bf16 v[24:27], v[32:35], v[120:123], v[24:27]
    v_mfma_f32_16x16x32_bf16 v[60:63], v[120:123], v[120:123], v[60:63]
    s_waitcnt vmcnt(16)
    v_mfma_f32_16x16x32_bf16 v[24:27], v[32:35], v[124:127], v[24:27]
    v_mfma_f32_16x16x32_bf16 v[60:63], v[124:127], v[124:127], v[60:63]
    s_waitcnt lgkmcnt(0)
    s_add_u32 s52, s52, 1
    s_addc_u32 s53, s53, 0
    s_waitcnt vmcnt(15)
    ds_write_b128 v6, v[128:131] offset:0
    ds_read_b64_tr_b16 v[128:129], v7 offset:0
    ds_read_b64_tr_b16 v[130:131], v7 offset:128
    s_nop 1
    s_mov_b32 exec_lo, 0x00100001
    s_mov_b32 exec_hi, 0x10000100
    v_mov_b32 v36, v60
    s_lshl_b64 exec, exec, 1
    v_mov_b32 v36, v61
    s_lshl_b64 exec, exec, 1
    v_mov_b32 v36, v62
    s_lshl_b64 exec, exec, 1
    v_mov_b32 v36, v63
    s_mov_b64 exec, -1
    v_mov_b32 v37, v36
    s_waitcnt vmcnt(14)
    ds_write_b128 v6, v[132:135] offset:1024
    ds_read_b64_tr_b16 v[132:133], v7 offset:1024
    ds_read_b64_tr_b16 v[134:135], v7 offset:1152
    v_permlane16_swap_b32 v36, v37
    v_mul_f32 v24, 0x3b000000, v24
    v_add_f32 v36, v36, v37
    v_mov_b32 v37, v36
    v_mul_f32 v25, v24, v24
    s_waitcnt vmcnt(13)
    ds_write_b128 v6, v[136:139] offset:2048
    ds_read_b64_tr_b16 v[136:137], v7 offset:2048
    ds_read_b64_tr_b16 v[138:139], v7 offset:2176
    v_permlane32_swap_b32 v36, v37
    v_mov_b32 v26, 0x3b000000
    v_add_f32 v36, v36, v37
    v_fma_f32 v36, v36, v26, -v25
    v_max_f32 v36, 0, v36
    s_waitcnt vmcnt(12)
    ds_write_b128 v6, v[140:143] offset:3072
    ds_read_b64_tr_b16 v[140:141], v7 offset:3072
    ds_read_b64_tr_b16 v[142:143], v7 offset:3200
    v_cvt_pk_bf16_f32 v36, v24, v36
    v_lshlrev_b32 v24, 16, v36
    v_and_b32 v36, 0xffff0000, v36
    v_add_f32 v36, 0x3727c5ac, v36
    s_waitcnt lgkmcnt(9)
    v_mfma_f32_16x16x32_bf16 v[28:31], v[128:131], v[32:35], 0
    v_mfma_f32_16x16x32_bf16 v[20:23], v[128:131], v[64:67], 0
    s_waitcnt vmcnt(11)
    ds_write_b128 v6, v[144:147] offset:0
    ds_read_b64_tr_b16 v[144:145], v7 offset:0
    ds_read_b64_tr_b16 v[146:147], v7 offset:128
    v_cvt_pk_bf16_f32 v36, v36, v36
    v_and_b32 v36, 0xffff0000, v36
    v_sqrt_f32 v36, v36
    s_waitcnt lgkmcnt(9)
    v_mfma_f32_16x16x32_bf16 v[28:31], v[132:135], v[32:35], v[28:31]
    v_mfma_f32_16x16x32_bf16 v[20:23], v[132:135], v[68:71], v[20:23]
    s_waitcnt vmcnt(10)
    ds_write_b128 v6, v[148:151] offset:1024
    ds_read_b64_tr_b16 v[148:149], v7 offset:1024
    ds_read_b64_tr_b16 v[150:151], v7 offset:1152
    v_cvt_pk_bf16_f32 v36, v36, v36
    v_and_b32 v36, 0xffff0000, v36
    v_rcp_f32 v36, v36
    s_waitcnt lgkmcnt(9)
    v_mfma_f32_16x16x32_bf16 v[28:31], v[136:139], v[32:35], v[28:31]
    v_mfma_f32_16x16x32_bf16 v[20:23], v[136:139], v[72:75], v[20:23]
    s_waitcnt vmcnt(9)
    ds_write_b128 v6, v[152:155] offset:2048
    ds_read_b64_tr_b16 v[152:153], v7 offset:2048
    ds_read_b64_tr_b16 v[154:155], v7 offset:2176
    s_waitcnt lgkmcnt(9)
    v_mfma_f32_16x16x32_bf16 v[28:31], v[140:143], v[32:35], v[28:31]
    v_mfma_f32_16x16x32_bf16 v[20:23], v[140:143], v[76:79], v[20:23]
    s_waitcnt vmcnt(8)
    ds_write_b128 v6, v[156:159] offset:3072
    ds_read_b64_tr_b16 v[156:157], v7 offset:3072
    ds_read_b64_tr_b16 v[158:159], v7 offset:3200
    s_waitcnt lgkmcnt(9)
    v_mfma_f32_16x16x32_bf16 v[28:31], v[144:147], v[32:35], v[28:31]
    v_mfma_f32_16x16x32_bf16 v[20:23], v[144:147], v[80:83], v[20:23]
    s_waitcnt vmcnt(7)
    ds_write_b128 v6, v[160:163] offset:0
    ds_read_b64_tr_b16 v[160:161], v7 offset:0
    ds_read_b64_tr_b16 v[162:163], v7 offset:128
    s_waitcnt lgkmcnt(9)
    v_mfma_f32_16x16x32_bf16 v[28:31], v[148:151], v[32:35], v[28:31]
    v_mfma_f32_16x16x32_bf16 v[20:23], v[148:151], v[84:87], v[20:23]
    s_waitcnt vmcnt(6)
    ds_write_b128 v6, v[164:167] offset:1024
    ds_read_b64_tr_b16 v[164:165], v7 offset:1024
    ds_read_b64_tr_b16 v[166:167], v7 offset:1152
    s_waitcnt lgkmcnt(9)
    v_mfma_f32_16x16x32_bf16 v[28:31], v[152:155], v[32:35], v[28:31]
    v_mfma_f32_16x16x32_bf16 v[20:23], v[152:155], v[88:91], v[20:23]
    s_waitcnt vmcnt(5)
    ds_write_b128 v6, v[168:171] offset:2048
    ds_read_b64_tr_b16 v[168:169], v7 offset:2048
    ds_read_b64_tr_b16 v[170:171], v7 offset:2176
    s_waitcnt lgkmcnt(9)
    v_mfma_f32_16x16x32_bf16 v[28:31], v[156:159], v[32:35], v[28:31]
    v_mfma_f32_16x16x32_bf16 v[20:23], v[156:159], v[92:95], v[20:23]
    s_waitcnt vmcnt(4)
    ds_write_b128 v6, v[172:175] offset:3072
    ds_read_b64_tr_b16 v[172:173], v7 offset:3072
    ds_read_b64_tr_b16 v[174:175], v7 offset:3200
    s_waitcnt lgkmcnt(9)
    v_mfma_f32_16x16x32_bf16 v[28:31], v[160:163], v[32:35], v[28:31]
    v_mfma_f32_16x16x32_bf16 v[20:23], v[160:163], v[96:99], v[20:23]
    s_waitcnt vmcnt(3)
    ds_write_b128 v6, v[176:179] offset:0
    ds_read_b64_tr_b16 v[176:177], v7 offset:0
    ds_read_b64_tr_b16 v[178:179], v7 offset:128
    s_waitcnt lgkmcnt(9)
    v_mfma_f32_16x16x32_bf16 v[28:31], v[164:167], v[32:35], v[28:31]
    v_mfma_f32_16x16x32_bf16 v[20:23], v[164:167], v[100:103], v[20:23]
    s_waitcnt vmcnt(2)
    ds_write_b128 v6, v[180:183] offset:1024
    ds_read_b64_tr_b16 v[180:181], v7 offset:1024
    ds_read_b64_tr_b16 v[182:183], v7 offset:1152
    s_waitcnt lgkmcnt(9)
    v_mfma_f32_16x16x32_bf16 v[28:31], v[168:171], v[32:35], v[28:31]
    v_mfma_f32_16x16x32_bf16 v[20:23], v[168:171], v[104:107], v[20:23]
    s_waitcnt vmcnt(1)
    ds_write_b128 v6, v[184:187] offset:2048
    ds_read_b64_tr_b16 v[184:185], v7 offset:2048
    ds_read_b64_tr_b16 v[186:187], v7 offset:2176
    s_waitcnt lgkmcnt(9)
    v_mfma_f32_16x16x32_bf16 v[28:31], v[172:175], v[32:35], v[28:31]
    v_mfma_f32_16x16x32_bf16 v[20:23], v[172:175], v[108:111], v[20:23]
    s_waitcnt vmcnt(0)
    ds_write_b128 v6, v[188:191] offset:3072
    ds_read_b64_tr_b16 v[188:189], v7 offset:3072
    ds_read_b64_tr_b16 v[190:191], v7 offset:3200
    s_waitcnt lgkmcnt(9)
    v_mfma_f32_16x16x32_bf16 v[28:31], v[176:179], v[32:35], v[28:31]
    v_mfma_f32_16x16x32_bf16 v[20:23], v[176:179], v[112:115], v[20:23]
    s_waitcnt lgkmcnt(6)
    v_mfma_f32_16x16x32_bf16 v[28:31], v[180:183], v[32:35], v[28:31]
    v_mfma_f32_16x16x32_bf16 v[20:23], v[180:183], v[116:119], v[20:23]
    s_waitcnt lgkmcnt(3)
    v_mfma_f32_16x16x32_bf16 v[28:31], v[184:187], v[32:35], v[28:31]
    v_mfma_f32_16x16x32_bf16 v[20:23], v[184:187], v[120:123], v[20:23]
    s_waitcnt lgkmcnt(0)
    v_mfma_f32_16x16x32_bf16 v[28:31], v[188:191], v[32:35], v[28:31]
    v_mfma_f32_16x16x32_bf16 v[20:23], v[188:191], v[124:127], v[20:23]
    s_nop 7
    v_pk_fma_f32 v[20:21], v[28:29], v[24:25], v[20:21] op_sel_hi:[1,0,1] neg_lo:[1,0,0] neg_hi:[1,0,0]
    v_pk_fma_f32 v[22:23], v[30:31], v[24:25], v[22:23] op_sel_hi:[1,0,1] neg_lo:[1,0,0] neg_hi:[1,0,0]
    v_pk_mul_f32 v[20:21], v[20:21], v[36:37] op_sel_hi:[1,0]
    v_pk_mul_f32 v[22:23], v[22:23], v[36:37] op_sel_hi:[1,0]
    v_cvt_pk_bf16_f32 v20, v20, v21
    v_cvt_pk_bf16_f32 v21, v22, v23
    buffer_store_dwordx2 v[20:21], v18, s[44:47], s58 offen sc1
    v_mov_b32 v17, s52
    s_mov_b64 exec, 255
    s_waitcnt vmcnt(0)
    buffer_store_dword v17, v16, s[44:47], s61 offen sc1
    s_mov_b64 exec, -1
    s_setprio 1
    s_branch G_ks
.p2align 6
V_start:
    s_mov_b32 s44, s28
    s_and_b32 s45, s29, 0xffff
    s_mov_b32 s46, 16777216
    s_mov_b32 s47, 0x20000
    s_mov_b32 s31, 3
    v_mov_b32 v2, 160768
    v_mov_b32 v3, 1
    v_add_u32 v6, 144384, v5
    v_bfe_u32 v14, v1, 2, 2
    v_lshl_add_u32 v14, v12, 3, v14
    v_and_b32 v15, 3, v1
    v_lshlrev_b32 v15, 3, v15
    v_lshl_add_u32 v7, v14, 5, v15
    v_add_u32 v7, 144384, v7
    v_and_b32 v14, 1, v12
    v_lshrrev_b32 v15, 1, v12
    v_lshlrev_b32 v13, 4, v13
    v_lshl_add_u32 v19, v15, 8, v13
    v_lshl_add_u32 v19, v14, 3, v19
    s_lshr_b32 s7, s57, 1
    s_lshl1_add_u32 s7, s4, s7
    s_lshl_b32 s7, s7, 10
    s_and_b32 s6, s57, 1
    s_lshl_b32 s59, s6, 9
    s_add_u32 s59, s59, s7
    s_add_u32 s59, s59, 3211264
    v_mul_u32_u24 v16, 70656, v1
    s_and_b32 s6, s2, 7
    s_lshr_b32 s7, s6, 0
    s_mul_i32 s62, s7, 70656
    s_add_u32 s62, s62, 3407872
    s_lshr_b32 s7, s2, 3
    s_mul_i32 s6, s6, 640
    s_lshl2_add_u32 s6, s7, s6
    v_lshrrev_b32 v14, 3, v1
    v_mul_u32_u24 v14, 640, v14
    v_and_b32 v15, 7, v1
    v_lshl_add_u32 v10, v15, 4, v14
    s_add_u32 s61, s6, 3407872
    v_mov_b32 v32, 0x3f803f80
    v_mov_b32 v33, 0x3f803f80
    v_mov_b32 v34, 0x3f803f80
    v_mov_b32 v35, 0x3f803f80
    v_mov_b32 v36, 0
    v_mov_b32 v37, 0
    s_waitcnt vmcnt(31)
    v_mfma_f32_16x16x32_bf16 v[24:27], v[32:35], v[64:67], 0
    v_mfma_f32_16x16x32_bf16 v[60:63], v[64:67], v[64:67], 0
    s_waitcnt vmcnt(30)
    v_mfma_f32_16x16x32_bf16 v[24:27], v[32:35], v[68:71], v[24:27]
    v_mfma_f32_16x16x32_bf16 v[60:63], v[68:71], v[68:71], v[60:63]
    s_waitcnt vmcnt(29)
    v_mfma_f32_16x16x32_bf16 v[24:27], v[32:35], v[72:75], v[24:27]
    v_mfma_f32_16x16x32_bf16 v[60:63], v[72:75], v[72:75], v[60:63]
    s_waitcnt vmcnt(28)
    v_mfma_f32_16x16x32_bf16 v[24:27], v[32:35], v[76:79], v[24:27]
    v_mfma_f32_16x16x32_bf16 v[60:63], v[76:79], v[76:79], v[60:63]
    s_waitcnt vmcnt(27)
    v_mfma_f32_16x16x32_bf16 v[24:27], v[32:35], v[80:83], v[24:27]
    v_mfma_f32_16x16x32_bf16 v[60:63], v[80:83], v[80:83], v[60:63]
    s_waitcnt vmcnt(26)
    v_mfma_f32_16x16x32_bf16 v[24:27], v[32:35], v[84:87], v[24:27]
    v_mfma_f32_16x16x32_bf16 v[60:63], v[84:87], v[84:87], v[60:63]
    s_waitcnt vmcnt(25)
    v_mfma_f32_16x16x32_bf16 v[24:27], v[32:35], v[88:91], v[24:27]
    v_mfma_f32_16x16x32_bf16 v[60:63], v[88:91], v[88:91], v[60:63]
    s_waitcnt vmcnt(24)
    v_mfma_f32_16x16x32_bf16 v[24:27], v[32:35], v[92:95], v[24:27]
    v_mfma_f32_16x16x32_bf16 v[60:63], v[92:95], v[92:95], v[60:63]
    s_waitcnt vmcnt(23)
    v_mfma_f32_16x16x32_bf16 v[24:27], v[32:35], v[96:99], v[24:27]
    v_mfma_f32_16x16x32_bf16 v[60:63], v[96:99], v[96:99], v[60:63]
    s_waitcnt vmcnt(22)
    v_mfma_f32_16x16x32_bf16 v[24:27], v[32:35], v[100:103], v[24:27]
    v_mfma_f32_16x16x32_bf16 v[60:63], v[100:103], v[100:103], v[60:63]
    s_waitcnt vmcnt(21)
    v_mfma_f32_16x16x32_bf16 v[24:27], v[32:35], v[104:107], v[24:27]
    v_mfma_f32_16x16x32_bf16 v[60:63], v[104:107], v[104:107], v[60:63]
    s_waitcnt vmcnt(20)
    v_mfma_f32_16x16x32_bf16 v[24:27], v[32:35], v[108:111], v[24:27]
    v_mfma_f32_16x16x32_bf16 v[60:63], v[108:111], v[108:111], v[60:63]
    s_waitcnt vmcnt(19)
    v_mfma_f32_16x16x32_bf16 v[24:27], v[32:35], v[112:115], v[24:27]
    v_mfma_f32_16x16x32_bf16 v[60:63], v[112:115], v[112:115], v[60:63]
    s_waitcnt vmcnt(18)
    v_mfma_f32_16x16x32_bf16 v[24:27], v[32:35], v[116:119], v[24:27]
    v_mfma_f32_16x16x32_bf16 v[60:63], v[116:119], v[116:119], v[60:63]
    s_waitcnt vmcnt(17)
    v_mfma_f32_16x16x32_bf16 v[24:27], v[32:35], v[120:123], v[24:27]
    v_mfma_f32_16x16x32_bf16 v[60:63], v[120:123], v[120:123], v[60:63]
    s_waitcnt vmcnt(16)
    v_mfma_f32_16x16x32_bf16 v[24:27], v[32:35], v[124:127], v[24:27]
    v_mfma_f32_16x16x32_bf16 v[60:63], v[124:127], v[124:127], v[60:63]
    s_mov_b32 s36, s12
    s_and_b32 s37, s13, 0xffff
    s_mov_b32 s38, 16384
    s_mov_b32 s39, 0x20000
    s_waitcnt lgkmcnt(0)
    s_add_u32 s52, s52, 1
    s_addc_u32 s53, s53, 0
    s_waitcnt vmcnt(15)
    ds_write_b128 v6, v[128:131] offset:0
    ds_read_b64_tr_b16 v[128:129], v7 offset:0
    ds_read_b64_tr_b16 v[130:131], v7 offset:128
    s_nop 1
    s_mov_b32 exec_lo, 0x00100001
    s_mov_b32 exec_hi, 0x10000100
    v_mov_b32 v36, v60
    s_lshl_b64 exec, exec, 1
    v_mov_b32 v36, v61
    s_lshl_b64 exec, exec, 1
    v_mov_b32 v36, v62
    s_lshl_b64 exec, exec, 1
    v_mov_b32 v36, v63
    s_mov_b64 exec, -1
    v_mov_b32 v37, v36
    s_waitcnt vmcnt(14)
    ds_write_b128 v6, v[132:135] offset:1024
    ds_read_b64_tr_b16 v[132:133], v7 offset:1024
    ds_read_b64_tr_b16 v[134:135], v7 offset:1152
    v_permlane16_swap_b32 v36, v37
    v_mul_f32 v24, 0x3b000000, v24
    v_add_f32 v36, v36, v37
    v_mov_b32 v37, v36
    v_mul_f32 v25, v24, v24
    s_waitcnt vmcnt(13)
    ds_write_b128 v6, v[136:139] offset:2048
    ds_read_b64_tr_b16 v[136:137], v7 offset:2048
    ds_read_b64_tr_b16 v[138:139], v7 offset:2176
    v_permlane32_swap_b32 v36, v37
    v_mov_b32 v26, 0x3b000000
    v_add_f32 v36, v36, v37
    v_fma_f32 v36, v36, v26, -v25
    v_max_f32 v36, 0, v36
    s_waitcnt vmcnt(12)
    ds_write_b128 v6, v[140:143] offset:3072
    ds_read_b64_tr_b16 v[140:141], v7 offset:3072
    ds_read_b64_tr_b16 v[142:143], v7 offset:3200
    v_cvt_pk_bf16_f32 v36, v24, v36
    v_lshlrev_b32 v24, 16, v36
    v_and_b32 v36, 0xffff0000, v36
    v_add_f32 v36, 0x3727c5ac, v36
    s_waitcnt lgkmcnt(9)
    v_mfma_f32_16x16x32_bf16 v[28:31], v[32:35], v[128:131], 0
    v_mfma_f32_16x16x32_bf16 v[20:23], v[64:67], v[128:131], 0
    s_waitcnt vmcnt(11)
    ds_write_b128 v6, v[144:147] offset:0
    ds_read_b64_tr_b16 v[144:145], v7 offset:0
    ds_read_b64_tr_b16 v[146:147], v7 offset:128
    v_cvt_pk_bf16_f32 v36, v36, v36
    v_and_b32 v36, 0xffff0000, v36
    v_sqrt_f32 v36, v36
    s_waitcnt lgkmcnt(9)
    v_mfma_f32_16x16x32_bf16 v[28:31], v[32:35], v[132:135], v[28:31]
    v_mfma_f32_16x16x32_bf16 v[20:23], v[68:71], v[132:135], v[20:23]
    s_waitcnt vmcnt(10)
    ds_write_b128 v6, v[148:151] offset:1024
    ds_read_b64_tr_b16 v[148:149], v7 offset:1024
    ds_read_b64_tr_b16 v[150:151], v7 offset:1152
    v_cvt_pk_bf16_f32 v36, v36, v36
    v_and_b32 v36, 0xffff0000, v36
    v_rcp_f32 v36, v36
    s_waitcnt lgkmcnt(9)
    v_mfma_f32_16x16x32_bf16 v[28:31], v[32:35], v[136:139], v[28:31]
    v_mfma_f32_16x16x32_bf16 v[20:23], v[72:75], v[136:139], v[20:23]
    s_waitcnt vmcnt(9)
    ds_write_b128 v6, v[152:155] offset:2048
    ds_read_b64_tr_b16 v[152:153], v7 offset:2048
    ds_read_b64_tr_b16 v[154:155], v7 offset:2176
    v_mov_b32_dpp v40, v24 row_newbcast:0 row_mask:0x1 bank_mask:0xf
    v_mov_b32_dpp v41, v24 row_newbcast:1 row_mask:0x1 bank_mask:0xf
    v_mov_b32_dpp v42, v24 row_newbcast:2 row_mask:0x1 bank_mask:0xf
    v_mov_b32_dpp v43, v24 row_newbcast:3 row_mask:0x1 bank_mask:0xf
    s_waitcnt lgkmcnt(9)
    v_mfma_f32_16x16x32_bf16 v[28:31], v[32:35], v[140:143], v[28:31]
    v_mfma_f32_16x16x32_bf16 v[20:23], v[76:79], v[140:143], v[20:23]
    s_waitcnt vmcnt(8)
    ds_write_b128 v6, v[156:159] offset:3072
    ds_read_b64_tr_b16 v[156:157], v7 offset:3072
    ds_read_b64_tr_b16 v[158:159], v7 offset:3200
    v_mov_b32_dpp v40, v24 row_newbcast:4 row_mask:0x2 bank_mask:0xf
    v_mov_b32_dpp v41, v24 row_newbcast:5 row_mask:0x2 bank_mask:0xf
    v_mov_b32_dpp v42, v24 row_newbcast:6 row_mask:0x2 bank_mask:0xf
    v_mov_b32_dpp v43, v24 row_newbcast:7 row_mask:0x2 bank_mask:0xf
    s_waitcnt lgkmcnt(9)
    v_mfma_f32_16x16x32_bf16 v[28:31], v[32:35], v[144:147], v[28:31]
    v_mfma_f32_16x16x32_bf16 v[20:23], v[80:83], v[144:147], v[20:23]
    s_waitcnt vmcnt(7)
    ds_write_b128 v6, v[160:163] offset:0
    ds_read_b64_tr_b16 v[160:161], v7 offset:0
    ds_read_b64_tr_b16 v[162:163], v7 offset:128
    v_mov_b32_dpp v40, v24 row_newbcast:8 row_mask:0x4 bank_mask:0xf
    v_mov_b32_dpp v41, v24 row_newbcast:9 row_mask:0x4 bank_mask:0xf
    v_mov_b32_dpp v42, v24 row_newbcast:10 row_mask:0x4 bank_mask:0xf
    v_mov_b32_dpp v43, v24 row_newbcast:11 row_mask:0x4 bank_mask:0xf
    s_waitcnt lgkmcnt(9)
    v_mfma_f32_16x16x32_bf16 v[28:31], v[32:35], v[148:151], v[28:31]
    v_mfma_f32_16x16x32_bf16 v[20:23], v[84:87], v[148:151], v[20:23]
    s_waitcnt vmcnt(6)
    ds_write_b128 v6, v[164:167] offset:1024
    ds_read_b64_tr_b16 v[164:165], v7 offset:1024
    ds_read_b64_tr_b16 v[166:167], v7 offset:1152
    v_mov_b32_dpp v40, v24 row_newbcast:12 row_mask:0x8 bank_mask:0xf
    v_mov_b32_dpp v41, v24 row_newbcast:13 row_mask:0x8 bank_mask:0xf
    v_mov_b32_dpp v42, v24 row_newbcast:14 row_mask:0x8 bank_mask:0xf
    v_mov_b32_dpp v43, v24 row_newbcast:15 row_mask:0x8 bank_mask:0xf
    s_waitcnt lgkmcnt(9)
    v_mfma_f32_16x16x32_bf16 v[28:31], v[32:35], v[152:155], v[28:31]
    v_mfma_f32_16x16x32_bf16 v[20:23], v[88:91], v[152:155], v[20:23]
    s_waitcnt vmcnt(5)
    ds_write_b128 v6, v[168:171] offset:2048
    ds_read_b64_tr_b16 v[168:169], v7 offset:2048
    ds_read_b64_tr_b16 v[170:171], v7 offset:2176
    v_mov_b32_dpp v44, v36 row_newbcast:0 row_mask:0x1 bank_mask:0xf
    v_mov_b32_dpp v45, v36 row_newbcast:1 row_mask:0x1 bank_mask:0xf
    v_mov_b32_dpp v46, v36 row_newbcast:2 row_mask:0x1 bank_mask:0xf
    v_mov_b32_dpp v47, v36 row_newbcast:3 row_mask:0x1 bank_mask:0xf
    s_waitcnt lgkmcnt(9)
    v_mfma_f32_16x16x32_bf16 v[28:31], v[32:35], v[156:159], v[28:31]
    v_mfma_f32_16x16x32_bf16 v[20:23], v[92:95], v[156:159], v[20:23]
    s_waitcnt vmcnt(4)
    ds_write_b128 v6, v[172:175] offset:3072
    ds_read_b64_tr_b16 v[172:173], v7 offset:3072
    ds_read_b64_tr_b16 v[174:175], v7 offset:3200
    v_mov_b32_dpp v44, v36 row_newbcast:4 row_mask:0x2 bank_mask:0xf
    v_mov_b32_dpp v45, v36 row_newbcast:5 row_mask:0x2 bank_mask:0xf
    v_mov_b32_dpp v46, v36 row_newbcast:6 row_mask:0x2 bank_mask:0xf
    v_mov_b32_dpp v47, v36 row_newbcast:7 row_mask:0x2 bank_mask:0xf
    s_waitcnt lgkmcnt(9)
    v_mfma_f32_16x16x32_bf16 v[28:31], v[32:35], v[160:163], v[28:31]
    v_mfma_f32_16x16x32_bf16 v[20:23], v[96:99], v[160:163], v[20:23]
    s_waitcnt vmcnt(3)
    ds_write_b128 v6, v[176:179] offset:0
    ds_read_b64_tr_b16 v[176:177], v7 offset:0
    ds_read_b64_tr_b16 v[178:179], v7 offset:128
    v_mov_b32_dpp v44, v36 row_newbcast:8 row_mask:0x4 bank_mask:0xf
    v_mov_b32_dpp v45, v36 row_newbcast:9 row_mask:0x4 bank_mask:0xf
    v_mov_b32_dpp v46, v36 row_newbcast:10 row_mask:0x4 bank_mask:0xf
    v_mov_b32_dpp v47, v36 row_newbcast:11 row_mask:0x4 bank_mask:0xf
    s_waitcnt lgkmcnt(9)
    v_mfma_f32_16x16x32_bf16 v[28:31], v[32:35], v[164:167], v[28:31]
    v_mfma_f32_16x16x32_bf16 v[20:23], v[100:103], v[164:167], v[20:23]
    s_waitcnt vmcnt(2)
    ds_write_b128 v6, v[180:183] offset:1024
    ds_read_b64_tr_b16 v[180:181], v7 offset:1024
    ds_read_b64_tr_b16 v[182:183], v7 offset:1152
    v_mov_b32_dpp v44, v36 row_newbcast:12 row_mask:0x8 bank_mask:0xf
    v_mov_b32_dpp v45, v36 row_newbcast:13 row_mask:0x8 bank_mask:0xf
    v_mov_b32_dpp v46, v36 row_newbcast:14 row_mask:0x8 bank_mask:0xf
    v_mov_b32_dpp v47, v36 row_newbcast:15 row_mask:0x8 bank_mask:0xf
    s_waitcnt lgkmcnt(9)
    v_mfma_f32_16x16x32_bf16 v[28:31], v[32:35], v[168:171], v[28:31]
    v_mfma_f32_16x16x32_bf16 v[20:23], v[104:107], v[168:171], v[20:23]
    s_waitcnt vmcnt(1)
    ds_write_b128 v6, v[184:187] offset:2048
    ds_read_b64_tr_b16 v[184:185], v7 offset:2048
    ds_read_b64_tr_b16 v[186:187], v7 offset:2176
    s_waitcnt lgkmcnt(9)
    v_mfma_f32_16x16x32_bf16 v[28:31], v[32:35], v[172:175], v[28:31]
    v_mfma_f32_16x16x32_bf16 v[20:23], v[108:111], v[172:175], v[20:23]
    s_waitcnt vmcnt(0)
    ds_write_b128 v6, v[188:191] offset:3072
    ds_read_b64_tr_b16 v[188:189], v7 offset:3072
    ds_read_b64_tr_b16 v[190:191], v7 offset:3200
    s_waitcnt lgkmcnt(9)
    v_mfma_f32_16x16x32_bf16 v[28:31], v[32:35], v[176:179], v[28:31]
    v_mfma_f32_16x16x32_bf16 v[20:23], v[112:115], v[176:179], v[20:23]
    s_waitcnt lgkmcnt(6)
    v_mfma_f32_16x16x32_bf16 v[28:31], v[32:35], v[180:183], v[28:31]
    v_mfma_f32_16x16x32_bf16 v[20:23], v[116:119], v[180:183], v[20:23]
    s_waitcnt lgkmcnt(3)
    v_mfma_f32_16x16x32_bf16 v[28:31], v[32:35], v[184:187], v[28:31]
    v_mfma_f32_16x16x32_bf16 v[20:23], v[120:123], v[184:187], v[20:23]
    s_waitcnt lgkmcnt(0)
    v_mfma_f32_16x16x32_bf16 v[28:31], v[32:35], v[188:191], v[28:31]
    v_mfma_f32_16x16x32_bf16 v[20:23], v[124:127], v[188:191], v[20:23]
    s_nop 7
    v_pk_fma_f32 v[20:21], v[28:29], v[40:41], v[20:21] neg_lo:[1,0,0] neg_hi:[1,0,0]
    v_pk_fma_f32 v[22:23], v[30:31], v[42:43], v[22:23] neg_lo:[1,0,0] neg_hi:[1,0,0]
    v_pk_mul_f32 v[20:21], v[20:21], v[44:45]
    v_pk_mul_f32 v[22:23], v[22:23], v[46:47]
    v_cvt_pk_bf16_f32 v20, v20, v21
    v_cvt_pk_bf16_f32 v21, v22, v23
    buffer_store_dwordx2 v[20:21], v19, s[44:47], s59 offen sc1
    s_movk_i32 s6, 0
    buffer_load_dwordx4 v[128:131], v5, s[36:39], s6 offen offset:0
    buffer_load_dwordx4 v[132:135], v5, s[36:39], s6 offen offset:1024
    buffer_load_dwordx4 v[136:139], v5, s[36:39], s6 offen offset:2048
    buffer_load_dwordx4 v[140:143], v5, s[36:39], s6 offen offset:3072
    s_movk_i32 s6, 4096
    buffer_load_dwordx4 v[144:147], v5, s[36:39], s6 offen offset:0
    buffer_load_dwordx4 v[148:151], v5, s[36:39], s6 offen offset:1024
    buffer_load_dwordx4 v[152:155], v5, s[36:39], s6 offen offset:2048
    buffer_load_dwordx4 v[156:159], v5, s[36:39], s6 offen offset:3072
    s_movk_i32 s6, 8192
    buffer_load_dwordx4 v[160:163], v5, s[36:39], s6 offen offset:0
    buffer_load_dwordx4 v[164:167], v5, s[36:39], s6 offen offset:1024
    buffer_load_dwordx4 v[168:171], v5, s[36:39], s6 offen offset:2048
    buffer_load_dwordx4 v[172:175], v5, s[36:39], s6 offen offset:3072
    s_movk_i32 s6, 12288
    buffer_load_dwordx4 v[176:179], v5, s[36:39], s6 offen offset:0
    buffer_load_dwordx4 v[180:183], v5, s[36:39], s6 offen offset:1024
    buffer_load_dwordx4 v[184:187], v5, s[36:39], s6 offen offset:2048
    buffer_load_dwordx4 v[188:191], v5, s[36:39], s6 offen offset:3072
    v_mov_b32 v17, s52
    s_mov_b64 exec, 255
    s_waitcnt vmcnt(16)
    buffer_store_dword v17, v16, s[44:47], s61 offen sc1
    s_mov_b64 exec, -1
    s_setprio 1
    v_and_b32 v14, 1, v12
    v_lshrrev_b32 v15, 1, v12
    v_lshl_add_u32 v18, v14, 9, v13
    v_lshl_add_u32 v18, v15, 3, v18
    s_waitcnt vmcnt(16)
    ds_write_b128 v6, v[128:131] offset:0
    ds_read_b64_tr_b16 v[128:129], v7 offset:0
    ds_read_b64_tr_b16 v[130:131], v7 offset:128
    s_waitcnt vmcnt(15)
    ds_write_b128 v6, v[132:135] offset:1024
    ds_read_b64_tr_b16 v[132:133], v7 offset:1024
    ds_read_b64_tr_b16 v[134:135], v7 offset:1152
    s_waitcnt vmcnt(14)
    ds_write_b128 v6, v[136:139] offset:2048
    ds_read_b64_tr_b16 v[136:137], v7 offset:2048
    ds_read_b64_tr_b16 v[138:139], v7 offset:2176
    s_waitcnt vmcnt(13)
    ds_write_b128 v6, v[140:143] offset:3072
    ds_read_b64_tr_b16 v[140:141], v7 offset:3072
    ds_read_b64_tr_b16 v[142:143], v7 offset:3200
    s_waitcnt lgkmcnt(9)
    v_mfma_f32_16x16x32_bf16 v[28:31], v[128:131], v[32:35], 0
    v_mfma_f32_16x16x32_bf16 v[20:23], v[128:131], v[64:67], 0
    s_waitcnt vmcnt(12)
    ds_write_b128 v6, v[144:147] offset:0
    ds_read_b64_tr_b16 v[144:145], v7 offset:0
    ds_read_b64_tr_b16 v[146:147], v7 offset:128
    s_waitcnt lgkmcnt(9)
    v_mfma_f32_16x16x32_bf16 v[28:31], v[132:135], v[32:35], v[28:31]
    v_mfma_f32_16x16x32_bf16 v[20:23], v[132:135], v[68:71], v[20:23]
    s_waitcnt vmcnt(11)
    ds_write_b128 v6, v[148:151] offset:1024
    ds_read_b64_tr_b16 v[148:149], v7 offset:1024
    ds_read_b64_tr_b16 v[150:151], v7 offset:1152
    s_waitcnt lgkmcnt(9)
    v_mfma_f32_16x16x32_bf16 v[28:31], v[136:139], v[32:35], v[28:31]
    v_mfma_f32_16x16x32_bf16 v[20:23], v[136:139], v[72:75], v[20:23]
    s_waitcnt vmcnt(10)
    ds_write_b128 v6, v[152:155] offset:2048
    ds_read_b64_tr_b16 v[152:153], v7 offset:2048
    ds_read_b64_tr_b16 v[154:155], v7 offset:2176
    s_waitcnt lgkmcnt(9)
    v_mfma_f32_16x16x32_bf16 v[28:31], v[140:143], v[32:35], v[28:31]
    v_mfma_f32_16x16x32_bf16 v[20:23], v[140:143], v[76:79], v[20:23]
    s_waitcnt vmcnt(9)
    ds_write_b128 v6, v[156:159] offset:3072
    ds_read_b64_tr_b16 v[156:157], v7 offset:3072
    ds_read_b64_tr_b16 v[158:159], v7 offset:3200
    s_waitcnt lgkmcnt(9)
    v_mfma_f32_16x16x32_bf16 v[28:31], v[144:147], v[32:35], v[28:31]
    v_mfma_f32_16x16x32_bf16 v[20:23], v[144:147], v[80:83], v[20:23]
    s_waitcnt vmcnt(8)
    ds_write_b128 v6, v[160:163] offset:0
    ds_read_b64_tr_b16 v[160:161], v7 offset:0
    ds_read_b64_tr_b16 v[162:163], v7 offset:128
    s_waitcnt lgkmcnt(9)
    v_mfma_f32_16x16x32_bf16 v[28:31], v[148:151], v[32:35], v[28:31]
    v_mfma_f32_16x16x32_bf16 v[20:23], v[148:151], v[84:87], v[20:23]
    s_waitcnt vmcnt(7)
    ds_write_b128 v6, v[164:167] offset:1024
    ds_read_b64_tr_b16 v[164:165], v7 offset:1024
    ds_read_b64_tr_b16 v[166:167], v7 offset:1152
    s_waitcnt lgkmcnt(9)
    v_mfma_f32_16x16x32_bf16 v[28:31], v[152:155], v[32:35], v[28:31]
    v_mfma_f32_16x16x32_bf16 v[20:23], v[152:155], v[88:91], v[20:23]
    s_waitcnt vmcnt(6)
    ds_write_b128 v6, v[168:171] offset:2048
    ds_read_b64_tr_b16 v[168:169], v7 offset:2048
    ds_read_b64_tr_b16 v[170:171], v7 offset:2176
    s_waitcnt lgkmcnt(9)
    v_mfma_f32_16x16x32_bf16 v[28:31], v[156:159], v[32:35], v[28:31]
    v_mfma_f32_16x16x32_bf16 v[20:23], v[156:159], v[92:95], v[20:23]
    s_waitcnt vmcnt(5)
    ds_write_b128 v6, v[172:175] offset:3072
    ds_read_b64_tr_b16 v[172:173], v7 offset:3072
    ds_read_b64_tr_b16 v[174:175], v7 offset:3200
    s_waitcnt lgkmcnt(9)
    v_mfma_f32_16x16x32_bf16 v[28:31], v[160:163], v[32:35], v[28:31]
    v_mfma_f32_16x16x32_bf16 v[20:23], v[160:163], v[96:99], v[20:23]
    s_waitcnt vmcnt(4)
    ds_write_b128 v6, v[176:179] offset:0
    ds_read_b64_tr_b16 v[176:177], v7 offset:0
    ds_read_b64_tr_b16 v[178:179], v7 offset:128
    s_waitcnt lgkmcnt(9)
    v_mfma_f32_16x16x32_bf16 v[28:31], v[164:167], v[32:35], v[28:31]
    v_mfma_f32_16x16x32_bf16 v[20:23], v[164:167], v[100:103], v[20:23]
    s_waitcnt vmcnt(3)
    ds_write_b128 v6, v[180:183] offset:1024
    ds_read_b64_tr_b16 v[180:181], v7 offset:1024
    ds_read_b64_tr_b16 v[182:183], v7 offset:1152
    s_waitcnt lgkmcnt(9)
    v_mfma_f32_16x16x32_bf16 v[28:31], v[168:171], v[32:35], v[28:31]
    v_mfma_f32_16x16x32_bf16 v[20:23], v[168:171], v[104:107], v[20:23]
    s_waitcnt vmcnt(2)
    ds_write_b128 v6, v[184:187] offset:2048
    ds_read_b64_tr_b16 v[184:185], v7 offset:2048
    ds_read_b64_tr_b16 v[186:187], v7 offset:2176
    s_waitcnt lgkmcnt(9)
    v_mfma_f32_16x16x32_bf16 v[28:31], v[172:175], v[32:35], v[28:31]
    v_mfma_f32_16x16x32_bf16 v[20:23], v[172:175], v[108:111], v[20:23]
    s_waitcnt vmcnt(1)
    ds_write_b128 v6, v[188:191] offset:3072
    ds_read_b64_tr_b16 v[188:189], v7 offset:3072
    ds_read_b64_tr_b16 v[190:191], v7 offset:3200
    s_waitcnt lgkmcnt(9)
    v_mfma_f32_16x16x32_bf16 v[28:31], v[176:179], v[32:35], v[28:31]
    v_mfma_f32_16x16x32_bf16 v[20:23], v[176:179], v[112:115], v[20:23]
    s_waitcnt lgkmcnt(6)
    v_mfma_f32_16x16x32_bf16 v[28:31], v[180:183], v[32:35], v[28:31]
    v_mfma_f32_16x16x32_bf16 v[20:23], v[180:183], v[116:119], v[20:23]
    s_waitcnt lgkmcnt(3)
    v_mfma_f32_16x16x32_bf16 v[28:31], v[184:187], v[32:35], v[28:31]
    v_mfma_f32_16x16x32_bf16 v[20:23], v[184:187], v[120:123], v[20:23]
    s_waitcnt lgkmcnt(0)
    v_mfma_f32_16x16x32_bf16 v[28:31], v[188:191], v[32:35], v[28:31]
    v_mfma_f32_16x16x32_bf16 v[20:23], v[188:191], v[124:127], v[20:23]
    s_nop 7
    v_pk_fma_f32 v[20:21], v[28:29], v[24:25], v[20:21] op_sel_hi:[1,0,1] neg_lo:[1,0,0] neg_hi:[1,0,0]
    v_pk_fma_f32 v[22:23], v[30:31], v[24:25], v[22:23] op_sel_hi:[1,0,1] neg_lo:[1,0,0] neg_hi:[1,0,0]
    v_pk_mul_f32 v[20:21], v[20:21], v[36:37] op_sel_hi:[1,0]
    v_pk_mul_f32 v[22:23], v[22:23], v[36:37] op_sel_hi:[1,0]
    v_cvt_pk_bf16_f32 v20, v20, v21
    v_cvt_pk_bf16_f32 v21, v22, v23
G_ks:
    v_add_u32 v18, 144384, v18
    ds_write_b64 v18, v[20:21]
    s_xor_b32 s6, s57, 1
    s_lshl_b32 s6, s6, 8
    v_add_u32 v15, s6, v13
    v_mul_u32_u24 v14, 65, v15
    v_lshl_add_u32 v14, v12, 4, v14
    v_lshrrev_b32 v15, 2, v15
    v_add_u32 v15, v2, v15
    s_mov_b32 s54, 32768
G_kl_top:
    ds_read_b32 v19, v2 offset:0
    s_waitcnt lgkmcnt(0)
    v_readfirstlane_b32 s6, v19
    s_cmp_ge_u32 s6, 4
    s_cbranch_scc1 G_kl_ok
    s_sleep 0
    s_sub_u32 s54, s54, 1
    s_cmp_lg_u32 s54, 0
    s_cbranch_scc1 G_kl_top
G_kl_ok:
    s_setprio 3
    ds_read_b128 v[64:67], v14 offset:0
    ds_read_b128 v[68:71], v14 offset:64
    ds_read_b128 v[72:75], v14 offset:128
    ds_read_b128 v[76:79], v14 offset:192
    ds_read_b128 v[80:83], v14 offset:256
    ds_read_b128 v[84:87], v14 offset:320
    ds_read_b128 v[88:91], v14 offset:384
    ds_read_b128 v[92:95], v14 offset:448
    ds_read_b128 v[96:99], v14 offset:512
    ds_read_b128 v[100:103], v14 offset:576
    ds_read_b128 v[104:107], v14 offset:640
    ds_read_b128 v[108:111], v14 offset:704
    ds_read_b128 v[112:115], v14 offset:768
    ds_read_b128 v[116:119], v14 offset:832
    buffer_load_dwordx4 v[20:23], v10, s[44:47], s62 offen sc1
    ds_read_b128 v[120:123], v14 offset:896
    s_waitcnt lgkmcnt(14)
    v_mfma_f32_16x16x32_bf16 v[44:47], v[128:131], v[64:67], 0
    ds_read_b128 v[124:127], v14 offset:960
    s_waitcnt lgkmcnt(14)
    v_mfma_f32_16x16x32_bf16 v[48:51], v[132:135], v[68:71], 0
    ds_read_b32 v56, v15 offset:256
    s_waitcnt lgkmcnt(14)
    v_mfma_f32_16x16x32_bf16 v[44:47], v[136:139], v[72:75], v[44:47]
    s_waitcnt lgkmcnt(13)
    v_mfma_f32_16x16x32_bf16 v[48:51], v[140:143], v[76:79], v[48:51]
    s_waitcnt lgkmcnt(12)
    v_mfma_f32_16x16x32_bf16 v[44:47], v[144:147], v[80:83], v[44:47]
    s_waitcnt lgkmcnt(11)
    v_mfma_f32_16x16x32_bf16 v[48:51], v[148:151], v[84:87], v[48:51]
    s_waitcnt lgkmcnt(10)
    v_mfma_f32_16x16x32_bf16 v[44:47], v[152:155], v[88:91], v[44:47]
    s_waitcnt lgkmcnt(9)
    v_mfma_f32_16x16x32_bf16 v[48:51], v[156:159], v[92:95], v[48:51]
    s_waitcnt lgkmcnt(8)
    v_mfma_f32_16x16x32_bf16 v[44:47], v[160:163], v[96:99], v[44:47]
    s_waitcnt lgkmcnt(7)
    v_mfma_f32_16x16x32_bf16 v[48:51], v[164:167], v[100:103], v[48:51]
    s_waitcnt lgkmcnt(6)
    v_mfma_f32_16x16x32_bf16 v[44:47], v[168:171], v[104:107], v[44:47]
    s_waitcnt lgkmcnt(5)
    v_mfma_f32_16x16x32_bf16 v[48:51], v[172:175], v[108:111], v[48:51]
    s_waitcnt lgkmcnt(4)
    v_mfma_f32_16x16x32_bf16 v[44:47], v[176:179], v[112:115], v[44:47]
    s_waitcnt lgkmcnt(3)
    v_mfma_f32_16x16x32_bf16 v[48:51], v[180:183], v[116:119], v[48:51]
    s_waitcnt lgkmcnt(2)
    v_mfma_f32_16x16x32_bf16 v[44:47], v[184:187], v[120:123], v[44:47]
    s_waitcnt lgkmcnt(1)
    v_mfma_f32_16x16x32_bf16 v[48:51], v[188:191], v[124:127], v[48:51]
    s_waitcnt lgkmcnt(0)
    s_nop 6
    v_pk_add_f32 v[44:45], v[44:45], v[48:49]
    v_pk_add_f32 v[46:47], v[46:47], v[50:51]
    v_pk_mul_f32 v[44:45], v[44:45], v[56:57] op_sel_hi:[1,0]
    v_pk_mul_f32 v[46:47], v[46:47], v[56:57] op_sel_hi:[1,0]
    v_cvt_pk_bf16_f32 v44, v44, v45
    v_cvt_pk_bf16_f32 v45, v46, v47
    ds_write_b64 v18, v[44:45] offset:256
    ds_write_b32 v2, v3 offset:24
    s_setprio 3
    s_mov_b32 s54, 32768
    s_branch G_pkv_in
G_pkv_top:
    buffer_load_dwordx4 v[20:23], v10, s[44:47], s62 offen sc1
G_pkv_in:
    s_waitcnt vmcnt(0)
    v_xor_b32 v20, v20, v17
    v_xor_b32 v21, v21, v17
    v_xor_b32 v22, v22, v17
    v_xor_b32 v23, v23, v17
    v_or3_b32 v20, v20, v21, v22
    v_or_b32 v20, v20, v23
    v_cmp_ne_u32 vcc, 0, v20
    s_nop 0
    s_cbranch_vccz G_pkv_ok
    s_sleep 0
    s_sub_u32 s54, s54, 1
    s_cmp_lg_u32 s54, 0
    s_cbranch_scc1 G_pkv_top
G_pkv_ok:
    ds_write_b32 v2, v3 offset:8
    s_setprio 0
    v_lshrrev_b32 v8, 3, v1
    v_and_b32 v9, 7, v1
    v_lshrrev_b32 v10, 2, v1
    v_and_b32 v10, 4, v10
    v_xor_b32 v10, v9, v10
    v_lshlrev_b32 v4, 10, v8
    v_lshl_add_u32 v4, v10, 4, v4
    s_lshl_b32 s6, s5, 7
    v_add_u32 v4, s6, v4
    v_mov_b32 v3, 1
    s_mov_b64 exec, 1
    ds_add_u32 v2, v3 offset:16
    s_mov_b64 exec, -1
    s_mov_b32 s36, s16
    s_and_b32 s37, s17, 0xffff
    s_mov_b32 s38, 524288
    s_mov_b32 s39, 0x20000
    s_and_b32 s66, s4, 7
    v_and_b32 v16, 3, v1
    v_lshl_add_u32 v16, v16, 2, v2
    s_mov_b32 s54, 32768
G_pf_top:
    ds_read_b32 v17, v16 offset:32
    s_waitcnt lgkmcnt(0)
    v_cmp_eq_u32 vcc, 0, v17
    s_nop 0
    s_cbranch_vccz G_pf_ok
    s_sleep 4
    s_sub_u32 s54, s54, 1
    s_cmp_lg_u32 s54, 0
    s_cbranch_scc1 G_pf_top
G_pf_ok:
    s_lshl_b32 s7, s66, 16
    buffer_load_dwordx4 v[192:195], v4, s[36:39], s7 offen
    s_add_u32 s7, s7, 8192
    buffer_load_dwordx4 v[196:199], v4, s[36:39], s7 offen
    s_add_u32 s7, s7, 8192
    buffer_load_dwordx4 v[200:203], v4, s[36:39], s7 offen
    s_add_u32 s7, s7, 8192
    buffer_load_dwordx4 v[204:207], v4, s[36:39], s7 offen
    s_add_u32 s7, s7, 8192
    buffer_load_dwordx4 v[208:211], v4, s[36:39], s7 offen
    s_add_u32 s7, s7, 8192
    buffer_load_dwordx4 v[212:215], v4, s[36:39], s7 offen
    s_add_u32 s7, s7, 8192
    buffer_load_dwordx4 v[216:219], v4, s[36:39], s7 offen
    s_add_u32 s7, s7, 8192
    buffer_load_dwordx4 v[220:223], v4, s[36:39], s7 offen
    s_add_u32 s7, s7, 8192
    v_add_u32 v5, 7168, v4
    s_mov_b32 s54, 32768
G_wqf_top:
    ds_read2_b32 v[16:17], v2 offset0:3 offset1:4
    s_waitcnt lgkmcnt(0)
    v_add_u32 v16, v16, v17
    s_nop 0
    v_readfirstlane_b32 s6, v16
    s_cmp_ge_u32 s6, 8
    s_cbranch_scc1 G_wqf_ok
    s_sleep 3
    s_sub_u32 s54, s54, 1
    s_cmp_lg_u32 s54, 0
    s_cbranch_scc1 G_wqf_top
G_wqf_ok:
    s_setprio 3
    s_mov_b32 m0, 0
    s_mov_b32 s7, 0
    buffer_load_dwordx4 v4, s[36:39], s7 offen lds
    buffer_load_dwordx4 v5, s[36:39], s7 offen offset:1024 lds
    s_mov_b32 m0, 2048
    s_mov_b32 s7, 65536
    buffer_load_dwordx4 v4, s[36:39], s7 offen lds
    buffer_load_dwordx4 v5, s[36:39], s7 offen offset:1024 lds
    s_mov_b32 m0, 4096
    s_mov_b32 s7, 131072
    buffer_load_dwordx4 v4, s[36:39], s7 offen lds
    buffer_load_dwordx4 v5, s[36:39], s7 offen offset:1024 lds
    s_mov_b32 m0, 6144
    s_mov_b32 s7, 196608
    buffer_load_dwordx4 v4, s[36:39], s7 offen lds
    buffer_load_dwordx4 v5, s[36:39], s7 offen offset:1024 lds
    s_mov_b32 m0, 8192
    s_mov_b32 s7, 262144
    buffer_load_dwordx4 v4, s[36:39], s7 offen lds
    buffer_load_dwordx4 v5, s[36:39], s7 offen offset:1024 lds
    s_mov_b32 m0, 10240
    s_mov_b32 s7, 327680
    buffer_load_dwordx4 v4, s[36:39], s7 offen lds
    buffer_load_dwordx4 v5, s[36:39], s7 offen offset:1024 lds
    s_mov_b32 m0, 12288
    s_mov_b32 s7, 393216
    buffer_load_dwordx4 v4, s[36:39], s7 offen lds
    buffer_load_dwordx4 v5, s[36:39], s7 offen offset:1024 lds
    s_mov_b32 m0, 14336
    s_mov_b32 s7, 458752
    buffer_load_dwordx4 v4, s[36:39], s7 offen lds
    buffer_load_dwordx4 v5, s[36:39], s7 offen offset:1024 lds
    s_mov_b32 m0, 16384
    s_mov_b32 s7, 16384
    buffer_load_dwordx4 v4, s[36:39], s7 offen lds
    buffer_load_dwordx4 v5, s[36:39], s7 offen offset:1024 lds
    s_mov_b32 m0, 18432
    s_mov_b32 s7, 81920
    buffer_load_dwordx4 v4, s[36:39], s7 offen lds
    buffer_load_dwordx4 v5, s[36:39], s7 offen offset:1024 lds
    s_mov_b32 m0, 20480
    s_mov_b32 s7, 147456
    buffer_load_dwordx4 v4, s[36:39], s7 offen lds
    buffer_load_dwordx4 v5, s[36:39], s7 offen offset:1024 lds
    s_mov_b32 m0, 22528
    s_mov_b32 s7, 212992
    buffer_load_dwordx4 v4, s[36:39], s7 offen lds
    buffer_load_dwordx4 v5, s[36:39], s7 offen offset:1024 lds
    s_mov_b32 m0, 24576
    s_mov_b32 s7, 278528
    buffer_load_dwordx4 v4, s[36:39], s7 offen lds
    buffer_load_dwordx4 v5, s[36:39], s7 offen offset:1024 lds
    s_mov_b32 m0, 26624
    s_mov_b32 s7, 344064
    buffer_load_dwordx4 v4, s[36:39], s7 offen lds
    buffer_load_dwordx4 v5, s[36:39], s7 offen offset:1024 lds
    s_mov_b32 m0, 28672
    s_mov_b32 s7, 409600
    buffer_load_dwordx4 v4, s[36:39], s7 offen lds
    buffer_load_dwordx4 v5, s[36:39], s7 offen offset:1024 lds
    s_mov_b32 m0, 30720
    s_mov_b32 s7, 475136
    buffer_load_dwordx4 v4, s[36:39], s7 offen lds
    buffer_load_dwordx4 v5, s[36:39], s7 offen offset:1024 lds
    s_mov_b32 m0, 32768
    s_mov_b32 s7, 32768
    buffer_load_dwordx4 v4, s[36:39], s7 offen lds
    buffer_load_dwordx4 v5, s[36:39], s7 offen offset:1024 lds
    s_mov_b32 m0, 34816
    s_mov_b32 s7, 98304
    buffer_load_dwordx4 v4, s[36:39], s7 offen lds
    buffer_load_dwordx4 v5, s[36:39], s7 offen offset:1024 lds
    s_mov_b32 m0, 36864
    s_mov_b32 s7, 163840
    buffer_load_dwordx4 v4, s[36:39], s7 offen lds
    buffer_load_dwordx4 v5, s[36:39], s7 offen offset:1024 lds
    s_mov_b32 m0, 38912
    s_mov_b32 s7, 229376
    buffer_load_dwordx4 v4, s[36:39], s7 offen lds
    buffer_load_dwordx4 v5, s[36:39], s7 offen offset:1024 lds
    s_mov_b32 m0, 40960
    s_mov_b32 s7, 294912
    buffer_load_dwordx4 v4, s[36:39], s7 offen lds
    buffer_load_dwordx4 v5, s[36:39], s7 offen offset:1024 lds
    s_mov_b32 m0, 43008
    s_mov_b32 s7, 360448
    buffer_load_dwordx4 v4, s[36:39], s7 offen lds
    buffer_load_dwordx4 v5, s[36:39], s7 offen offset:1024 lds
    s_mov_b32 m0, 45056
    s_mov_b32 s7, 425984
    buffer_load_dwordx4 v4, s[36:39], s7 offen lds
    buffer_load_dwordx4 v5, s[36:39], s7 offen offset:1024 lds
    s_mov_b32 m0, 47104
    s_mov_b32 s7, 491520
    buffer_load_dwordx4 v4, s[36:39], s7 offen lds
    buffer_load_dwordx4 v5, s[36:39], s7 offen offset:1024 lds
    s_mov_b32 m0, 49152
    s_mov_b32 s7, 49152
    buffer_load_dwordx4 v4, s[36:39], s7 offen lds
    buffer_load_dwordx4 v5, s[36:39], s7 offen offset:1024 lds
    s_mov_b32 m0, 51200
    s_mov_b32 s7, 114688
    buffer_load_dwordx4 v4, s[36:39], s7 offen lds
    buffer_load_dwordx4 v5, s[36:39], s7 offen offset:1024 lds
    s_mov_b32 m0, 53248
    s_mov_b32 s7, 180224
    buffer_load_dwordx4 v4, s[36:39], s7 offen lds
    buffer_load_dwordx4 v5, s[36:39], s7 offen offset:1024 lds
    s_mov_b32 m0, 55296
    s_mov_b32 s7, 245760
    buffer_load_dwordx4 v4, s[36:39], s7 offen lds
    buffer_load_dwordx4 v5, s[36:39], s7 offen offset:1024 lds
    s_mov_b32 m0, 57344
    s_mov_b32 s7, 311296
    buffer_load_dwordx4 v4, s[36:39], s7 offen lds
    buffer_load_dwordx4 v5, s[36:39], s7 offen offset:1024 lds
    s_mov_b32 m0, 59392
    s_mov_b32 s7, 376832
    buffer_load_dwordx4 v4, s[36:39], s7 offen lds
    buffer_load_dwordx4 v5, s[36:39], s7 offen offset:1024 lds
    s_mov_b32 m0, 61440
    s_mov_b32 s7, 442368
    buffer_load_dwordx4 v4, s[36:39], s7 offen lds
    buffer_load_dwordx4 v5, s[36:39], s7 offen offset:1024 lds
    s_mov_b32 m0, 63488
    s_mov_b32 s7, 507904
    buffer_load_dwordx4 v4, s[36:39], s7 offen lds
    buffer_load_dwordx4 v5, s[36:39], s7 offen offset:1024 lds
    s_waitcnt vmcnt(16)
    ds_write_b32 v2, v3 offset:52
    s_branch G_ffn2
.p2align 6
A_start:
    s_setprio 2
    s_and_b32 s6, s2, 7
    s_lshl_b32 s6, s6, 2
    s_lshr_b32 s6, 0x14735260, s6
    s_and_b32 s6, s6, 7
    s_lshr_b32 s7, s2, 3
    s_and_b32 s5, s7, 3
    s_and_b32 s4, s6, 1
    s_lshl2_add_u32 s5, s4, s5
    s_lshr_b32 s6, s6, 1
    s_lshr_b32 s7, s7, 2
    s_lshl3_add_u32 s4, s6, s7
    s_lshl3_add_u32 s30, s4, s5
    v_and_b32 v1, 63, v0
    v_lshrrev_b32 v96, 3, v1
    v_and_b32 v97, 7, v1
    v_lshlrev_b32 v15, 10, v96
    v_lshl_add_u32 v15, v97, 4, v15
    s_lshl_b32 s6, s3, 4
    v_add_u32 v96, s6, v96
    v_mul_u32_u24 v8, 1040, v96
    v_lshl_add_u32 v8, v97, 4, v8
    v_mov_b32 v112, 160768
    v_lshl_add_u32 v9, v96, 2, v112
    v_mov_b32 v119, 1
    s_lshl_b32 s6, s3, 8
    s_add_u32 s6, s6, 83072
    v_lshlrev_b32 v114, 10, v97
    v_add_u32 v114, s6, v114
    v_lshrrev_b32 v98, 5, v1
    v_bfe_u32 v99, v1, 2, 2
    v_lshlrev_b32 v10, 10, v98
    v_lshl_add_u32 v10, v99, 7, v10
    v_bfe_u32 v100, v1, 4, 1
    v_lshl_add_u32 v10, v100, 5, v10
    v_and_b32 v100, 3, v1
    v_lshl_add_u32 v10, v100, 3, v10
    v_lshl_add_u32 v118, v100, 2, v112
    v_lshrrev_b32 v99, 1, v99
    s_and_b32 s6, s3, 1
    s_lshr_b32 s7, s3, 1
    v_xor_b32 v99, s6, v99
    v_lshl_add_u32 v10, v99, 6, v10
    v_add_u32 v10, 66560, v10
    s_lshl2_add_u32 s6, s6, s7
    s_lshl_b32 s6, s6, 10
    v_lshlrev_b32 v101, 4, v1
    v_add_u32 v113, 148480, v101
    v_add_u32 v115, s6, v113
    v_and_b32 v96, 31, v1
    s_lshl_b32 s6, s7, 5
    v_add_u32 v99, s6, v96
    v_mul_u32_u24 v11, 1040, v99
    v_lshl_add_u32 v11, v98, 4, v11
    v_lshl_add_u32 v12, v99, 2, v112
    s_mov_b32 s68, 0x3f803f80
    s_mov_b32 s69, 0x1f80
    s_mov_b32 s55, 0x1f800000
    s_mov_b32 s56, 0x0000ffff
    s_mov_b32 s57, 0x0000ffff
    s_lshl_b32 s66, s3, 11
    s_add_u32 s66, s66, 66560
    v_add_u32 v2, s66, v101
    s_lshl_b32 s6, s3, 11
    s_add_u32 s7, s6, 91136
    v_add_u32 v3, s7, v101
    v_mov_b32 v4, 0xdddddddd
    v_mov_b32 v5, 0xdddddddd
    v_lshlrev_b32 v6, 4, v96
    v_add_u32 v6, 156672, v6
    s_and_b32 s6, s3, 1
    s_lshr_b32 s7, s3, 1
    s_lshl2_add_u32 s7, s6, s7
    s_lshl_b32 s7, s7, 9
    v_add_u32 v116, s7, v6
    s_lshl_b32 s7, s3, 2
    v_add_u32 v117, s7, v112
    v_and_b32 v99, 15, v1
    v_lshlrev_b32 v7, 4, v99
    v_lshl_add_u32 v7, v98, 8, v7
    v_bfe_u32 v100, v1, 4, 1
    v_lshl_add_u32 v7, v100, 9, v7
    s_lshl_b32 s6, s3, 14
    s_add_u32 s62, s6, 3211264
    s_add_u32 s58, s6, 3145728
    s_sub_u32 s58, s58, s66
    s_and_b32 s7, s5, 3
    s_lshl_b32 s7, s7, 12
    s_xor_b32 s6, s7, 12288
    s_add_u32 s61, s58, s6
    s_add_u32 s65, s62, s6
    s_xor_b32 s6, s7, 8192
    s_add_u32 s60, s58, s6
    s_add_u32 s64, s62, s6
    s_xor_b32 s6, s7, 4096
    s_add_u32 s59, s58, s6
    s_add_u32 s63, s62, s6
    s_xor_b32 s6, s7, 0
    s_add_u32 s58, s58, s6
    s_add_u32 s62, s62, s6
    v_cmp_eq_u32 vcc, 20, v1
    v_mov_b32 v0, 0x3f80
    v_mov_b32 v1, 0
    v_cndmask_b32 v0, 0, v0, vcc
    v_cmp_eq_u32 vcc, 0, v99
    v_mov_b32 v92, 0x3f803f80
    s_lshl_b32 s6, s4, 16
    v_cndmask_b32 v92, 0, v92, vcc
    v_mov_b32 v93, v92
    s_lshl_b32 s7, s3, 14
    s_add_u32 s6, s6, s7
    s_add_u32 s7, s6, 8192
    s_waitcnt lgkmcnt(0)
    s_mov_b32 s32, s8
    s_and_b32 s33, s9, 0xffff
    s_mov_b32 s34, 2097152
    s_mov_b32 s35, 0x20000
    s_barrier
    buffer_load_dwordx4 v[16:19], v15, s[32:35], s6 offen offset:0
    buffer_load_dwordx4 v[20:23], v15, s[32:35], s6 offen offset:128
    buffer_load_dwordx4 v[24:27], v15, s[32:35], s6 offen offset:256
    buffer_load_dwordx4 v[28:31], v15, s[32:35], s6 offen offset:384
    buffer_load_dwordx4 v[32:35], v15, s[32:35], s6 offen offset:512
    buffer_load_dwordx4 v[36:39], v15, s[32:35], s6 offen offset:640
    buffer_load_dwordx4 v[40:43], v15, s[32:35], s6 offen offset:768
    buffer_load_dwordx4 v[44:47], v15, s[32:35], s6 offen offset:896
    buffer_load_dwordx4 v[48:51], v15, s[32:35], s7 offen offset:0
    buffer_load_dwordx4 v[52:55], v15, s[32:35], s7 offen offset:128
    buffer_load_dwordx4 v[56:59], v15, s[32:35], s7 offen offset:256
    buffer_load_dwordx4 v[60:63], v15, s[32:35], s7 offen offset:384
    buffer_load_dwordx4 v[64:67], v15, s[32:35], s7 offen offset:512
    buffer_load_dwordx4 v[68:71], v15, s[32:35], s7 offen offset:640
    buffer_load_dwordx4 v[72:75], v15, s[32:35], s7 offen offset:768
    buffer_load_dwordx4 v[76:79], v15, s[32:35], s7 offen offset:896
    s_mov_b32 s44, s28
    s_and_b32 s45, s29, 0xffff
    s_mov_b32 s46, 16777216
    s_mov_b32 s47, 0x20000
    v_pk_mov_b32 v[132:133], v[92:93], v[92:93]
    v_pk_mov_b32 v[134:135], v[92:93], v[92:93]
    v_pk_mov_b32 v[140:141], v[92:93], v[92:93]
    v_pk_mov_b32 v[142:143], v[92:93], v[92:93]
    v_pk_mov_b32 v[148:149], v[92:93], v[92:93]
    v_pk_mov_b32 v[150:151], v[92:93], v[92:93]
    v_pk_mov_b32 v[156:157], v[92:93], v[92:93]
    v_pk_mov_b32 v[158:159], v[92:93], v[92:93]
    v_pk_mov_b32 v[164:165], v[92:93], v[92:93]
    v_pk_mov_b32 v[166:167], v[92:93], v[92:93]
    v_pk_mov_b32 v[172:173], v[92:93], v[92:93]
    v_pk_mov_b32 v[174:175], v[92:93], v[92:93]
    v_pk_mov_b32 v[180:181], v[92:93], v[92:93]
    v_pk_mov_b32 v[182:183], v[92:93], v[92:93]
    v_pk_mov_b32 v[188:189], v[92:93], v[92:93]
    v_pk_mov_b32 v[190:191], v[92:93], v[92:93]
    v_pk_mov_b32 v[196:197], v[92:93], v[92:93]
    v_pk_mov_b32 v[198:199], v[92:93], v[92:93]
    v_pk_mov_b32 v[204:205], v[92:93], v[92:93]
    v_pk_mov_b32 v[206:207], v[92:93], v[92:93]
    v_pk_mov_b32 v[212:213], v[92:93], v[92:93]
    v_pk_mov_b32 v[214:215], v[92:93], v[92:93]
    v_pk_mov_b32 v[220:221], v[92:93], v[92:93]
    v_pk_mov_b32 v[222:223], v[92:93], v[92:93]
    v_pk_mov_b32 v[228:229], v[92:93], v[92:93]
    v_pk_mov_b32 v[230:231], v[92:93], v[92:93]
    v_pk_mov_b32 v[236:237], v[92:93], v[92:93]
    v_pk_mov_b32 v[238:239], v[92:93], v[92:93]
    v_pk_mov_b32 v[244:245], v[92:93], v[92:93]
    v_pk_mov_b32 v[246:247], v[92:93], v[92:93]
    v_pk_mov_b32 v[252:253], v[92:93], v[92:93]
    v_pk_mov_b32 v[254:255], v[92:93], v[92:93]
    v_mov_b32 v80, 0
    v_mov_b32 v81, 0
    v_mov_b32 v82, 0
    v_mov_b32 v83, 0
    v_mov_b32 v120, 0
    v_mov_b32 v121, 0
    v_mov_b32 v122, 0
    v_mov_b32 v123, 0
    v_mov_b32 v124, 0
    v_mov_b32 v125, 0
    s_mov_b32 exec_lo, 0x00100001
    s_mov_b32 exec_hi, 0x10000100
    v_mov_b32 v122, s69
    s_lshl_b64 exec, exec, 1
    v_mov_b32 v122, s55
    s_lshl_b64 exec, exec, 1
    v_mov_b32 v123, s69
    s_lshl_b64 exec, exec, 1
    v_mov_b32 v123, s55
    s_mov_b64 exec, -1
    s_mov_b32 vcc_lo, 0x00f0000f
    s_mov_b32 vcc_hi, 0xf0000f00
    v_mov_b32 v92, s68
    v_cndmask_b32 v92, 0, v92, vcc
    v_mov_b32 v93, v92
    v_mov_b32 v94, v92
    v_mov_b32 v95, v92
    s_nop 0
    s_waitcnt vmcnt(15)
    v_mfma_f32_16x16x32_bf16 v[104:107], v[92:95], v[16:19], 0
    v_dot2_f32_bf16 v80, v16, v16, v80
    v_dot2_f32_bf16 v82, v17, v17, v82
    v_dot2_f32_bf16 v80, v18, v18, v80
    v_dot2_f32_bf16 v82, v19, v19, v82
    s_waitcnt vmcnt(14)
    v_mfma_f32_16x16x32_bf16 v[104:107], v[92:95], v[20:23], v[104:107]
    v_dot2_f32_bf16 v80, v20, v20, v80
    v_dot2_f32_bf16 v82, v21, v21, v82
    v_dot2_f32_bf16 v80, v22, v22, v80
    v_dot2_f32_bf16 v82, v23, v23, v82
    s_waitcnt vmcnt(13)
    v_mfma_f32_16x16x32_bf16 v[104:107], v[92:95], v[24:27], v[104:107]
    v_dot2_f32_bf16 v80, v24, v24, v80
    v_dot2_f32_bf16 v82, v25, v25, v82
    v_dot2_f32_bf16 v80, v26, v26, v80
    v_dot2_f32_bf16 v82, v27, v27, v82
    s_waitcnt vmcnt(12)
    v_mfma_f32_16x16x32_bf16 v[104:107], v[92:95], v[28:31], v[104:107]
    v_dot2_f32_bf16 v80, v28, v28, v80
    v_dot2_f32_bf16 v82, v29, v29, v82
    v_dot2_f32_bf16 v80, v30, v30, v80
    v_dot2_f32_bf16 v82, v31, v31, v82
    s_waitcnt vmcnt(11)
    v_mfma_f32_16x16x32_bf16 v[104:107], v[92:95], v[32:35], v[104:107]
    v_dot2_f32_bf16 v80, v32, v32, v80
    v_dot2_f32_bf16 v82, v33, v33, v82
    v_dot2_f32_bf16 v80, v34, v34, v80
    v_dot2_f32_bf16 v82, v35, v35, v82
    s_waitcnt vmcnt(10)
    v_mfma_f32_16x16x32_bf16 v[104:107], v[92:95], v[36:39], v[104:107]
    v_dot2_f32_bf16 v80, v36, v36, v80
    v_dot2_f32_bf16 v82, v37, v37, v82
    v_dot2_f32_bf16 v80, v38, v38, v80
    v_dot2_f32_bf16 v82, v39, v39, v82
    s_waitcnt vmcnt(9)
    v_mfma_f32_16x16x32_bf16 v[104:107], v[92:95], v[40:43], v[104:107]
    v_dot2_f32_bf16 v80, v40, v40, v80
    v_dot2_f32_bf16 v82, v41, v41, v82
    v_dot2_f32_bf16 v80, v42, v42, v80
    v_dot2_f32_bf16 v82, v43, v43, v82
    s_waitcnt vmcnt(8)
    v_mfma_f32_16x16x32_bf16 v[104:107], v[92:95], v[44:47], v[104:107]
    v_dot2_f32_bf16 v80, v44, v44, v80
    v_dot2_f32_bf16 v82, v45, v45, v82
    v_dot2_f32_bf16 v80, v46, v46, v80
    v_dot2_f32_bf16 v82, v47, v47, v82
    s_nop 2
    v_add_f32 v82, v82, v80
    v_mov_b32 v80, v104
    s_nop 2
    v_add_f32_dpp v80, v80, v80 quad_perm:[1,0,3,2] row_mask:0xf bank_mask:0xf
    v_add_f32_dpp v82, v82, v82 quad_perm:[1,0,3,2] row_mask:0xf bank_mask:0xf
    s_nop 0
    v_add_f32_dpp v80, v80, v80 quad_perm:[2,3,0,1] row_mask:0xf bank_mask:0xf
    v_add_f32_dpp v82, v82, v82 quad_perm:[2,3,0,1] row_mask:0xf bank_mask:0xf
    s_nop 0
    v_add_f32_dpp v80, v80, v80 row_half_mirror row_mask:0xf bank_mask:0xf
    v_add_f32_dpp v82, v82, v82 row_half_mirror row_mask:0xf bank_mask:0xf
    s_nop 0
    v_mul_f32 v80, 0x3b000000, v80
    v_mul_f32 v82, 0x3b000000, v82
    v_fma_f32 v82, -v80, v80, v82
    v_max_f32 v82, 0, v82
    v_cvt_pk_bf16_f32 v84, v80, v82
    v_lshlrev_b32 v80, 16, v84
    v_mul_f32 v80, s55, v80
    v_sub_f32 v88, 0, v80
    v_sub_f32 v89, 0, v80
    v_sub_f32 v90, 0, v80
    v_sub_f32 v91, 0, v80
    v_and_b32 v84, 0xffff0000, v84
    s_nop 0
    v_mfma_f32_16x16x32_bf16 v[96:99], v[122:125], v[16:19], v[88:91]
    v_mfma_f32_16x16x32_bf16 v[100:103], v[120:123], v[16:19], v[88:91]
    s_nop 4
    v_mfma_f32_16x16x32_bf16 v[104:107], v[122:125], v[20:23], v[88:91]
    v_mfma_f32_16x16x32_bf16 v[108:111], v[120:123], v[20:23], v[88:91]
    v_add_f32 v84, 0x3727c5ac, v84
    v_cvt_pk_bf16_f32 v16, v96, v97
    v_cvt_pk_bf16_f32 v17, v98, v99
    v_cvt_pk_bf16_f32 v18, v100, v101
    v_cvt_pk_bf16_f32 v19, v102, v103
    ds_write_b128 v8, v[16:19] offset:0
    v_mfma_f32_16x16x32_bf16 v[96:99], v[122:125], v[24:27], v[88:91]
    v_mfma_f32_16x16x32_bf16 v[100:103], v[120:123], v[24:27], v[88:91]
    v_cvt_pk_bf16_f32 v84, v84, v84
    v_cvt_pk_bf16_f32 v20, v104, v105
    v_cvt_pk_bf16_f32 v21, v106, v107
    v_cvt_pk_bf16_f32 v22, v108, v109
    v_cvt_pk_bf16_f32 v23, v110, v111
    ds_write_b128 v8, v[20:23] offset:128
    v_mfma_f32_16x16x32_bf16 v[104:107], v[122:125], v[28:31], v[88:91]
    v_mfma_f32_16x16x32_bf16 v[108:111], v[120:123], v[28:31], v[88:91]
    v_and_b32 v84, 0xffff0000, v84
    v_cvt_pk_bf16_f32 v24, v96, v97
    v_cvt_pk_bf16_f32 v25, v98, v99
    v_cvt_pk_bf16_f32 v26, v100, v101
    v_cvt_pk_bf16_f32 v27, v102, v103
    ds_write_b128 v8, v[24:27] offset:256
    v_mfma_f32_16x16x32_bf16 v[96:99], v[122:125], v[32:35], v[88:91]
    v_mfma_f32_16x16x32_bf16 v[100:103], v[120:123], v[32:35], v[88:91]
    v_sqrt_f32 v84, v84
    v_cvt_pk_bf16_f32 v28, v104, v105
    v_cvt_pk_bf16_f32 v29, v106, v107
    v_cvt_pk_bf16_f32 v30, v108, v109
    v_cvt_pk_bf16_f32 v31, v110, v111
    ds_write_b128 v8, v[28:31] offset:384
    v_mfma_f32_16x16x32_bf16 v[104:107], v[122:125], v[36:39], v[88:91]
    v_mfma_f32_16x16x32_bf16 v[108:111], v[120:123], v[36:39], v[88:91]
    v_cvt_pk_bf16_f32 v84, v84, v84
    v_cvt_pk_bf16_f32 v32, v96, v97
    v_cvt_pk_bf16_f32 v33, v98, v99
    v_cvt_pk_bf16_f32 v34, v100, v101
    v_cvt_pk_bf16_f32 v35, v102, v103
    ds_write_b128 v8, v[32:35] offset:512
    v_mfma_f32_16x16x32_bf16 v[96:99], v[122:125], v[40:43], v[88:91]
    v_mfma_f32_16x16x32_bf16 v[100:103], v[120:123], v[40:43], v[88:91]
    v_and_b32 v84, 0xffff0000, v84
    v_cvt_pk_bf16_f32 v36, v104, v105
    v_cvt_pk_bf16_f32 v37, v106, v107
    v_cvt_pk_bf16_f32 v38, v108, v109
    v_cvt_pk_bf16_f32 v39, v110, v111
    ds_write_b128 v8, v[36:39] offset:640
    v_mfma_f32_16x16x32_bf16 v[104:107], v[122:125], v[44:47], v[88:91]
    v_mfma_f32_16x16x32_bf16 v[108:111], v[120:123], v[44:47], v[88:91]
    v_mul_f32 v84, s55, v84
    v_cvt_pk_bf16_f32 v40, v96, v97
    v_cvt_pk_bf16_f32 v41, v98, v99
    v_cvt_pk_bf16_f32 v42, v100, v101
    v_cvt_pk_bf16_f32 v43, v102, v103
    ds_write_b128 v8, v[40:43] offset:768
    s_nop 1
    v_rcp_f32 v84, v84
    v_cvt_pk_bf16_f32 v44, v104, v105
    v_cvt_pk_bf16_f32 v45, v106, v107
    v_cvt_pk_bf16_f32 v46, v108, v109
    v_cvt_pk_bf16_f32 v47, v110, v111
    ds_write_b128 v8, v[44:47] offset:896
    ds_write_b32 v9, v84 offset:256
    s_waitcnt vmcnt(7)
    v_mfma_f32_16x16x32_bf16 v[104:107], v[92:95], v[48:51], 0
    v_dot2_f32_bf16 v81, v48, v48, v81
    v_dot2_f32_bf16 v83, v49, v49, v83
    v_dot2_f32_bf16 v81, v50, v50, v81
    v_dot2_f32_bf16 v83, v51, v51, v83
    s_waitcnt vmcnt(6)
    v_mfma_f32_16x16x32_bf16 v[104:107], v[92:95], v[52:55], v[104:107]
    v_dot2_f32_bf16 v81, v52, v52, v81
    v_dot2_f32_bf16 v83, v53, v53, v83
    v_dot2_f32_bf16 v81, v54, v54, v81
    v_dot2_f32_bf16 v83, v55, v55, v83
    s_waitcnt vmcnt(5)
    v_mfma_f32_16x16x32_bf16 v[104:107], v[92:95], v[56:59], v[104:107]
    v_dot2_f32_bf16 v81, v56, v56, v81
    v_dot2_f32_bf16 v83, v57, v57, v83
    v_dot2_f32_bf16 v81, v58, v58, v81
    v_dot2_f32_bf16 v83, v59, v59, v83
    s_waitcnt vmcnt(4)
    v_mfma_f32_16x16x32_bf16 v[104:107], v[92:95], v[60:63], v[104:107]
    v_dot2_f32_bf16 v81, v60, v60, v81
    v_dot2_f32_bf16 v83, v61, v61, v83
    v_dot2_f32_bf16 v81, v62, v62, v81
    v_dot2_f32_bf16 v83, v63, v63, v83
    s_waitcnt vmcnt(3)
    v_mfma_f32_16x16x32_bf16 v[104:107], v[92:95], v[64:67], v[104:107]
    v_dot2_f32_bf16 v81, v64, v64, v81
    v_dot2_f32_bf16 v83, v65, v65, v83
    v_dot2_f32_bf16 v81, v66, v66, v81
    v_dot2_f32_bf16 v83, v67, v67, v83
    s_waitcnt vmcnt(2)
    v_mfma_f32_16x16x32_bf16 v[104:107], v[92:95], v[68:71], v[104:107]
    v_dot2_f32_bf16 v81, v68, v68, v81
    v_dot2_f32_bf16 v83, v69, v69, v83
    v_dot2_f32_bf16 v81, v70, v70, v81
    v_dot2_f32_bf16 v83, v71, v71, v83
    s_waitcnt vmcnt(1)
    v_mfma_f32_16x16x32_bf16 v[104:107], v[92:95], v[72:75], v[104:107]
    v_dot2_f32_bf16 v81, v72, v72, v81
    v_dot2_f32_bf16 v83, v73, v73, v83
    v_dot2_f32_bf16 v81, v74, v74, v81
    v_dot2_f32_bf16 v83, v75, v75, v83
    s_waitcnt vmcnt(0)
    v_mfma_f32_16x16x32_bf16 v[104:107], v[92:95], v[76:79], v[104:107]
    v_dot2_f32_bf16 v81, v76, v76, v81
    v_dot2_f32_bf16 v83, v77, v77, v83
    v_dot2_f32_bf16 v81, v78, v78, v81
    v_dot2_f32_bf16 v83, v79, v79, v83
    s_nop 2
    v_add_f32 v83, v83, v81
    v_mov_b32 v81, v104
    s_nop 2
    v_add_f32_dpp v81, v81, v81 quad_perm:[1,0,3,2] row_mask:0xf bank_mask:0xf
    v_add_f32_dpp v83, v83, v83 quad_perm:[1,0,3,2] row_mask:0xf bank_mask:0xf
    s_nop 0
    v_add_f32_dpp v81, v81, v81 quad_perm:[2,3,0,1] row_mask:0xf bank_mask:0xf
    v_add_f32_dpp v83, v83, v83 quad_perm:[2,3,0,1] row_mask:0xf bank_mask:0xf
    s_nop 0
    v_add_f32_dpp v81, v81, v81 row_half_mirror row_mask:0xf bank_mask:0xf
    v_add_f32_dpp v83, v83, v83 row_half_mirror row_mask:0xf bank_mask:0xf
    s_nop 0
    v_mul_f32 v81, 0x3b000000, v81
    v_mul_f32 v83, 0x3b000000, v83
    v_fma_f32 v83, -v81, v81, v83
    v_max_f32 v83, 0, v83
    v_cvt_pk_bf16_f32 v85, v81, v83
    v_lshlrev_b32 v81, 16, v85
    v_mul_f32 v81, s55, v81
    v_sub_f32 v88, 0, v81
    v_sub_f32 v89, 0, v81
    v_sub_f32 v90, 0, v81
    v_sub_f32 v91, 0, v81
    v_and_b32 v85, 0xffff0000, v85
    s_waitcnt lgkmcnt(7)
    v_mfma_f32_16x16x32_bf16 v[96:99], v[122:125], v[48:51], v[88:91]
    v_mfma_f32_16x16x32_bf16 v[100:103], v[120:123], v[48:51], v[88:91]
    v_mfma_f32_16x16x32_bf16 v[104:107], v[122:125], v[52:55], v[88:91]
    v_mfma_f32_16x16x32_bf16 v[108:111], v[120:123], v[52:55], v[88:91]
    s_nop 2
    v_mfma_f32_16x16x32_bf16 v[16:19], v[122:125], v[56:59], v[88:91]
    v_mfma_f32_16x16x32_bf16 v[20:23], v[120:123], v[56:59], v[88:91]
    v_add_f32 v85, 0x3727c5ac, v85
    v_cvt_pk_bf16_f32 v48, v96, v97
    v_cvt_pk_bf16_f32 v49, v98, v99
    v_cvt_pk_bf16_f32 v50, v100, v101
    v_cvt_pk_bf16_f32 v51, v102, v103
    ds_write_b128 v8, v[48:51] offset:8320
    v_mfma_f32_16x16x32_bf16 v[96:99], v[122:125], v[60:63], v[88:91]
    v_mfma_f32_16x16x32_bf16 v[100:103], v[120:123], v[60:63], v[88:91]
    v_cvt_pk_bf16_f32 v85, v85, v85
    v_cvt_pk_bf16_f32 v52, v104, v105
    v_cvt_pk_bf16_f32 v53, v106, v107
    v_cvt_pk_bf16_f32 v54, v108, v109
    v_cvt_pk_bf16_f32 v55, v110, v111
    ds_write_b128 v8, v[52:55] offset:8448
    v_mfma_f32_16x16x32_bf16 v[104:107], v[122:125], v[64:67], v[88:91]
    v_mfma_f32_16x16x32_bf16 v[108:111], v[120:123], v[64:67], v[88:91]
    v_and_b32 v85, 0xffff0000, v85
    v_cvt_pk_bf16_f32 v56, v16, v17
    v_cvt_pk_bf16_f32 v57, v18, v19
    v_cvt_pk_bf16_f32 v58, v20, v21
    v_cvt_pk_bf16_f32 v59, v22, v23
    ds_write_b128 v8, v[56:59] offset:8576
    v_mfma_f32_16x16x32_bf16 v[16:19], v[122:125], v[68:71], v[88:91]
    v_mfma_f32_16x16x32_bf16 v[20:23], v[120:123], v[68:71], v[88:91]
    v_sqrt_f32 v85, v85
    v_cvt_pk_bf16_f32 v60, v96, v97
    v_cvt_pk_bf16_f32 v61, v98, v99
    v_cvt_pk_bf16_f32 v62, v100, v101
    v_cvt_pk_bf16_f32 v63, v102, v103
    ds_write_b128 v8, v[60:63] offset:8704
    v_mfma_f32_16x16x32_bf16 v[96:99], v[122:125], v[72:75], v[88:91]
    v_mfma_f32_16x16x32_bf16 v[100:103], v[120:123], v[72:75], v[88:91]
    v_cvt_pk_bf16_f32 v85, v85, v85
    v_cvt_pk_bf16_f32 v64, v104, v105
    v_cvt_pk_bf16_f32 v65, v106, v107
    v_cvt_pk_bf16_f32 v66, v108, v109
    v_cvt_pk_bf16_f32 v67, v110, v111
    ds_write_b128 v8, v[64:67] offset:8832
    v_mfma_f32_16x16x32_bf16 v[104:107], v[122:125], v[76:79], v[88:91]
    v_mfma_f32_16x16x32_bf16 v[108:111], v[120:123], v[76:79], v[88:91]
    v_and_b32 v85, 0xffff0000, v85
    v_cvt_pk_bf16_f32 v68, v16, v17
    v_cvt_pk_bf16_f32 v69, v18, v19
    v_cvt_pk_bf16_f32 v70, v20, v21
    v_cvt_pk_bf16_f32 v71, v22, v23
    ds_write_b128 v8, v[68:71] offset:8960
    s_nop 1
    v_mul_f32 v85, s55, v85
    v_cvt_pk_bf16_f32 v72, v96, v97
    v_cvt_pk_bf16_f32 v73, v98, v99
    v_cvt_pk_bf16_f32 v74, v100, v101
    v_cvt_pk_bf16_f32 v75, v102, v103
    ds_write_b128 v8, v[72:75] offset:9088
    s_nop 1
    v_rcp_f32 v85, v85
    v_cvt_pk_bf16_f32 v76, v104, v105
    v_cvt_pk_bf16_f32 v77, v106, v107
    v_cvt_pk_bf16_f32 v78, v108, v109
    v_cvt_pk_bf16_f32 v79, v110, v111
    ds_write_b128 v8, v[76:79] offset:9216
    ds_write_b32 v9, v85 offset:288
    s_mov_b64 exec, 1
    ds_add_u32 v112, v119 offset:0
    s_mov_b64 exec, -1
    s_mov_b32 s54, 32768
A_ln_top:
    ds_read2_b32 v[96:97], v112 offset0:0 offset1:1
    s_waitcnt lgkmcnt(0)
    v_add_u32 v96, v96, v97
    s_nop 0
    v_readfirstlane_b32 s6, v96
    s_cmp_ge_u32 s6, 7
    s_cbranch_scc1 A_ln_ok
    s_sleep 0
    s_sub_u32 s54, s54, 1
    s_cmp_lg_u32 s54, 0
    s_cbranch_scc1 A_ln_top
A_ln_ok:
    ds_read_b32 v104, v12 offset:256
    v_add_u32 v113, 4294963200, v113
    ds_read_b64_tr_b16 v[16:17], v10 offset:0
    ds_read_b64_tr_b16 v[18:19], v10 offset:512
    ds_read_b128 v[40:43], v11 offset:0
    ds_read_b64_tr_b16 v[20:21], v10 offset:2048
    ds_read_b64_tr_b16 v[22:23], v10 offset:2560
    ds_read_b128 v[44:47], v11 offset:32
    ds_read_b64_tr_b16 v[24:25], v10 offset:4096
    ds_read_b64_tr_b16 v[26:27], v10 offset:4608
    ds_read_b128 v[48:51], v11 offset:64
    ds_read_b64_tr_b16 v[28:29], v10 offset:6144
    ds_read_b64_tr_b16 v[30:31], v10 offset:6656
    ds_read_b128 v[52:55], v11 offset:96
    ds_read_b64_tr_b16 v[32:33], v10 offset:8192
    ds_read_b64_tr_b16 v[34:35], v10 offset:8704
    ds_read_b128 v[56:59], v11 offset:128
    ds_read_b64_tr_b16 v[36:37], v10 offset:10240
    ds_read_b64_tr_b16 v[38:39], v10 offset:10752
    ds_read_b128 v[60:63], v11 offset:160
    s_waitcnt lgkmcnt(15)
    v_mfma_f32_32x32x16_bf16 v[64:79], v[16:19], v[40:43], 0
    ds_read_b64_tr_b16 v[16:17], v10 offset:12288
    ds_read_b64_tr_b16 v[18:19], v10 offset:12800
    ds_read_b128 v[40:43], v11 offset:192
    s_waitcnt lgkmcnt(15)
    v_mfma_f32_32x32x16_bf16 v[64:79], v[20:23], v[44:47], v[64:79]
    ds_read_b64_tr_b16 v[20:21], v10 offset:14336
    ds_read_b64_tr_b16 v[22:23], v10 offset:14848
    ds_read_b128 v[44:47], v11 offset:224
    s_waitcnt lgkmcnt(15)
    v_mfma_f32_32x32x16_bf16 v[64:79], v[24:27], v[48:51], v[64:79]
    ds_read_b64_tr_b16 v[24:25], v10 offset:16384
    ds_read_b64_tr_b16 v[26:27], v10 offset:16896
    ds_read_b128 v[48:51], v11 offset:256
    s_waitcnt lgkmcnt(15)
    v_mfma_f32_32x32x16_bf16 v[64:79], v[28:31], v[52:55], v[64:79]
    ds_read_b64_tr_b16 v[28:29], v10 offset:18432
    ds_read_b64_tr_b16 v[30:31], v10 offset:18944
    ds_read_b128 v[52:55], v11 offset:288
    s_waitcnt lgkmcnt(15)
    v_mfma_f32_32x32x16_bf16 v[64:79], v[32:35], v[56:59], v[64:79]
    ds_read_b64_tr_b16 v[32:33], v10 offset:20480
    ds_read_b64_tr_b16 v[34:35], v10 offset:20992
    ds_read_b128 v[56:59], v11 offset:320
    s_waitcnt lgkmcnt(15)
    v_mfma_f32_32x32x16_bf16 v[64:79], v[36:39], v[60:63], v[64:79]
    ds_read_b64_tr_b16 v[36:37], v10 offset:22528
    ds_read_b64_tr_b16 v[38:39], v10 offset:23040
    ds_read_b128 v[60:63], v11 offset:352
    s_waitcnt lgkmcnt(15)
    v_mfma_f32_32x32x16_bf16 v[64:79], v[16:19], v[40:43], v[64:79]
    ds_read_b64_tr_b16 v[16:17], v10 offset:24576
    ds_read_b64_tr_b16 v[18:19], v10 offset:25088
    ds_read_b128 v[40:43], v11 offset:384
    s_waitcnt lgkmcnt(15)
    v_mfma_f32_32x32x16_bf16 v[64:79], v[20:23], v[44:47], v[64:79]
    ds_read_b64_tr_b16 v[20:21], v10 offset:26624
    ds_read_b64_tr_b16 v[22:23], v10 offset:27136
    ds_read_b128 v[44:47], v11 offset:416
    s_waitcnt lgkmcnt(15)
    v_mfma_f32_32x32x16_bf16 v[64:79], v[24:27], v[48:51], v[64:79]
    ds_read_b64_tr_b16 v[24:25], v10 offset:28672
    ds_read_b64_tr_b16 v[26:27], v10 offset:29184
    ds_read_b128 v[48:51], v11 offset:448
    s_waitcnt lgkmcnt(15)
    v_mfma_f32_32x32x16_bf16 v[64:79], v[28:31], v[52:55], v[64:79]
    ds_read_b64_tr_b16 v[28:29], v10 offset:30720
    ds_read_b64_tr_b16 v[30:31], v10 offset:31232
    ds_read_b128 v[52:55], v11 offset:480
    s_waitcnt lgkmcnt(15)
    v_mfma_f32_32x32x16_bf16 v[64:79], v[32:35], v[56:59], v[64:79]
    ds_read_b64_tr_b16 v[32:33], v10 offset:32768
    ds_read_b64_tr_b16 v[34:35], v10 offset:33280
    ds_read_b128 v[56:59], v11 offset:512
    s_waitcnt lgkmcnt(15)
    v_mfma_f32_32x32x16_bf16 v[64:79], v[36:39], v[60:63], v[64:79]
    ds_read_b64_tr_b16 v[36:37], v10 offset:34816
    ds_read_b64_tr_b16 v[38:39], v10 offset:35328
    ds_read_b128 v[60:63], v11 offset:544
    s_waitcnt lgkmcnt(15)
    v_mfma_f32_32x32x16_bf16 v[64:79], v[16:19], v[40:43], v[64:79]
    ds_read_b64_tr_b16 v[16:17], v10 offset:36864
    ds_read_b64_tr_b16 v[18:19], v10 offset:37376
    ds_read_b128 v[40:43], v11 offset:576
    s_waitcnt lgkmcnt(15)
    v_mfma_f32_32x32x16_bf16 v[64:79], v[20:23], v[44:47], v[64:79]
    ds_read_b64_tr_b16 v[20:21], v10 offset:38912
    ds_read_b64_tr_b16 v[22:23], v10 offset:39424
    ds_read_b128 v[44:47], v11 offset:608
    s_waitcnt lgkmcnt(15)
    v_mfma_f32_32x32x16_bf16 v[64:79], v[24:27], v[48:51], v[64:79]
    ds_read_b64_tr_b16 v[24:25], v10 offset:40960
    ds_read_b64_tr_b16 v[26:27], v10 offset:41472
    ds_read_b128 v[48:51], v11 offset:640
    s_waitcnt lgkmcnt(15)
    v_mfma_f32_32x32x16_bf16 v[64:79], v[28:31], v[52:55], v[64:79]
    ds_read_b64_tr_b16 v[28:29], v10 offset:43008
    ds_read_b64_tr_b16 v[30:31], v10 offset:43520
    ds_read_b128 v[52:55], v11 offset:672
    s_waitcnt lgkmcnt(15)
    v_mfma_f32_32x32x16_bf16 v[64:79], v[32:35], v[56:59], v[64:79]
    ds_read_b64_tr_b16 v[32:33], v10 offset:45056
    ds_read_b64_tr_b16 v[34:35], v10 offset:45568
    ds_read_b128 v[56:59], v11 offset:704
    s_waitcnt lgkmcnt(15)
    v_mfma_f32_32x32x16_bf16 v[64:79], v[36:39], v[60:63], v[64:79]
    ds_read_b64_tr_b16 v[36:37], v10 offset:47104
    ds_read_b64_tr_b16 v[38:39], v10 offset:47616
    ds_read_b128 v[60:63], v11 offset:736
    s_waitcnt lgkmcnt(15)
    v_mfma_f32_32x32x16_bf16 v[64:79], v[16:19], v[40:43], v[64:79]
    ds_read_b64_tr_b16 v[16:17], v10 offset:49152
    ds_read_b64_tr_b16 v[18:19], v10 offset:49664
    ds_read_b128 v[40:43], v11 offset:768
    s_waitcnt lgkmcnt(15)
    v_mfma_f32_32x32x16_bf16 v[64:79], v[20:23], v[44:47], v[64:79]
    ds_read_b64_tr_b16 v[20:21], v10 offset:51200
    ds_read_b64_tr_b16 v[22:23], v10 offset:51712
    ds_read_b128 v[44:47], v11 offset:800
    s_waitcnt lgkmcnt(15)
    v_mfma_f32_32x32x16_bf16 v[64:79], v[24:27], v[48:51], v[64:79]
    ds_read_b64_tr_b16 v[24:25], v10 offset:53248
    ds_read_b64_tr_b16 v[26:27], v10 offset:53760
    ds_read_b128 v[48:51], v11 offset:832
    s_waitcnt lgkmcnt(15)
    v_mfma_f32_32x32x16_bf16 v[64:79], v[28:31], v[52:55], v[64:79]
    ds_read_b64_tr_b16 v[28:29], v10 offset:55296
    ds_read_b64_tr_b16 v[30:31], v10 offset:55808
    ds_read_b128 v[52:55], v11 offset:864
    s_waitcnt lgkmcnt(15)
    v_mfma_f32_32x32x16_bf16 v[64:79], v[32:35], v[56:59], v[64:79]
    ds_read_b64_tr_b16 v[32:33], v10 offset:57344
    ds_read_b64_tr_b16 v[34:35], v10 offset:57856
    ds_read_b128 v[56:59], v11 offset:896
    s_waitcnt lgkmcnt(15)
    v_mfma_f32_32x32x16_bf16 v[64:79], v[36:39], v[60:63], v[64:79]
    ds_read_b64_tr_b16 v[36:37], v10 offset:59392
    ds_read_b64_tr_b16 v[38:39], v10 offset:59904
    ds_read_b128 v[60:63], v11 offset:928
    s_waitcnt lgkmcnt(15)
    v_mfma_f32_32x32x16_bf16 v[64:79], v[16:19], v[40:43], v[64:79]
    ds_read_b64_tr_b16 v[16:17], v10 offset:61440
    ds_read_b64_tr_b16 v[18:19], v10 offset:61952
    ds_read_b128 v[40:43], v11 offset:960
    s_waitcnt lgkmcnt(15)
    v_mfma_f32_32x32x16_bf16 v[64:79], v[20:23], v[44:47], v[64:79]
    ds_read_b64_tr_b16 v[20:21], v10 offset:63488
    ds_read_b64_tr_b16 v[22:23], v10 offset:64000
    ds_read_b128 v[44:47], v11 offset:992
    s_waitcnt lgkmcnt(15)
    v_mfma_f32_32x32x16_bf16 v[64:79], v[24:27], v[48:51], v[64:79]
    s_waitcnt lgkmcnt(12)
    v_mfma_f32_32x32x16_bf16 v[64:79], v[28:31], v[52:55], v[64:79]
    s_waitcnt lgkmcnt(9)
    v_mfma_f32_32x32x16_bf16 v[64:79], v[32:35], v[56:59], v[64:79]
    s_waitcnt lgkmcnt(6)
    v_mfma_f32_32x32x16_bf16 v[64:79], v[36:39], v[60:63], v[64:79]
    ds_read2_b32 v[106:107], v112 offset0:2 offset1:6
    ds_read_b128 v[8:11], v113 offset:0
    s_waitcnt lgkmcnt(5)
    v_mfma_f32_32x32x16_bf16 v[64:79], v[16:19], v[40:43], v[64:79]
    s_waitcnt lgkmcnt(2)
    v_mfma_f32_32x32x16_bf16 v[64:79], v[20:23], v[44:47], v[64:79]
    s_setprio 3
    v_mul_f32 v104, 0x3eb8aa3b, v104
    s_waitcnt lgkmcnt(1)
    v_readfirstlane_b32 s67, v106
    v_readfirstlane_b32 s7, v107
    s_cmp_eq_u32 s67, 0
    s_cbranch_scc1 A_nol
    buffer_load_dwordx4 v[12:15], v2, s[44:47], s58 offen offset:0 sc1
    buffer_load_dwordx4 v[80:83], v2, s[44:47], s58 offen offset:1024 sc1
    buffer_load_dwordx4 v[128:131], v7, s[44:47], s62 offen offset:0 sc1
    buffer_load_dwordx4 v[84:87], v2, s[44:47], s58 offen offset:2048 sc1
    buffer_load_dwordx4 v[136:139], v7, s[44:47], s62 offen offset:1024 sc1
A_nol:
    s_nop 7
    v_pk_mul_f32 v[64:65], v[64:65], v[104:105] op_sel_hi:[1,0]
    v_pk_mul_f32 v[66:67], v[66:67], v[104:105] op_sel_hi:[1,0]
    v_pk_mul_f32 v[68:69], v[68:69], v[104:105] op_sel_hi:[1,0]
    v_pk_mul_f32 v[70:71], v[70:71], v[104:105] op_sel_hi:[1,0]
    v_cvt_pk_bf16_f32 v120, v64, v65
    v_cvt_pk_bf16_f32 v121, v66, v67
    v_cvt_pk_bf16_f32 v122, v68, v69
    v_cvt_pk_bf16_f32 v123, v70, v71
    ds_write_b128 v115, v[120:123] offset:0
    v_pk_mul_f32 v[72:73], v[72:73], v[104:105] op_sel_hi:[1,0]
    v_pk_mul_f32 v[74:75], v[74:75], v[104:105] op_sel_hi:[1,0]
    v_pk_mul_f32 v[76:77], v[76:77], v[104:105] op_sel_hi:[1,0]
    v_pk_mul_f32 v[78:79], v[78:79], v[104:105] op_sel_hi:[1,0]
    v_cvt_pk_bf16_f32 v124, v72, v73
    v_cvt_pk_bf16_f32 v125, v74, v75
    v_cvt_pk_bf16_f32 v126, v76, v77
    v_cvt_pk_bf16_f32 v127, v78, v79
    ds_write_b128 v115, v[124:127] offset:2048
    s_cmp_lg_u32 s7, 0
    s_waitcnt lgkmcnt(2)
    s_cbranch_scc1 A_ks_ok
    s_mov_b32 s54, 32768
A_ks_top:
    ds_read_b32 v106, v112 offset:24
    ds_read_b128 v[8:11], v113 offset:0
    s_waitcnt lgkmcnt(0)
    v_readfirstlane_b32 s7, v106
    s_cmp_lg_u32 s7, 0
    s_cbranch_scc1 A_ks_ok
    s_sleep 0
    s_sub_u32 s54, s54, 1
    s_cmp_lg_u32 s54, 0
    s_cbranch_scc1 A_ks_top
A_ks_ok:
    ds_read_b32 v107, v112 offset:8
    v_mfma_f32_32x32x16_bf16 v[16:31], v[8:11], v[120:123], 0
    v_mfma_f32_32x32x16_bf16 v[48:63], v[8:11], v[124:127], 0
    v_mfma_f32_32x32x8_bf16 v[64:79], v[0:1], v[4:5], 0
    s_waitcnt lgkmcnt(0)
    v_readfirstlane_b32 s7, v107
    s_andn2_b32 s7, s7, s67
    s_cbranch_scc0 A_no2
    buffer_load_dwordx4 v[12:15], v2, s[44:47], s58 offen offset:0 sc1
    buffer_load_dwordx4 v[80:83], v2, s[44:47], s58 offen offset:1024 sc1
    buffer_load_dwordx4 v[128:131], v7, s[44:47], s62 offen offset:0 sc1
    buffer_load_dwordx4 v[84:87], v2, s[44:47], s58 offen offset:2048 sc1
    buffer_load_dwordx4 v[136:139], v7, s[44:47], s62 offen offset:1024 sc1
    s_mov_b32 s67, 1
A_no2:
    s_nop 6
    v_max3_f32 v16, v16, v17, v18
    v_max3_f32 v24, v24, v25, v26
    v_max3_f32 v48, v48, v49, v50
    v_max3_f32 v56, v56, v57, v58
    v_max3_f32 v16, v16, v19, v20
    v_max3_f32 v24, v24, v27, v28
    v_max3_f32 v48, v48, v51, v52
    v_max3_f32 v56, v56, v59, v60
    v_max3_f32 v16, v16, v21, v22
    v_max3_f32 v24, v24, v29, v30
    v_max3_f32 v48, v48, v53, v54
    v_max3_f32 v56, v56, v61, v62
    v_max3_f32 v16, v16, v23, v31
    v_max3_f32 v48, v48, v55, v63
    v_max_f32 v16, v16, v24
    v_max_f32 v48, v48, v56
    v_mov_b32 v17, v16
    v_mov_b32 v49, v48
    s_nop 0
    v_permlane32_swap_b32 v16, v17
    v_permlane32_swap_b32 v48, v49
    s_nop 0
    v_max_f32 v16, v16, v17
    v_max_f32 v48, v48, v49
    v_sub_f32 v16, 0xc2c00000, v16
    v_sub_f32 v48, 0xc2c00000, v48
    v_mov_b32 v17, v16
    v_mov_b32 v49, v48
    v_mov_b32 v18, v16
    v_mov_b32 v50, v48
    v_mov_b32 v19, v16
    v_mov_b32 v51, v48
    ds_write_b128 v116, v[16:19]
    ds_write_b128 v116, v[48:51] offset:1024
    s_mov_b64 exec, 1
    ds_add_u32 v112, v119 offset:12
    s_mov_b64 exec, -1
    s_cmp_lg_u32 s67, 0
    s_cbranch_scc1 A_kvb
    s_mov_b32 s54, 32768
A_kw_top:
    ds_read_b32 v16, v112 offset:8
    s_waitcnt lgkmcnt(0)
    v_readfirstlane_b32 s6, v16
    s_cmp_ge_u32 s6, 1
    s_cbranch_scc1 A_kw_ok
    s_sleep 0
    s_sub_u32 s54, s54, 1
    s_cmp_lg_u32 s54, 0
    s_cbranch_scc1 A_kw_top
A_kw_ok:
    buffer_load_dwordx4 v[12:15], v2, s[44:47], s58 offen offset:0 sc1
    buffer_load_dwordx4 v[80:83], v2, s[44:47], s58 offen offset:1024 sc1
    buffer_load_dwordx4 v[128:131], v7, s[44:47], s62 offen offset:0 sc1
    buffer_load_dwordx4 v[84:87], v2, s[44:47], s58 offen offset:2048 sc1
    buffer_load_dwordx4 v[136:139], v7, s[44:47], s62 offen offset:1024 sc1
A_kvb:
    buffer_load_dwordx4 v[88:91], v2, s[44:47], s58 offen offset:3072 sc1
    buffer_load_dwordx4 v[144:147], v7, s[44:47], s62 offen offset:2048 sc1
    buffer_load_dwordx4 v[152:155], v7, s[44:47], s62 offen offset:3072 sc1
    buffer_load_dwordx4 v[92:95], v2, s[44:47], s59 offen offset:1024 sc1
    buffer_load_dwordx4 v[160:163], v7, s[44:47], s63 offen offset:0 sc1
    buffer_load_dwordx4 v[96:99], v2, s[44:47], s59 offen offset:2048 sc1
    buffer_load_dwordx4 v[168:171], v7, s[44:47], s63 offen offset:1024 sc1
    buffer_load_dwordx4 v[100:103], v2, s[44:47], s59 offen offset:3072 sc1
    buffer_load_dwordx4 v[176:179], v7, s[44:47], s63 offen offset:2048 sc1
    s_mov_b32 s54, 32768
A_c_top:
    ds_read_b32 v16, v112 offset:12
    ds_read_b128 v[8:11], v113 offset:4096
    ds_read_b128 v[48:51], v6
    ds_read_b128 v[52:55], v6
    ds_read_b128 v[56:59], v6
    ds_read_b128 v[60:63], v6
    s_waitcnt lgkmcnt(5)
    v_readfirstlane_b32 s6, v16
    s_cmp_ge_u32 s6, 4
    s_cbranch_scc1 A_c_ok
    s_sleep 0
    s_sub_u32 s54, s54, 1
    s_cmp_lg_u32 s54, 0
    s_cbranch_scc1 A_c_top
A_c_ok:
    s_add_u32 m0, s66, 1024
    s_nop 0
    buffer_load_dwordx4 v2, s[44:47], s59 offen sc1 lds
    s_add_u32 m0, s66, 8192
    s_nop 0
    buffer_load_dwordx4 v2, s[44:47], s60 offen sc1 lds
    ds_write_b32 v114, v1
    ds_write_b32 v117, v119 offset:32
    s_waitcnt vmcnt(15) lgkmcnt(2)
    s_setprio 1
    v_mfma_f32_32x32x16_bf16 v[16:31], v[12:15], v[8:11], v[48:63]
    s_nop 11
    v_exp_f32 v16, v16
    v_exp_f32 v17, v17
    buffer_load_dwordx4 v[184:187], v7, s[44:47], s63 offen offset:3072 sc1
    v_exp_f32 v18, v18
    v_exp_f32 v19, v19
    v_exp_f32 v20, v20
    s_waitcnt vmcnt(14)
    v_mfma_f32_32x32x16_bf16 v[32:47], v[80:83], v[8:11], v[48:63]
    v_permlane16_swap_b32 v128, v132
    v_permlane16_swap_b32 v129, v133
    v_exp_f32 v21, v21
    v_permlane16_swap_b32 v130, v134
    v_permlane16_swap_b32 v131, v135
    v_exp_f32 v22, v22
    v_exp_f32 v23, v23
    v_exp_f32 v24, v24
    v_exp_f32 v25, v25
    v_smfmac_f32_32x32x32_bf16 v[64:79], v[128:131], v[16:23], v4
    v_exp_f32 v26, v26
    v_exp_f32 v27, v27
    v_exp_f32 v28, v28
    v_exp_f32 v29, v29
    v_exp_f32 v30, v30
    v_exp_f32 v31, v31
    v_exp_f32 v32, v32
    v_exp_f32 v33, v33
    v_smfmac_f32_32x32x32_bf16 v[64:79], v[132:135], v[24:31], v4
    buffer_load_dwordx4 v[104:107], v2, s[44:47], s60 offen offset:1024 sc1
    buffer_load_dwordx4 v[192:195], v7, s[44:47], s64 offen offset:0 sc1
    v_exp_f32 v34, v34
    v_exp_f32 v35, v35
    v_exp_f32 v36, v36
    s_waitcnt vmcnt(14)
    v_mfma_f32_32x32x16_bf16 v[16:31], v[84:87], v[8:11], v[48:63]
    v_permlane16_swap_b32 v136, v140
    v_permlane16_swap_b32 v137, v141
    v_exp_f32 v37, v37
    v_permlane16_swap_b32 v138, v142
    v_permlane16_swap_b32 v139, v143
    v_exp_f32 v38, v38
    v_exp_f32 v39, v39
    v_exp_f32 v40, v40
    v_exp_f32 v41, v41
    v_smfmac_f32_32x32x32_bf16 v[64:79], v[136:139], v[32:39], v4
    v_exp_f32 v42, v42
    v_exp_f32 v43, v43
    v_exp_f32 v44, v44
    v_exp_f32 v45, v45
    v_exp_f32 v46, v46
    v_exp_f32 v47, v47
    v_exp_f32 v16, v16
    v_exp_f32 v17, v17
    v_smfmac_f32_32x32x32_bf16 v[64:79], v[140:143], v[40:47], v4
    s_add_u32 m0, s66, 0
    s_nop 0
    buffer_load_dwordx4 v2, s[44:47], s58 offen sc1 lds
    buffer_load_dwordx4 v[108:111], v2, s[44:47], s60 offen offset:2048 sc1
    buffer_load_dwordx4 v[200:203], v7, s[44:47], s64 offen offset:1024 sc1
    v_exp_f32 v18, v18
    v_exp_f32 v19, v19
    v_exp_f32 v20, v20
    s_waitcnt vmcnt(7)
    v_mfma_f32_32x32x16_bf16 v[32:47], v[88:91], v[8:11], v[48:63]
    ds_read_b128 v[12:15], v2 offset:1024
    v_permlane16_swap_b32 v144, v148
    v_permlane16_swap_b32 v145, v149
    v_exp_f32 v21, v21
    v_permlane16_swap_b32 v146, v150
    v_permlane16_swap_b32 v147, v151
    v_exp_f32 v22, v22
    v_exp_f32 v23, v23
    v_exp_f32 v24, v24
    v_exp_f32 v25, v25
    v_smfmac_f32_32x32x32_bf16 v[64:79], v[144:147], v[16:23], v4
    v_exp_f32 v26, v26
    v_exp_f32 v27, v27
    v_exp_f32 v28, v28
    v_exp_f32 v29, v29
    v_exp_f32 v30, v30
    v_exp_f32 v31, v31
    v_exp_f32 v32, v32
    v_exp_f32 v33, v33
    v_smfmac_f32_32x32x32_bf16 v[64:79], v[148:151], v[24:31], v4
    s_add_u32 m0, s66, 9216
    s_nop 0
    buffer_load_dwordx4 v2, s[44:47], s61 offen sc1 lds
    buffer_load_dwordx4 v[112:115], v2, s[44:47], s60 offen offset:3072 sc1
    buffer_load_dwordx4 v[208:211], v7, s[44:47], s64 offen offset:2048 sc1
    v_exp_f32 v34, v34
    v_exp_f32 v35, v35
    v_exp_f32 v36, v36
    s_waitcnt vmcnt(17) lgkmcnt(0)
    v_mfma_f32_32x32x16_bf16 v[16:31], v[12:15], v[8:11], v[48:63]
    v_permlane16_swap_b32 v152, v156
    v_permlane16_swap_b32 v153, v157
    v_exp_f32 v37, v37
    v_permlane16_swap_b32 v154, v158
    v_permlane16_swap_b32 v155, v159
    v_exp_f32 v38, v38
    v_exp_f32 v39, v39
    v_exp_f32 v40, v40
    v_exp_f32 v41, v41
    v_smfmac_f32_32x32x32_bf16 v[64:79], v[152:155], v[32:39], v4
    v_exp_f32 v42, v42
    v_exp_f32 v43, v43
    v_exp_f32 v44, v44
    v_exp_f32 v45, v45
    v_exp_f32 v46, v46
    v_exp_f32 v47, v47
    v_exp_f32 v16, v16
    v_exp_f32 v17, v17
    v_smfmac_f32_32x32x32_bf16 v[64:79], v[156:159], v[40:47], v4
    buffer_load_dwordx4 v[216:219], v7, s[44:47], s64 offen offset:3072 sc1
    v_exp_f32 v18, v18
    v_exp_f32 v19, v19
    v_exp_f32 v20, v20
    s_waitcnt vmcnt(16)
    v_mfma_f32_32x32x16_bf16 v[32:47], v[92:95], v[8:11], v[48:63]
    v_permlane16_swap_b32 v160, v164
    v_permlane16_swap_b32 v161, v165
    v_exp_f32 v21, v21
    v_permlane16_swap_b32 v162, v166
    v_permlane16_swap_b32 v163, v167
    v_exp_f32 v22, v22
    v_exp_f32 v23, v23
    v_exp_f32 v24, v24
    v_exp_f32 v25, v25
    v_smfmac_f32_32x32x32_bf16 v[64:79], v[160:163], v[16:23], v4
    v_exp_f32 v26, v26
    v_exp_f32 v27, v27
    v_exp_f32 v28, v28
    v_exp_f32 v29, v29
    v_exp_f32 v30, v30
    v_exp_f32 v31, v31
    v_exp_f32 v32, v32
    v_exp_f32 v33, v33
    v_smfmac_f32_32x32x32_bf16 v[64:79], v[164:167], v[24:31], v4
    buffer_load_dwordx4 v[116:119], v2, s[44:47], s61 offen offset:1024 sc1
    buffer_load_dwordx4 v[224:227], v7, s[44:47], s65 offen offset:0 sc1
    v_exp_f32 v34, v34
    v_exp_f32 v35, v35
    v_exp_f32 v36, v36
    s_waitcnt vmcnt(16)
    v_mfma_f32_32x32x16_bf16 v[16:31], v[96:99], v[8:11], v[48:63]
    v_permlane16_swap_b32 v168, v172
    v_permlane16_swap_b32 v169, v173
    v_exp_f32 v37, v37
    v_permlane16_swap_b32 v170, v174
    v_permlane16_swap_b32 v171, v175
    v_exp_f32 v38, v38
    v_exp_f32 v39, v39
    v_exp_f32 v40, v40
    v_exp_f32 v41, v41
    v_smfmac_f32_32x32x32_bf16 v[64:79], v[168:171], v[32:39], v4
    v_exp_f32 v42, v42
    v_exp_f32 v43, v43
    v_exp_f32 v44, v44
    v_exp_f32 v45, v45
    v_exp_f32 v46, v46
    v_exp_f32 v47, v47
    v_exp_f32 v16, v16
    v_exp_f32 v17, v17
    v_smfmac_f32_32x32x32_bf16 v[64:79], v[172:175], v[40:47], v4
    buffer_load_dwordx4 v[120:123], v2, s[44:47], s61 offen offset:2048 sc1
    buffer_load_dwordx4 v[232:235], v7, s[44:47], s65 offen offset:1024 sc1
    v_exp_f32 v18, v18
    v_exp_f32 v19, v19
    v_exp_f32 v20, v20
    s_waitcnt vmcnt(14)
    v_mfma_f32_32x32x16_bf16 v[32:47], v[100:103], v[8:11], v[48:63]
    ds_read_b128 v[12:15], v2 offset:8192
    v_permlane16_swap_b32 v176, v180
    v_permlane16_swap_b32 v177, v181
    v_exp_f32 v21, v21
    v_permlane16_swap_b32 v178, v182
    v_permlane16_swap_b32 v179, v183
    v_exp_f32 v22, v22
    v_exp_f32 v23, v23
    v_exp_f32 v24, v24
    v_exp_f32 v25, v25
    v_smfmac_f32_32x32x32_bf16 v[64:79], v[176:179], v[16:23], v4
    v_exp_f32 v26, v26
    v_exp_f32 v27, v27
    v_exp_f32 v28, v28
    v_exp_f32 v29, v29
    v_exp_f32 v30, v30
    v_exp_f32 v31, v31
    v_exp_f32 v32, v32
    v_exp_f32 v33, v33
    v_smfmac_f32_32x32x32_bf16 v[64:79], v[180:183], v[24:31], v4
    buffer_load_dwordx4 v[124:127], v2, s[44:47], s61 offen offset:3072 sc1
    buffer_load_dwordx4 v[240:243], v7, s[44:47], s65 offen offset:2048 sc1
    v_exp_f32 v34, v34
    v_exp_f32 v35, v35
    v_exp_f32 v36, v36
    s_waitcnt vmcnt(15) lgkmcnt(0)
    v_mfma_f32_32x32x16_bf16 v[16:31], v[12:15], v[8:11], v[48:63]
    v_permlane16_swap_b32 v184, v188
    v_permlane16_swap_b32 v185, v189
    v_exp_f32 v37, v37
    v_permlane16_swap_b32 v186, v190
    v_permlane16_swap_b32 v187, v191
    v_exp_f32 v38, v38
    v_exp_f32 v39, v39
    v_exp_f32 v40, v40
    v_exp_f32 v41, v41
    v_smfmac_f32_32x32x32_bf16 v[64:79], v[184:187], v[32:39], v4
    v_exp_f32 v42, v42
    v_exp_f32 v43, v43
    v_exp_f32 v44, v44
    v_exp_f32 v45, v45
    v_exp_f32 v46, v46
    v_exp_f32 v47, v47
    v_exp_f32 v16, v16
    v_exp_f32 v17, v17
    v_smfmac_f32_32x32x32_bf16 v[64:79], v[188:191], v[40:47], v4
    buffer_load_dwordx4 v[248:251], v7, s[44:47], s65 offen offset:3072 sc1
    v_exp_f32 v18, v18
    v_exp_f32 v19, v19
    v_exp_f32 v20, v20
    s_waitcnt vmcnt(14)
    v_mfma_f32_32x32x16_bf16 v[32:47], v[104:107], v[8:11], v[48:63]
    v_permlane16_swap_b32 v192, v196
    v_permlane16_swap_b32 v193, v197
    v_exp_f32 v21, v21
    v_permlane16_swap_b32 v194, v198
    v_permlane16_swap_b32 v195, v199
    v_exp_f32 v22, v22
    v_exp_f32 v23, v23
    v_exp_f32 v24, v24
    v_exp_f32 v25, v25
    v_smfmac_f32_32x32x32_bf16 v[64:79], v[192:195], v[16:23], v4
    v_exp_f32 v26, v26
    v_exp_f32 v27, v27
    v_exp_f32 v28, v28
    v_exp_f32 v29, v29
    v_exp_f32 v30, v30
    v_exp_f32 v31, v31
    v_exp_f32 v32, v32
    v_exp_f32 v33, v33
    v_smfmac_f32_32x32x32_bf16 v[64:79], v[196:199], v[24:31], v4
    s_sub_u32 s6, 148480, s66
    v_add_u32 v7, s6, v2
    s_lshl_b32 s6, s3, 8
    s_add_u32 m0, s6, 33792
    v_exp_f32 v34, v34
    v_exp_f32 v35, v35
    v_exp_f32 v36, v36
    s_waitcnt vmcnt(11)
    v_mfma_f32_32x32x16_bf16 v[16:31], v[108:111], v[8:11], v[48:63]
    v_permlane16_swap_b32 v200, v204
    v_permlane16_swap_b32 v201, v205
    v_exp_f32 v37, v37
    v_permlane16_swap_b32 v202, v206
    v_permlane16_swap_b32 v203, v207
    v_exp_f32 v38, v38
    v_exp_f32 v39, v39
    v_exp_f32 v40, v40
    v_exp_f32 v41, v41
    v_smfmac_f32_32x32x32_bf16 v[64:79], v[200:203], v[32:39], v4
    v_exp_f32 v42, v42
    v_exp_f32 v43, v43
    v_exp_f32 v44, v44
    v_exp_f32 v45, v45
    v_exp_f32 v46, v46
    v_exp_f32 v47, v47
    v_exp_f32 v16, v16
    v_exp_f32 v17, v17
    v_smfmac_f32_32x32x32_bf16 v[64:79], v[204:207], v[40:47], v4
    v_exp_f32 v18, v18
    v_exp_f32 v19, v19
    v_exp_f32 v20, v20
    s_waitcnt vmcnt(8)
    v_mfma_f32_32x32x16_bf16 v[32:47], v[112:115], v[8:11], v[48:63]
    ds_read_b128 v[12:15], v2 offset:9216
    v_permlane16_swap_b32 v208, v212
    v_permlane16_swap_b32 v209, v213
    v_exp_f32 v21, v21
    v_permlane16_swap_b32 v210, v214
    v_permlane16_swap_b32 v211, v215
    v_exp_f32 v22, v22
    v_exp_f32 v23, v23
    v_exp_f32 v24, v24
    v_exp_f32 v25, v25
    v_smfmac_f32_32x32x32_bf16 v[64:79], v[208:211], v[16:23], v4
    v_exp_f32 v26, v26
    v_exp_f32 v27, v27
    v_exp_f32 v28, v28
    v_exp_f32 v29, v29
    v_exp_f32 v30, v30
    v_exp_f32 v31, v31
    v_exp_f32 v32, v32
    v_exp_f32 v33, v33
    v_smfmac_f32_32x32x32_bf16 v[64:79], v[212:215], v[24:31], v4
    v_exp_f32 v34, v34
    v_exp_f32 v35, v35
    v_exp_f32 v36, v36
    s_waitcnt vmcnt(7) lgkmcnt(0)
    v_mfma_f32_32x32x16_bf16 v[16:31], v[12:15], v[8:11], v[48:63]
    v_permlane16_swap_b32 v216, v220
    v_permlane16_swap_b32 v217, v221
    v_exp_f32 v37, v37
    v_permlane16_swap_b32 v218, v222
    v_permlane16_swap_b32 v219, v223
    v_exp_f32 v38, v38
    v_exp_f32 v39, v39
    v_exp_f32 v40, v40
    v_exp_f32 v41, v41
    v_smfmac_f32_32x32x32_bf16 v[64:79], v[216:219], v[32:39], v4
    v_exp_f32 v42, v42
    v_exp_f32 v43, v43
    v_exp_f32 v44, v44
    v_exp_f32 v45, v45
    v_exp_f32 v46, v46
    v_exp_f32 v47, v47
    v_exp_f32 v16, v16
    v_exp_f32 v17, v17
    v_smfmac_f32_32x32x32_bf16 v[64:79], v[220:223], v[40:47], v4
    v_exp_f32 v18, v18
    v_exp_f32 v19, v19
    v_exp_f32 v20, v20
    s_waitcnt vmcnt(5)
    v_mfma_f32_32x32x16_bf16 v[32:47], v[116:119], v[8:11], v[48:63]
    v_permlane16_swap_b32 v224, v228
    v_permlane16_swap_b32 v225, v229
    v_exp_f32 v21, v21
    v_permlane16_swap_b32 v226, v230
    v_permlane16_swap_b32 v227, v231
    v_exp_f32 v22, v22
    v_exp_f32 v23, v23
    v_exp_f32 v24, v24
    v_exp_f32 v25, v25
    v_smfmac_f32_32x32x32_bf16 v[64:79], v[224:227], v[16:23], v4
    v_exp_f32 v26, v26
    v_exp_f32 v27, v27
    v_exp_f32 v28, v28
    v_exp_f32 v29, v29
    v_exp_f32 v30, v30
    v_exp_f32 v31, v31
    v_exp_f32 v32, v32
    v_exp_f32 v33, v33
    v_smfmac_f32_32x32x32_bf16 v[64:79], v[228:231], v[24:31], v4
    v_exp_f32 v34, v34
    v_exp_f32 v35, v35
    v_exp_f32 v36, v36
    s_waitcnt vmcnt(3)
    v_mfma_f32_32x32x16_bf16 v[16:31], v[120:123], v[8:11], v[48:63]
    v_permlane16_swap_b32 v232, v236
    v_permlane16_swap_b32 v233, v237
    v_exp_f32 v37, v37
    v_permlane16_swap_b32 v234, v238
    v_permlane16_swap_b32 v235, v239
    v_exp_f32 v38, v38
    v_exp_f32 v39, v39
    v_exp_f32 v40, v40
    v_exp_f32 v41, v41
    v_smfmac_f32_32x32x32_bf16 v[64:79], v[232:235], v[32:39], v4
    v_exp_f32 v42, v42
    v_exp_f32 v43, v43
    v_exp_f32 v44, v44
    v_exp_f32 v45, v45
    v_exp_f32 v46, v46
    v_exp_f32 v47, v47
    v_exp_f32 v16, v16
    v_exp_f32 v17, v17
    v_smfmac_f32_32x32x32_bf16 v[64:79], v[236:239], v[40:47], v4
    v_exp_f32 v18, v18
    v_exp_f32 v19, v19
    v_exp_f32 v20, v20
    s_waitcnt vmcnt(1)
    v_mfma_f32_32x32x16_bf16 v[32:47], v[124:127], v[8:11], v[48:63]
    ds_read_b128 v[12:15], v2 offset:0
    v_permlane16_swap_b32 v240, v244
    v_permlane16_swap_b32 v241, v245
    v_exp_f32 v21, v21
    v_permlane16_swap_b32 v242, v246
    v_permlane16_swap_b32 v243, v247
    v_exp_f32 v22, v22
    v_exp_f32 v23, v23
    v_exp_f32 v24, v24
    v_exp_f32 v25, v25
    v_smfmac_f32_32x32x32_bf16 v[64:79], v[240:243], v[16:23], v4
    ds_read_b128 v[8:11], v7 offset:1024
    ds_read_b128 v[48:51], v6 offset:512
    ds_read_b128 v[52:55], v6 offset:512
    ds_read_b128 v[56:59], v6 offset:512
    ds_read_b128 v[60:63], v6 offset:512
    v_exp_f32 v26, v26
    v_exp_f32 v27, v27
    v_exp_f32 v28, v28
    v_exp_f32 v29, v29
    v_exp_f32 v30, v30
    v_exp_f32 v31, v31
    v_exp_f32 v32, v32
    v_exp_f32 v33, v33
    v_smfmac_f32_32x32x32_bf16 v[64:79], v[244:247], v[24:31], v4
    v_exp_f32 v34, v34
    v_exp_f32 v35, v35
    v_exp_f32 v36, v36
    s_waitcnt vmcnt(0) lgkmcnt(0)
    v_mfma_f32_32x32x16_bf16 v[16:31], v[12:15], v[8:11], v[48:63]
    ds_read_b128 v[12:15], v2 offset:1024
    v_permlane16_swap_b32 v248, v252
    v_permlane16_swap_b32 v249, v253
    v_exp_f32 v37, v37
    v_permlane16_swap_b32 v250, v254
    v_permlane16_swap_b32 v251, v255
    v_exp_f32 v38, v38
    v_exp_f32 v39, v39
    v_exp_f32 v40, v40
    v_exp_f32 v41, v41
    v_smfmac_f32_32x32x32_bf16 v[64:79], v[248:251], v[32:39], v4
    v_exp_f32 v42, v42
    v_exp_f32 v43, v43
    v_exp_f32 v44, v44
    v_exp_f32 v45, v45
    v_exp_f32 v46, v46
    v_exp_f32 v47, v47
    v_exp_f32 v16, v16
    v_exp_f32 v17, v17
    v_smfmac_f32_32x32x32_bf16 v[64:79], v[252:255], v[40:47], v4
    v_exp_f32 v18, v18
    v_exp_f32 v19, v19
    v_exp_f32 v20, v20
    v_mfma_f32_32x32x16_bf16 v[32:47], v[80:83], v[8:11], v[48:63]
    v_exp_f32 v21, v21
    v_exp_f32 v22, v22
    v_exp_f32 v23, v23
    v_exp_f32 v24, v24
    v_exp_f32 v25, v25
    v_exp_f32 v26, v26
    v_exp_f32 v27, v27
    v_exp_f32 v28, v28
    ds_write_b128 v3, v[64:67] offset:0
    ds_write_b128 v3, v[68:71] offset:1024
    ds_write_addtid_b32 v72 offset:49152
    v_mfma_f32_32x32x8_bf16 v[64:79], v[0:1], v[4:5], 0
    v_exp_f32 v29, v29
    v_exp_f32 v30, v30
    v_exp_f32 v31, v31
    v_smfmac_f32_32x32x32_bf16 v[64:79], v[128:131], v[16:23], v4
    v_exp_f32 v32, v32
    v_exp_f32 v33, v33
    v_exp_f32 v34, v34
    v_smfmac_f32_32x32x32_bf16 v[64:79], v[132:135], v[24:31], v4
    v_exp_f32 v35, v35
    v_exp_f32 v36, v36
    v_mfma_f32_32x32x16_bf16 v[16:31], v[84:87], v[8:11], v[48:63]
    v_exp_f32 v37, v37
    v_exp_f32 v38, v38
    v_exp_f32 v39, v39
    v_exp_f32 v40, v40
    v_exp_f32 v41, v41
    v_smfmac_f32_32x32x32_bf16 v[64:79], v[136:139], v[32:39], v4
    v_exp_f32 v42, v42
    v_exp_f32 v43, v43
    v_exp_f32 v44, v44
    v_exp_f32 v45, v45
    v_exp_f32 v46, v46
    v_exp_f32 v47, v47
    v_exp_f32 v16, v16
    v_exp_f32 v17, v17
    v_smfmac_f32_32x32x32_bf16 v[64:79], v[140:143], v[40:47], v4
    v_exp_f32 v18, v18
    v_exp_f32 v19, v19
    v_exp_f32 v20, v20
    v_mfma_f32_32x32x16_bf16 v[32:47], v[88:91], v[8:11], v[48:63]
    v_exp_f32 v21, v21
    v_exp_f32 v22, v22
    v_exp_f32 v23, v23
    v_exp_f32 v24, v24
    v_exp_f32 v25, v25
    v_smfmac_f32_32x32x32_bf16 v[64:79], v[144:147], v[16:23], v4
    v_exp_f32 v26, v26
    v_exp_f32 v27, v27
    v_exp_f32 v28, v28
    v_exp_f32 v29, v29
    v_exp_f32 v30, v30
    v_exp_f32 v31, v31
    v_exp_f32 v32, v32
    v_exp_f32 v33, v33
    v_smfmac_f32_32x32x32_bf16 v[64:79], v[148:151], v[24:31], v4
    v_exp_f32 v34, v34
    v_exp_f32 v35, v35
    v_exp_f32 v36, v36
    s_waitcnt lgkmcnt(0)
    v_mfma_f32_32x32x16_bf16 v[16:31], v[12:15], v[8:11], v[48:63]
    ds_read_b128 v[12:15], v2 offset:8192
    v_exp_f32 v37, v37
    v_exp_f32 v38, v38
    v_exp_f32 v39, v39
    v_exp_f32 v40, v40
    v_exp_f32 v41, v41
    v_smfmac_f32_32x32x32_bf16 v[64:79], v[152:155], v[32:39], v4
    v_exp_f32 v42, v42
    v_exp_f32 v43, v43
    v_exp_f32 v44, v44
    v_exp_f32 v45, v45
    v_exp_f32 v46, v46
    v_exp_f32 v47, v47
    v_exp_f32 v16, v16
    v_exp_f32 v17, v17
    v_smfmac_f32_32x32x32_bf16 v[64:79], v[156:159], v[40:47], v4
    v_exp_f32 v18, v18
    v_exp_f32 v19, v19
    v_exp_f32 v20, v20
    v_mfma_f32_32x32x16_bf16 v[32:47], v[92:95], v[8:11], v[48:63]
    v_exp_f32 v21, v21
    v_exp_f32 v22, v22
    v_exp_f32 v23, v23
    v_exp_f32 v24, v24
    v_exp_f32 v25, v25
    v_smfmac_f32_32x32x32_bf16 v[64:79], v[160:163], v[16:23], v4
    v_exp_f32 v26, v26
    v_exp_f32 v27, v27
    v_exp_f32 v28, v28
    v_exp_f32 v29, v29
    v_exp_f32 v30, v30
    v_exp_f32 v31, v31
    v_exp_f32 v32, v32
    v_exp_f32 v33, v33
    v_smfmac_f32_32x32x32_bf16 v[64:79], v[164:167], v[24:31], v4
    v_exp_f32 v34, v34
    v_exp_f32 v35, v35
    v_exp_f32 v36, v36
    v_mfma_f32_32x32x16_bf16 v[16:31], v[96:99], v[8:11], v[48:63]
    v_exp_f32 v37, v37
    v_exp_f32 v38, v38
    v_exp_f32 v39, v39
    v_exp_f32 v40, v40
    v_exp_f32 v41, v41
    v_smfmac_f32_32x32x32_bf16 v[64:79], v[168:171], v[32:39], v4
    v_exp_f32 v42, v42
    v_exp_f32 v43, v43
    v_exp_f32 v44, v44
    v_exp_f32 v45, v45
    v_exp_f32 v46, v46
    v_exp_f32 v47, v47
    v_exp_f32 v16, v16
    v_exp_f32 v17, v17
    v_smfmac_f32_32x32x32_bf16 v[64:79], v[172:175], v[40:47], v4
    v_exp_f32 v18, v18
    v_exp_f32 v19, v19
    v_exp_f32 v20, v20
    v_mfma_f32_32x32x16_bf16 v[32:47], v[100:103], v[8:11], v[48:63]
    v_exp_f32 v21, v21
    v_exp_f32 v22, v22
    v_exp_f32 v23, v23
    v_exp_f32 v24, v24
    v_exp_f32 v25, v25
    v_smfmac_f32_32x32x32_bf16 v[64:79], v[176:179], v[16:23], v4
    v_exp_f32 v26, v26
    v_exp_f32 v27, v27
    v_exp_f32 v28, v28
    v_exp_f32 v29, v29
    v_exp_f32 v30, v30
    v_exp_f32 v31, v31
    v_exp_f32 v32, v32
    v_exp_f32 v33, v33
    v_smfmac_f32_32x32x32_bf16 v[64:79], v[180:183], v[24:31], v4
    v_exp_f32 v34, v34
    v_exp_f32 v35, v35
    v_exp_f32 v36, v36
    s_waitcnt lgkmcnt(0)
    v_mfma_f32_32x32x16_bf16 v[16:31], v[12:15], v[8:11], v[48:63]
    ds_read_b128 v[12:15], v2 offset:9216
    v_exp_f32 v37, v37
    v_exp_f32 v38, v38
    v_exp_f32 v39, v39
    v_exp_f32 v40, v40
    v_exp_f32 v41, v41
    v_smfmac_f32_32x32x32_bf16 v[64:79], v[184:187], v[32:39], v4
    v_exp_f32 v42, v42
    v_exp_f32 v43, v43
    v_exp_f32 v44, v44
    v_exp_f32 v45, v45
    v_exp_f32 v46, v46
    v_exp_f32 v47, v47
    v_exp_f32 v16, v16
    v_exp_f32 v17, v17
    v_smfmac_f32_32x32x32_bf16 v[64:79], v[188:191], v[40:47], v4
    v_exp_f32 v18, v18
    v_exp_f32 v19, v19
    v_exp_f32 v20, v20
    v_mfma_f32_32x32x16_bf16 v[32:47], v[104:107], v[8:11], v[48:63]
    v_exp_f32 v21, v21
    v_exp_f32 v22, v22
    v_exp_f32 v23, v23
    v_exp_f32 v24, v24
    v_exp_f32 v25, v25
    v_smfmac_f32_32x32x32_bf16 v[64:79], v[192:195], v[16:23], v4
    v_exp_f32 v26, v26
    v_exp_f32 v27, v27
    v_exp_f32 v28, v28
    v_exp_f32 v29, v29
    v_exp_f32 v30, v30
    v_exp_f32 v31, v31
    v_exp_f32 v32, v32
    v_exp_f32 v33, v33
    v_smfmac_f32_32x32x32_bf16 v[64:79], v[196:199], v[24:31], v4
    v_exp_f32 v34, v34
    v_exp_f32 v35, v35
    v_exp_f32 v36, v36
    v_mfma_f32_32x32x16_bf16 v[16:31], v[108:111], v[8:11], v[48:63]
    v_exp_f32 v37, v37
    v_exp_f32 v38, v38
    v_exp_f32 v39, v39
    v_exp_f32 v40, v40
    v_exp_f32 v41, v41
    v_smfmac_f32_32x32x32_bf16 v[64:79], v[200:203], v[32:39], v4
    v_exp_f32 v42, v42
    v_exp_f32 v43, v43
    v_exp_f32 v44, v44
    v_exp_f32 v45, v45
    v_exp_f32 v46, v46
    v_exp_f32 v47, v47
    v_exp_f32 v16, v16
    v_exp_f32 v17, v17
    v_smfmac_f32_32x32x32_bf16 v[64:79], v[204:207], v[40:47], v4
    v_exp_f32 v18, v18
    v_exp_f32 v19, v19
    v_exp_f32 v20, v20
    v_mfma_f32_32x32x16_bf16 v[32:47], v[112:115], v[8:11], v[48:63]
    v_exp_f32 v21, v21
    v_exp_f32 v22, v22
    v_exp_f32 v23, v23
    v_exp_f32 v24, v24
    v_exp_f32 v25, v25
    v_smfmac_f32_32x32x32_bf16 v[64:79], v[208:211], v[16:23], v4
    v_exp_f32 v26, v26
    v_exp_f32 v27, v27
    v_exp_f32 v28, v28
    v_exp_f32 v29, v29
    v_exp_f32 v30, v30
    v_exp_f32 v31, v31
    v_exp_f32 v32, v32
    v_exp_f32 v33, v33
    v_smfmac_f32_32x32x32_bf16 v[64:79], v[212:215], v[24:31], v4
    v_exp_f32 v34, v34
    v_exp_f32 v35, v35
    v_exp_f32 v36, v36
    s_waitcnt lgkmcnt(0)
    v_mfma_f32_32x32x16_bf16 v[16:31], v[12:15], v[8:11], v[48:63]
    ds_read_b128 v[12:15], v2 offset:0
    v_exp_f32 v37, v37
    v_exp_f32 v38, v38
    v_exp_f32 v39, v39
    v_exp_f32 v40, v40
    v_exp_f32 v41, v41
    v_smfmac_f32_32x32x32_bf16 v[64:79], v[216:219], v[32:39], v4
    v_exp_f32 v42, v42
    v_exp_f32 v43, v43
    v_exp_f32 v44, v44
    v_exp_f32 v45, v45
    v_exp_f32 v46, v46
    v_exp_f32 v47, v47
    v_exp_f32 v16, v16
    v_exp_f32 v17, v17
    v_smfmac_f32_32x32x32_bf16 v[64:79], v[220:223], v[40:47], v4
    v_exp_f32 v18, v18
    v_exp_f32 v19, v19
    v_exp_f32 v20, v20
    v_mfma_f32_32x32x16_bf16 v[32:47], v[116:119], v[8:11], v[48:63]
    v_exp_f32 v21, v21
    v_exp_f32 v22, v22
    v_exp_f32 v23, v23
    v_exp_f32 v24, v24
    v_exp_f32 v25, v25
    v_smfmac_f32_32x32x32_bf16 v[64:79], v[224:227], v[16:23], v4
    v_exp_f32 v26, v26
    v_exp_f32 v27, v27
    v_exp_f32 v28, v28
    v_exp_f32 v29, v29
    v_exp_f32 v30, v30
    v_exp_f32 v31, v31
    v_exp_f32 v32, v32
    v_exp_f32 v33, v33
    v_smfmac_f32_32x32x32_bf16 v[64:79], v[228:231], v[24:31], v4
    v_exp_f32 v34, v34
    v_exp_f32 v35, v35
    v_exp_f32 v36, v36
    v_mfma_f32_32x32x16_bf16 v[16:31], v[120:123], v[8:11], v[48:63]
    v_exp_f32 v37, v37
    v_exp_f32 v38, v38
    v_exp_f32 v39, v39
    v_exp_f32 v40, v40
    v_exp_f32 v41, v41
    v_smfmac_f32_32x32x32_bf16 v[64:79], v[232:235], v[32:39], v4
    v_exp_f32 v42, v42
    v_exp_f32 v43, v43
    v_exp_f32 v44, v44
    v_exp_f32 v45, v45
    v_exp_f32 v46, v46
    v_exp_f32 v47, v47
    v_exp_f32 v16, v16
    v_exp_f32 v17, v17
    v_smfmac_f32_32x32x32_bf16 v[64:79], v[236:239], v[40:47], v4
    v_exp_f32 v18, v18
    v_exp_f32 v19, v19
    v_exp_f32 v20, v20
    v_mfma_f32_32x32x16_bf16 v[32:47], v[124:127], v[8:11], v[48:63]
    v_exp_f32 v21, v21
    v_exp_f32 v22, v22
    v_exp_f32 v23, v23
    v_exp_f32 v24, v24
    v_exp_f32 v25, v25
    v_smfmac_f32_32x32x32_bf16 v[64:79], v[240:243], v[16:23], v4
    ds_read_b128 v[8:11], v7 offset:2048
    ds_read_b128 v[48:51], v6 offset:1024
    ds_read_b128 v[52:55], v6 offset:1024
    ds_read_b128 v[56:59], v6 offset:1024
    ds_read_b128 v[60:63], v6 offset:1024
    v_exp_f32 v26, v26
    v_exp_f32 v27, v27
    v_exp_f32 v28, v28
    v_exp_f32 v29, v29
    v_exp_f32 v30, v30
    v_exp_f32 v31, v31
    v_exp_f32 v32, v32
    v_exp_f32 v33, v33
    v_smfmac_f32_32x32x32_bf16 v[64:79], v[244:247], v[24:31], v4
    v_exp_f32 v34, v34
    v_exp_f32 v35, v35
    v_exp_f32 v36, v36
    s_waitcnt lgkmcnt(0)
    v_mfma_f32_32x32x16_bf16 v[16:31], v[12:15], v[8:11], v[48:63]
    ds_read_b128 v[12:15], v2 offset:1024
    v_exp_f32 v37, v37
    v_exp_f32 v38, v38
    v_exp_f32 v39, v39
    v_exp_f32 v40, v40
    v_exp_f32 v41, v41
    v_smfmac_f32_32x32x32_bf16 v[64:79], v[248:251], v[32:39], v4
    v_exp_f32 v42, v42
    v_exp_f32 v43, v43
    v_exp_f32 v44, v44
    v_exp_f32 v45, v45
    v_exp_f32 v46, v46
    v_exp_f32 v47, v47
    v_exp_f32 v16, v16
    v_exp_f32 v17, v17
    v_smfmac_f32_32x32x32_bf16 v[64:79], v[252:255], v[40:47], v4
    v_exp_f32 v18, v18
    v_exp_f32 v19, v19
    v_exp_f32 v20, v20
    v_mfma_f32_32x32x16_bf16 v[32:47], v[80:83], v[8:11], v[48:63]
    v_exp_f32 v21, v21
    v_exp_f32 v22, v22
    v_exp_f32 v23, v23
    v_exp_f32 v24, v24
    v_exp_f32 v25, v25
    v_exp_f32 v26, v26
    v_exp_f32 v27, v27
    v_exp_f32 v28, v28
    ds_write_b128 v3, v[64:67] offset:8192
    ds_write_b128 v3, v[68:71] offset:9216
    ds_write_addtid_b32 v72 offset:50176
    v_mfma_f32_32x32x8_bf16 v[64:79], v[0:1], v[4:5], 0
    v_exp_f32 v29, v29
    v_exp_f32 v30, v30
    v_exp_f32 v31, v31
    v_smfmac_f32_32x32x32_bf16 v[64:79], v[128:131], v[16:23], v4
    v_exp_f32 v32, v32
    v_exp_f32 v33, v33
    v_exp_f32 v34, v34
    v_smfmac_f32_32x32x32_bf16 v[64:79], v[132:135], v[24:31], v4
    v_exp_f32 v35, v35
    v_exp_f32 v36, v36
    v_mfma_f32_32x32x16_bf16 v[16:31], v[84:87], v[8:11], v[48:63]
    v_exp_f32 v37, v37
    v_exp_f32 v38, v38
    v_exp_f32 v39, v39
    v_exp_f32 v40, v40
    v_exp_f32 v41, v41
    v_smfmac_f32_32x32x32_bf16 v[64:79], v[136:139], v[32:39], v4
    v_exp_f32 v42, v42
    v_exp_f32 v43, v43
    v_exp_f32 v44, v44
    v_exp_f32 v45, v45
    v_exp_f32 v46, v46
    v_exp_f32 v47, v47
    v_exp_f32 v16, v16
    v_exp_f32 v17, v17
    v_smfmac_f32_32x32x32_bf16 v[64:79], v[140:143], v[40:47], v4
    v_exp_f32 v18, v18
    v_exp_f32 v19, v19
    v_exp_f32 v20, v20
    v_mfma_f32_32x32x16_bf16 v[32:47], v[88:91], v[8:11], v[48:63]
    v_exp_f32 v21, v21
    v_exp_f32 v22, v22
    v_exp_f32 v23, v23
    v_exp_f32 v24, v24
    v_exp_f32 v25, v25
    v_smfmac_f32_32x32x32_bf16 v[64:79], v[144:147], v[16:23], v4
    v_exp_f32 v26, v26
    v_exp_f32 v27, v27
    v_exp_f32 v28, v28
    v_exp_f32 v29, v29
    v_exp_f32 v30, v30
    v_exp_f32 v31, v31
    v_exp_f32 v32, v32
    v_exp_f32 v33, v33
    v_smfmac_f32_32x32x32_bf16 v[64:79], v[148:151], v[24:31], v4
    v_exp_f32 v34, v34
    v_exp_f32 v35, v35
    v_exp_f32 v36, v36
    s_waitcnt lgkmcnt(0)
    v_mfma_f32_32x32x16_bf16 v[16:31], v[12:15], v[8:11], v[48:63]
    ds_read_b128 v[12:15], v2 offset:8192
    v_exp_f32 v37, v37
    v_exp_f32 v38, v38
    v_exp_f32 v39, v39
    v_exp_f32 v40, v40
    v_exp_f32 v41, v41
    v_smfmac_f32_32x32x32_bf16 v[64:79], v[152:155], v[32:39], v4
    v_exp_f32 v42, v42
    v_exp_f32 v43, v43
    v_exp_f32 v44, v44
    v_exp_f32 v45, v45
    v_exp_f32 v46, v46
    v_exp_f32 v47, v47
    v_exp_f32 v16, v16
    v_exp_f32 v17, v17
    v_smfmac_f32_32x32x32_bf16 v[64:79], v[156:159], v[40:47], v4
    v_exp_f32 v18, v18
    v_exp_f32 v19, v19
    v_exp_f32 v20, v20
    v_mfma_f32_32x32x16_bf16 v[32:47], v[92:95], v[8:11], v[48:63]
    v_exp_f32 v21, v21
    v_exp_f32 v22, v22
    v_exp_f32 v23, v23
    v_exp_f32 v24, v24
    v_exp_f32 v25, v25
    v_smfmac_f32_32x32x32_bf16 v[64:79], v[160:163], v[16:23], v4
    v_exp_f32 v26, v26
    v_exp_f32 v27, v27
    v_exp_f32 v28, v28
    v_exp_f32 v29, v29
    v_exp_f32 v30, v30
    v_exp_f32 v31, v31
    v_exp_f32 v32, v32
    v_exp_f32 v33, v33
    v_smfmac_f32_32x32x32_bf16 v[64:79], v[164:167], v[24:31], v4
    v_exp_f32 v34, v34
    v_exp_f32 v35, v35
    v_exp_f32 v36, v36
    v_mfma_f32_32x32x16_bf16 v[16:31], v[96:99], v[8:11], v[48:63]
    v_exp_f32 v37, v37
    v_exp_f32 v38, v38
    v_exp_f32 v39, v39
    v_exp_f32 v40, v40
    v_exp_f32 v41, v41
    v_smfmac_f32_32x32x32_bf16 v[64:79], v[168:171], v[32:39], v4
    v_exp_f32 v42, v42
    v_exp_f32 v43, v43
    v_exp_f32 v44, v44
    v_exp_f32 v45, v45
    v_exp_f32 v46, v46
    v_exp_f32 v47, v47
    v_exp_f32 v16, v16
    v_exp_f32 v17, v17
    v_smfmac_f32_32x32x32_bf16 v[64:79], v[172:175], v[40:47], v4
    v_exp_f32 v18, v18
    v_exp_f32 v19, v19
    v_exp_f32 v20, v20
    v_mfma_f32_32x32x16_bf16 v[32:47], v[100:103], v[8:11], v[48:63]
    v_exp_f32 v21, v21
    v_exp_f32 v22, v22
    v_exp_f32 v23, v23
    v_exp_f32 v24, v24
    v_exp_f32 v25, v25
    v_smfmac_f32_32x32x32_bf16 v[64:79], v[176:179], v[16:23], v4
    v_exp_f32 v26, v26
    v_exp_f32 v27, v27
    v_exp_f32 v28, v28
    v_exp_f32 v29, v29
    v_exp_f32 v30, v30
    v_exp_f32 v31, v31
    v_exp_f32 v32, v32
    v_exp_f32 v33, v33
    v_smfmac_f32_32x32x32_bf16 v[64:79], v[180:183], v[24:31], v4
    v_exp_f32 v34, v34
    v_exp_f32 v35, v35
    v_exp_f32 v36, v36
    s_waitcnt lgkmcnt(0)
    v_mfma_f32_32x32x16_bf16 v[16:31], v[12:15], v[8:11], v[48:63]
    ds_read_b128 v[12:15], v2 offset:9216
    v_exp_f32 v37, v37
    v_exp_f32 v38, v38
    v_exp_f32 v39, v39
    v_exp_f32 v40, v40
    v_exp_f32 v41, v41
    v_smfmac_f32_32x32x32_bf16 v[64:79], v[184:187], v[32:39], v4
    v_exp_f32 v42, v42
    v_exp_f32 v43, v43
    v_exp_f32 v44, v44
    v_exp_f32 v45, v45
    v_exp_f32 v46, v46
    v_exp_f32 v47, v47
    v_exp_f32 v16, v16
    v_exp_f32 v17, v17
    v_smfmac_f32_32x32x32_bf16 v[64:79], v[188:191], v[40:47], v4
    v_exp_f32 v18, v18
    v_exp_f32 v19, v19
    v_exp_f32 v20, v20
    v_mfma_f32_32x32x16_bf16 v[32:47], v[104:107], v[8:11], v[48:63]
    v_exp_f32 v21, v21
    v_exp_f32 v22, v22
    v_exp_f32 v23, v23
    v_exp_f32 v24, v24
    v_exp_f32 v25, v25
    v_smfmac_f32_32x32x32_bf16 v[64:79], v[192:195], v[16:23], v4
    v_exp_f32 v26, v26
    v_exp_f32 v27, v27
    v_exp_f32 v28, v28
    v_exp_f32 v29, v29
    v_exp_f32 v30, v30
    v_exp_f32 v31, v31
    v_exp_f32 v32, v32
    v_exp_f32 v33, v33
    v_smfmac_f32_32x32x32_bf16 v[64:79], v[196:199], v[24:31], v4
    v_exp_f32 v34, v34
    v_exp_f32 v35, v35
    v_exp_f32 v36, v36
    v_mfma_f32_32x32x16_bf16 v[16:31], v[108:111], v[8:11], v[48:63]
    v_exp_f32 v37, v37
    v_exp_f32 v38, v38
    v_exp_f32 v39, v39
    v_exp_f32 v40, v40
    v_exp_f32 v41, v41
    v_smfmac_f32_32x32x32_bf16 v[64:79], v[200:203], v[32:39], v4
    v_exp_f32 v42, v42
    v_exp_f32 v43, v43
    v_exp_f32 v44, v44
    v_exp_f32 v45, v45
    v_exp_f32 v46, v46
    v_exp_f32 v47, v47
    v_exp_f32 v16, v16
    v_exp_f32 v17, v17
    v_smfmac_f32_32x32x32_bf16 v[64:79], v[204:207], v[40:47], v4
    v_exp_f32 v18, v18
    v_exp_f32 v19, v19
    v_exp_f32 v20, v20
    v_mfma_f32_32x32x16_bf16 v[32:47], v[112:115], v[8:11], v[48:63]
    v_exp_f32 v21, v21
    v_exp_f32 v22, v22
    v_exp_f32 v23, v23
    v_exp_f32 v24, v24
    v_exp_f32 v25, v25
    v_smfmac_f32_32x32x32_bf16 v[64:79], v[208:211], v[16:23], v4
    v_exp_f32 v26, v26
    v_exp_f32 v27, v27
    v_exp_f32 v28, v28
    v_exp_f32 v29, v29
    v_exp_f32 v30, v30
    v_exp_f32 v31, v31
    v_exp_f32 v32, v32
    v_exp_f32 v33, v33
    v_smfmac_f32_32x32x32_bf16 v[64:79], v[212:215], v[24:31], v4
    v_exp_f32 v34, v34
    v_exp_f32 v35, v35
    v_exp_f32 v36, v36
    s_waitcnt lgkmcnt(0)
    v_mfma_f32_32x32x16_bf16 v[16:31], v[12:15], v[8:11], v[48:63]
    ds_read_b128 v[12:15], v2 offset:0
    v_exp_f32 v37, v37
    v_exp_f32 v38, v38
    v_exp_f32 v39, v39
    v_exp_f32 v40, v40
    v_exp_f32 v41, v41
    v_smfmac_f32_32x32x32_bf16 v[64:79], v[216:219], v[32:39], v4
    v_exp_f32 v42, v42
    v_exp_f32 v43, v43
    v_exp_f32 v44, v44
    v_exp_f32 v45, v45
    v_exp_f32 v46, v46
    v_exp_f32 v47, v47
    v_exp_f32 v16, v16
    v_exp_f32 v17, v17
    v_smfmac_f32_32x32x32_bf16 v[64:79], v[220:223], v[40:47], v4
    v_exp_f32 v18, v18
    v_exp_f32 v19, v19
    v_exp_f32 v20, v20
    v_mfma_f32_32x32x16_bf16 v[32:47], v[116:119], v[8:11], v[48:63]
    v_exp_f32 v21, v21
    v_exp_f32 v22, v22
    v_exp_f32 v23, v23
    v_exp_f32 v24, v24
    v_exp_f32 v25, v25
    v_smfmac_f32_32x32x32_bf16 v[64:79], v[224:227], v[16:23], v4
    v_exp_f32 v26, v26
    v_exp_f32 v27, v27
    v_exp_f32 v28, v28
    v_exp_f32 v29, v29
    v_exp_f32 v30, v30
    v_exp_f32 v31, v31
    v_exp_f32 v32, v32
    v_exp_f32 v33, v33
    v_smfmac_f32_32x32x32_bf16 v[64:79], v[228:231], v[24:31], v4
    v_exp_f32 v34, v34
    v_exp_f32 v35, v35
    v_exp_f32 v36, v36
    v_mfma_f32_32x32x16_bf16 v[16:31], v[120:123], v[8:11], v[48:63]
    v_exp_f32 v37, v37
    v_exp_f32 v38, v38
    v_exp_f32 v39, v39
    v_exp_f32 v40, v40
    v_exp_f32 v41, v41
    v_smfmac_f32_32x32x32_bf16 v[64:79], v[232:235], v[32:39], v4
    v_exp_f32 v42, v42
    v_exp_f32 v43, v43
    v_exp_f32 v44, v44
    v_exp_f32 v45, v45
    v_exp_f32 v46, v46
    v_exp_f32 v47, v47
    v_exp_f32 v16, v16
    v_exp_f32 v17, v17
    v_smfmac_f32_32x32x32_bf16 v[64:79], v[236:239], v[40:47], v4
    v_exp_f32 v18, v18
    v_exp_f32 v19, v19
    v_exp_f32 v20, v20
    v_mfma_f32_32x32x16_bf16 v[32:47], v[124:127], v[8:11], v[48:63]
    v_exp_f32 v21, v21
    v_exp_f32 v22, v22
    v_exp_f32 v23, v23
    v_exp_f32 v24, v24
    v_exp_f32 v25, v25
    v_smfmac_f32_32x32x32_bf16 v[64:79], v[240:243], v[16:23], v4
    ds_read_b128 v[8:11], v7 offset:3072
    ds_read_b128 v[48:51], v6 offset:1536
    ds_read_b128 v[52:55], v6 offset:1536
    ds_read_b128 v[56:59], v6 offset:1536
    ds_read_b128 v[60:63], v6 offset:1536
    v_exp_f32 v26, v26
    v_exp_f32 v27, v27
    v_exp_f32 v28, v28
    v_exp_f32 v29, v29
    v_exp_f32 v30, v30
    v_exp_f32 v31, v31
    v_exp_f32 v32, v32
    v_exp_f32 v33, v33
    v_smfmac_f32_32x32x32_bf16 v[64:79], v[244:247], v[24:31], v4
    v_exp_f32 v34, v34
    v_exp_f32 v35, v35
    v_exp_f32 v36, v36
    s_waitcnt lgkmcnt(0)
    v_mfma_f32_32x32x16_bf16 v[16:31], v[12:15], v[8:11], v[48:63]
    ds_read_b128 v[12:15], v2 offset:1024
    v_exp_f32 v37, v37
    v_exp_f32 v38, v38
    v_exp_f32 v39, v39
    v_exp_f32 v40, v40
    v_exp_f32 v41, v41
    v_smfmac_f32_32x32x32_bf16 v[64:79], v[248:251], v[32:39], v4
    v_exp_f32 v42, v42
    v_exp_f32 v43, v43
    v_exp_f32 v44, v44
    v_exp_f32 v45, v45
    v_exp_f32 v46, v46
    v_exp_f32 v47, v47
    v_exp_f32 v16, v16
    v_exp_f32 v17, v17
    v_smfmac_f32_32x32x32_bf16 v[64:79], v[252:255], v[40:47], v4
    v_exp_f32 v18, v18
    v_exp_f32 v19, v19
    v_exp_f32 v20, v20
    v_mfma_f32_32x32x16_bf16 v[32:47], v[80:83], v[8:11], v[48:63]
    v_exp_f32 v21, v21
    v_exp_f32 v22, v22
    v_exp_f32 v23, v23
    v_exp_f32 v24, v24
    v_exp_f32 v25, v25
    v_exp_f32 v26, v26
    v_exp_f32 v27, v27
    v_exp_f32 v28, v28
    ds_write_b128 v3, v[64:67] offset:16384
    ds_write_b128 v3, v[68:71] offset:17408
    ds_write_addtid_b32 v72 offset:51200
    v_mfma_f32_32x32x8_bf16 v[64:79], v[0:1], v[4:5], 0
    v_exp_f32 v29, v29
    v_exp_f32 v30, v30
    v_exp_f32 v31, v31
    v_smfmac_f32_32x32x32_bf16 v[64:79], v[128:131], v[16:23], v4
    v_exp_f32 v32, v32
    v_exp_f32 v33, v33
    v_exp_f32 v34, v34
    v_smfmac_f32_32x32x32_bf16 v[64:79], v[132:135], v[24:31], v4
    v_exp_f32 v35, v35
    v_exp_f32 v36, v36
    v_mfma_f32_32x32x16_bf16 v[16:31], v[84:87], v[8:11], v[48:63]
    v_exp_f32 v37, v37
    v_exp_f32 v38, v38
    v_exp_f32 v39, v39
    v_exp_f32 v40, v40
    v_exp_f32 v41, v41
    v_smfmac_f32_32x32x32_bf16 v[64:79], v[136:139], v[32:39], v4
    v_exp_f32 v42, v42
    v_exp_f32 v43, v43
    v_exp_f32 v44, v44
    v_exp_f32 v45, v45
    v_exp_f32 v46, v46
    v_exp_f32 v47, v47
    v_exp_f32 v16, v16
    v_exp_f32 v17, v17
    v_smfmac_f32_32x32x32_bf16 v[64:79], v[140:143], v[40:47], v4
    v_exp_f32 v18, v18
    v_exp_f32 v19, v19
    v_exp_f32 v20, v20
    v_mfma_f32_32x32x16_bf16 v[32:47], v[88:91], v[8:11], v[48:63]
    v_exp_f32 v21, v21
    v_exp_f32 v22, v22
    v_exp_f32 v23, v23
    v_exp_f32 v24, v24
    v_exp_f32 v25, v25
    v_smfmac_f32_32x32x32_bf16 v[64:79], v[144:147], v[16:23], v4
    v_exp_f32 v26, v26
    v_exp_f32 v27, v27
    v_exp_f32 v28, v28
    v_exp_f32 v29, v29
    v_exp_f32 v30, v30
    v_exp_f32 v31, v31
    v_exp_f32 v32, v32
    v_exp_f32 v33, v33
    v_smfmac_f32_32x32x32_bf16 v[64:79], v[148:151], v[24:31], v4
    v_exp_f32 v34, v34
    v_exp_f32 v35, v35
    v_exp_f32 v36, v36
    s_waitcnt lgkmcnt(0)
    v_mfma_f32_32x32x16_bf16 v[16:31], v[12:15], v[8:11], v[48:63]
    ds_read_b128 v[12:15], v2 offset:8192
    v_exp_f32 v37, v37
    v_exp_f32 v38, v38
    v_exp_f32 v39, v39
    v_exp_f32 v40, v40
    v_exp_f32 v41, v41
    v_smfmac_f32_32x32x32_bf16 v[64:79], v[152:155], v[32:39], v4
    v_exp_f32 v42, v42
    v_exp_f32 v43, v43
    v_exp_f32 v44, v44
    v_exp_f32 v45, v45
    v_exp_f32 v46, v46
    v_exp_f32 v47, v47
    v_exp_f32 v16, v16
    v_exp_f32 v17, v17
    v_smfmac_f32_32x32x32_bf16 v[64:79], v[156:159], v[40:47], v4
    v_exp_f32 v18, v18
    v_exp_f32 v19, v19
    v_exp_f32 v20, v20
    v_mfma_f32_32x32x16_bf16 v[32:47], v[92:95], v[8:11], v[48:63]
    v_exp_f32 v21, v21
    v_exp_f32 v22, v22
    v_exp_f32 v23, v23
    v_exp_f32 v24, v24
    v_exp_f32 v25, v25
    v_smfmac_f32_32x32x32_bf16 v[64:79], v[160:163], v[16:23], v4
    v_exp_f32 v26, v26
    v_exp_f32 v27, v27
    v_exp_f32 v28, v28
    v_exp_f32 v29, v29
    v_exp_f32 v30, v30
    v_exp_f32 v31, v31
    v_exp_f32 v32, v32
    v_exp_f32 v33, v33
    v_smfmac_f32_32x32x32_bf16 v[64:79], v[164:167], v[24:31], v4
    v_exp_f32 v34, v34
    v_exp_f32 v35, v35
    v_exp_f32 v36, v36
    v_mfma_f32_32x32x16_bf16 v[16:31], v[96:99], v[8:11], v[48:63]
    v_exp_f32 v37, v37
    v_exp_f32 v38, v38
    v_exp_f32 v39, v39
    v_exp_f32 v40, v40
    v_exp_f32 v41, v41
    v_smfmac_f32_32x32x32_bf16 v[64:79], v[168:171], v[32:39], v4
    v_exp_f32 v42, v42
    v_exp_f32 v43, v43
    v_exp_f32 v44, v44
    v_exp_f32 v45, v45
    v_exp_f32 v46, v46
    v_exp_f32 v47, v47
    v_exp_f32 v16, v16
    v_exp_f32 v17, v17
    v_smfmac_f32_32x32x32_bf16 v[64:79], v[172:175], v[40:47], v4
    v_exp_f32 v18, v18
    v_exp_f32 v19, v19
    v_exp_f32 v20, v20
    v_mfma_f32_32x32x16_bf16 v[32:47], v[100:103], v[8:11], v[48:63]
    v_exp_f32 v21, v21
    v_exp_f32 v22, v22
    v_exp_f32 v23, v23
    v_exp_f32 v24, v24
    v_exp_f32 v25, v25
    v_smfmac_f32_32x32x32_bf16 v[64:79], v[176:179], v[16:23], v4
    v_exp_f32 v26, v26
    v_exp_f32 v27, v27
    v_exp_f32 v28, v28
    v_exp_f32 v29, v29
    v_exp_f32 v30, v30
    v_exp_f32 v31, v31
    v_exp_f32 v32, v32
    v_exp_f32 v33, v33
    v_smfmac_f32_32x32x32_bf16 v[64:79], v[180:183], v[24:31], v4
    v_exp_f32 v34, v34
    v_exp_f32 v35, v35
    v_exp_f32 v36, v36
    s_waitcnt lgkmcnt(0)
    v_mfma_f32_32x32x16_bf16 v[16:31], v[12:15], v[8:11], v[48:63]
    ds_read_b128 v[12:15], v2 offset:9216
    v_exp_f32 v37, v37
    v_exp_f32 v38, v38
    v_exp_f32 v39, v39
    v_exp_f32 v40, v40
    v_exp_f32 v41, v41
    v_smfmac_f32_32x32x32_bf16 v[64:79], v[184:187], v[32:39], v4
    v_exp_f32 v42, v42
    v_exp_f32 v43, v43
    v_exp_f32 v44, v44
    v_exp_f32 v45, v45
    v_exp_f32 v46, v46
    v_exp_f32 v47, v47
    v_exp_f32 v16, v16
    v_exp_f32 v17, v17
    v_smfmac_f32_32x32x32_bf16 v[64:79], v[188:191], v[40:47], v4
    v_exp_f32 v18, v18
    v_exp_f32 v19, v19
    v_exp_f32 v20, v20
    v_mfma_f32_32x32x16_bf16 v[32:47], v[104:107], v[8:11], v[48:63]
    v_exp_f32 v21, v21
    v_exp_f32 v22, v22
    v_exp_f32 v23, v23
    v_exp_f32 v24, v24
    v_exp_f32 v25, v25
    v_smfmac_f32_32x32x32_bf16 v[64:79], v[192:195], v[16:23], v4
    v_exp_f32 v26, v26
    v_exp_f32 v27, v27
    v_exp_f32 v28, v28
    v_exp_f32 v29, v29
    v_exp_f32 v30, v30
    v_exp_f32 v31, v31
    v_exp_f32 v32, v32
    v_exp_f32 v33, v33
    v_smfmac_f32_32x32x32_bf16 v[64:79], v[196:199], v[24:31], v4
    v_exp_f32 v34, v34
    v_exp_f32 v35, v35
    v_exp_f32 v36, v36
    v_mfma_f32_32x32x16_bf16 v[16:31], v[108:111], v[8:11], v[48:63]
    v_exp_f32 v37, v37
    v_exp_f32 v38, v38
    v_exp_f32 v39, v39
    v_exp_f32 v40, v40
    v_exp_f32 v41, v41
    v_smfmac_f32_32x32x32_bf16 v[64:79], v[200:203], v[32:39], v4
    v_exp_f32 v42, v42
    v_exp_f32 v43, v43
    v_exp_f32 v44, v44
    v_exp_f32 v45, v45
    v_exp_f32 v46, v46
    v_exp_f32 v47, v47
    v_exp_f32 v16, v16
    v_exp_f32 v17, v17
    v_smfmac_f32_32x32x32_bf16 v[64:79], v[204:207], v[40:47], v4
    v_exp_f32 v18, v18
    v_exp_f32 v19, v19
    v_exp_f32 v20, v20
    v_mfma_f32_32x32x16_bf16 v[32:47], v[112:115], v[8:11], v[48:63]
    v_exp_f32 v21, v21
    v_exp_f32 v22, v22
    v_exp_f32 v23, v23
    v_exp_f32 v24, v24
    v_exp_f32 v25, v25
    v_smfmac_f32_32x32x32_bf16 v[64:79], v[208:211], v[16:23], v4
    v_exp_f32 v26, v26
    v_exp_f32 v27, v27
    v_exp_f32 v28, v28
    v_exp_f32 v29, v29
    v_exp_f32 v30, v30
    v_exp_f32 v31, v31
    v_exp_f32 v32, v32
    v_exp_f32 v33, v33
    v_smfmac_f32_32x32x32_bf16 v[64:79], v[212:215], v[24:31], v4
    v_exp_f32 v34, v34
    v_exp_f32 v35, v35
    v_exp_f32 v36, v36
    s_waitcnt lgkmcnt(0)
    v_mfma_f32_32x32x16_bf16 v[16:31], v[12:15], v[8:11], v[48:63]
    ds_read_b128 v[12:15], v2 offset:0
    v_exp_f32 v37, v37
    v_exp_f32 v38, v38
    v_exp_f32 v39, v39
    v_exp_f32 v40, v40
    v_exp_f32 v41, v41
    v_smfmac_f32_32x32x32_bf16 v[64:79], v[216:219], v[32:39], v4
    v_exp_f32 v42, v42
    v_exp_f32 v43, v43
    v_exp_f32 v44, v44
    v_exp_f32 v45, v45
    v_exp_f32 v46, v46
    v_exp_f32 v47, v47
    v_exp_f32 v16, v16
    v_exp_f32 v17, v17
    v_smfmac_f32_32x32x32_bf16 v[64:79], v[220:223], v[40:47], v4
    v_exp_f32 v18, v18
    v_exp_f32 v19, v19
    v_exp_f32 v20, v20
    v_mfma_f32_32x32x16_bf16 v[32:47], v[116:119], v[8:11], v[48:63]
    v_exp_f32 v21, v21
    v_exp_f32 v22, v22
    v_exp_f32 v23, v23
    v_exp_f32 v24, v24
    v_exp_f32 v25, v25
    v_smfmac_f32_32x32x32_bf16 v[64:79], v[224:227], v[16:23], v4
    v_exp_f32 v26, v26
    v_exp_f32 v27, v27
    v_exp_f32 v28, v28
    v_exp_f32 v29, v29
    v_exp_f32 v30, v30
    v_exp_f32 v31, v31
    v_exp_f32 v32, v32
    v_exp_f32 v33, v33
    v_smfmac_f32_32x32x32_bf16 v[64:79], v[228:231], v[24:31], v4
    v_exp_f32 v34, v34
    v_exp_f32 v35, v35
    v_exp_f32 v36, v36
    v_mfma_f32_32x32x16_bf16 v[16:31], v[120:123], v[8:11], v[48:63]
    v_exp_f32 v37, v37
    v_exp_f32 v38, v38
    v_exp_f32 v39, v39
    v_exp_f32 v40, v40
    v_exp_f32 v41, v41
    v_smfmac_f32_32x32x32_bf16 v[64:79], v[232:235], v[32:39], v4
    v_exp_f32 v42, v42
    v_exp_f32 v43, v43
    v_exp_f32 v44, v44
    v_exp_f32 v45, v45
    v_exp_f32 v46, v46
    v_exp_f32 v47, v47
    v_exp_f32 v16, v16
    v_exp_f32 v17, v17
    v_smfmac_f32_32x32x32_bf16 v[64:79], v[236:239], v[40:47], v4
    v_exp_f32 v18, v18
    v_exp_f32 v19, v19
    v_exp_f32 v20, v20
    v_mfma_f32_32x32x16_bf16 v[32:47], v[124:127], v[8:11], v[48:63]
    v_exp_f32 v21, v21
    v_exp_f32 v22, v22
    v_exp_f32 v23, v23
    v_exp_f32 v24, v24
    v_exp_f32 v25, v25
    v_smfmac_f32_32x32x32_bf16 v[64:79], v[240:243], v[16:23], v4
    ds_read_b128 v[8:11], v7 offset:4096
    ds_read_b128 v[48:51], v6 offset:2048
    ds_read_b128 v[52:55], v6 offset:2048
    ds_read_b128 v[56:59], v6 offset:2048
    ds_read_b128 v[60:63], v6 offset:2048
    v_exp_f32 v26, v26
    v_exp_f32 v27, v27
    v_exp_f32 v28, v28
    v_exp_f32 v29, v29
    v_exp_f32 v30, v30
    v_exp_f32 v31, v31
    v_exp_f32 v32, v32
    v_exp_f32 v33, v33
    v_smfmac_f32_32x32x32_bf16 v[64:79], v[244:247], v[24:31], v4
    v_exp_f32 v34, v34
    v_exp_f32 v35, v35
    v_exp_f32 v36, v36
    s_waitcnt lgkmcnt(0)
    v_mfma_f32_32x32x16_bf16 v[16:31], v[12:15], v[8:11], v[48:63]
    ds_read_b128 v[12:15], v2 offset:1024
    v_exp_f32 v37, v37
    v_exp_f32 v38, v38
    v_exp_f32 v39, v39
    v_exp_f32 v40, v40
    v_exp_f32 v41, v41
    v_smfmac_f32_32x32x32_bf16 v[64:79], v[248:251], v[32:39], v4
    v_exp_f32 v42, v42
    v_exp_f32 v43, v43
    v_exp_f32 v44, v44
    v_exp_f32 v45, v45
    v_exp_f32 v46, v46
    v_exp_f32 v47, v47
    v_exp_f32 v16, v16
    v_exp_f32 v17, v17
    v_smfmac_f32_32x32x32_bf16 v[64:79], v[252:255], v[40:47], v4
    v_exp_f32 v18, v18
    v_exp_f32 v19, v19
    v_exp_f32 v20, v20
    v_mfma_f32_32x32x16_bf16 v[32:47], v[80:83], v[8:11], v[48:63]
    v_exp_f32 v21, v21
    v_exp_f32 v22, v22
    v_exp_f32 v23, v23
    v_exp_f32 v24, v24
    v_exp_f32 v25, v25
    v_exp_f32 v26, v26
    v_exp_f32 v27, v27
    v_exp_f32 v28, v28
    ds_write_b128 v3, v[64:67] offset:24576
    ds_write_b128 v3, v[68:71] offset:25600
    ds_write_addtid_b32 v72 offset:52224
    v_mfma_f32_32x32x8_bf16 v[64:79], v[0:1], v[4:5], 0
    v_exp_f32 v29, v29
    v_exp_f32 v30, v30
    v_exp_f32 v31, v31
    v_smfmac_f32_32x32x32_bf16 v[64:79], v[128:131], v[16:23], v4
    v_exp_f32 v32, v32
    v_exp_f32 v33, v33
    v_exp_f32 v34, v34
    v_smfmac_f32_32x32x32_bf16 v[64:79], v[132:135], v[24:31], v4
    v_exp_f32 v35, v35
    v_exp_f32 v36, v36
    v_mfma_f32_32x32x16_bf16 v[16:31], v[84:87], v[8:11], v[48:63]
    v_exp_f32 v37, v37
    v_exp_f32 v38, v38
    v_exp_f32 v39, v39
    v_exp_f32 v40, v40
    v_exp_f32 v41, v41
    v_smfmac_f32_32x32x32_bf16 v[64:79], v[136:139], v[32:39], v4
    v_exp_f32 v42, v42
    v_exp_f32 v43, v43
    v_exp_f32 v44, v44
    v_exp_f32 v45, v45
    v_exp_f32 v46, v46
    v_exp_f32 v47, v47
    v_exp_f32 v16, v16
    v_exp_f32 v17, v17
    v_smfmac_f32_32x32x32_bf16 v[64:79], v[140:143], v[40:47], v4
    v_exp_f32 v18, v18
    v_exp_f32 v19, v19
    v_exp_f32 v20, v20
    v_mfma_f32_32x32x16_bf16 v[32:47], v[88:91], v[8:11], v[48:63]
    v_exp_f32 v21, v21
    v_exp_f32 v22, v22
    v_exp_f32 v23, v23
    v_exp_f32 v24, v24
    v_exp_f32 v25, v25
    v_smfmac_f32_32x32x32_bf16 v[64:79], v[144:147], v[16:23], v4
    v_exp_f32 v26, v26
    v_exp_f32 v27, v27
    v_exp_f32 v28, v28
    v_exp_f32 v29, v29
    v_exp_f32 v30, v30
    v_exp_f32 v31, v31
    v_exp_f32 v32, v32
    v_exp_f32 v33, v33
    v_smfmac_f32_32x32x32_bf16 v[64:79], v[148:151], v[24:31], v4
    v_exp_f32 v34, v34
    v_exp_f32 v35, v35
    v_exp_f32 v36, v36
    s_waitcnt lgkmcnt(0)
    v_mfma_f32_32x32x16_bf16 v[16:31], v[12:15], v[8:11], v[48:63]
    ds_read_b128 v[12:15], v2 offset:8192
    v_exp_f32 v37, v37
    v_exp_f32 v38, v38
    v_exp_f32 v39, v39
    v_exp_f32 v40, v40
    v_exp_f32 v41, v41
    v_smfmac_f32_32x32x32_bf16 v[64:79], v[152:155], v[32:39], v4
    v_exp_f32 v42, v42
    v_exp_f32 v43, v43
    v_exp_f32 v44, v44
    v_exp_f32 v45, v45
    v_exp_f32 v46, v46
    v_exp_f32 v47, v47
    v_exp_f32 v16, v16
    v_exp_f32 v17, v17
    v_smfmac_f32_32x32x32_bf16 v[64:79], v[156:159], v[40:47], v4
    v_exp_f32 v18, v18
    v_exp_f32 v19, v19
    v_exp_f32 v20, v20
    v_mfma_f32_32x32x16_bf16 v[32:47], v[92:95], v[8:11], v[48:63]
    v_exp_f32 v21, v21
    v_exp_f32 v22, v22
    v_exp_f32 v23, v23
    v_exp_f32 v24, v24
    v_exp_f32 v25, v25
    v_smfmac_f32_32x32x32_bf16 v[64:79], v[160:163], v[16:23], v4
    v_exp_f32 v26, v26
    v_exp_f32 v27, v27
    v_exp_f32 v28, v28
    v_exp_f32 v29, v29
    v_exp_f32 v30, v30
    v_exp_f32 v31, v31
    v_exp_f32 v32, v32
    v_exp_f32 v33, v33
    v_smfmac_f32_32x32x32_bf16 v[64:79], v[164:167], v[24:31], v4
    v_exp_f32 v34, v34
    v_exp_f32 v35, v35
    v_exp_f32 v36, v36
    v_mfma_f32_32x32x16_bf16 v[16:31], v[96:99], v[8:11], v[48:63]
    v_exp_f32 v37, v37
    v_exp_f32 v38, v38
    v_exp_f32 v39, v39
    v_exp_f32 v40, v40
    v_exp_f32 v41, v41
    v_smfmac_f32_32x32x32_bf16 v[64:79], v[168:171], v[32:39], v4
    v_exp_f32 v42, v42
    v_exp_f32 v43, v43
    v_exp_f32 v44, v44
    v_exp_f32 v45, v45
    v_exp_f32 v46, v46
    v_exp_f32 v47, v47
    v_exp_f32 v16, v16
    v_exp_f32 v17, v17
    v_smfmac_f32_32x32x32_bf16 v[64:79], v[172:175], v[40:47], v4
    v_exp_f32 v18, v18
    v_exp_f32 v19, v19
    v_exp_f32 v20, v20
    v_mfma_f32_32x32x16_bf16 v[32:47], v[100:103], v[8:11], v[48:63]
    v_exp_f32 v21, v21
    v_exp_f32 v22, v22
    v_exp_f32 v23, v23
    v_exp_f32 v24, v24
    v_exp_f32 v25, v25
    v_smfmac_f32_32x32x32_bf16 v[64:79], v[176:179], v[16:23], v4
    v_exp_f32 v26, v26
    v_exp_f32 v27, v27
    v_exp_f32 v28, v28
    v_exp_f32 v29, v29
    v_exp_f32 v30, v30
    v_exp_f32 v31, v31
    v_exp_f32 v32, v32
    v_exp_f32 v33, v33
    v_smfmac_f32_32x32x32_bf16 v[64:79], v[180:183], v[24:31], v4
    v_exp_f32 v34, v34
    v_exp_f32 v35, v35
    v_exp_f32 v36, v36
    s_waitcnt lgkmcnt(0)
    v_mfma_f32_32x32x16_bf16 v[16:31], v[12:15], v[8:11], v[48:63]
    ds_read_b128 v[12:15], v2 offset:9216
    v_exp_f32 v37, v37
    v_exp_f32 v38, v38
    v_exp_f32 v39, v39
    v_exp_f32 v40, v40
    v_exp_f32 v41, v41
    v_smfmac_f32_32x32x32_bf16 v[64:79], v[184:187], v[32:39], v4
    v_exp_f32 v42, v42
    v_exp_f32 v43, v43
    v_exp_f32 v44, v44
    v_exp_f32 v45, v45
    v_exp_f32 v46, v46
    v_exp_f32 v47, v47
    v_exp_f32 v16, v16
    v_exp_f32 v17, v17
    v_smfmac_f32_32x32x32_bf16 v[64:79], v[188:191], v[40:47], v4
    v_exp_f32 v18, v18
    v_exp_f32 v19, v19
    v_exp_f32 v20, v20
    v_mfma_f32_32x32x16_bf16 v[32:47], v[104:107], v[8:11], v[48:63]
    v_exp_f32 v21, v21
    v_exp_f32 v22, v22
    v_exp_f32 v23, v23
    v_exp_f32 v24, v24
    v_exp_f32 v25, v25
    v_smfmac_f32_32x32x32_bf16 v[64:79], v[192:195], v[16:23], v4
    v_exp_f32 v26, v26
    v_exp_f32 v27, v27
    v_exp_f32 v28, v28
    v_exp_f32 v29, v29
    v_exp_f32 v30, v30
    v_exp_f32 v31, v31
    v_exp_f32 v32, v32
    v_exp_f32 v33, v33
    v_smfmac_f32_32x32x32_bf16 v[64:79], v[196:199], v[24:31], v4
    v_exp_f32 v34, v34
    v_exp_f32 v35, v35
    v_exp_f32 v36, v36
    v_mfma_f32_32x32x16_bf16 v[16:31], v[108:111], v[8:11], v[48:63]
    v_exp_f32 v37, v37
    v_exp_f32 v38, v38
    v_exp_f32 v39, v39
    v_exp_f32 v40, v40
    v_exp_f32 v41, v41
    v_smfmac_f32_32x32x32_bf16 v[64:79], v[200:203], v[32:39], v4
    v_exp_f32 v42, v42
    v_exp_f32 v43, v43
    v_exp_f32 v44, v44
    v_exp_f32 v45, v45
    v_exp_f32 v46, v46
    v_exp_f32 v47, v47
    v_exp_f32 v16, v16
    v_exp_f32 v17, v17
    v_smfmac_f32_32x32x32_bf16 v[64:79], v[204:207], v[40:47], v4
    v_exp_f32 v18, v18
    v_exp_f32 v19, v19
    v_exp_f32 v20, v20
    v_mfma_f32_32x32x16_bf16 v[32:47], v[112:115], v[8:11], v[48:63]
    v_exp_f32 v21, v21
    v_exp_f32 v22, v22
    v_exp_f32 v23, v23
    v_exp_f32 v24, v24
    v_exp_f32 v25, v25
    v_smfmac_f32_32x32x32_bf16 v[64:79], v[208:211], v[16:23], v4
    v_exp_f32 v26, v26
    v_exp_f32 v27, v27
    v_exp_f32 v28, v28
    v_exp_f32 v29, v29
    v_exp_f32 v30, v30
    v_exp_f32 v31, v31
    v_exp_f32 v32, v32
    v_exp_f32 v33, v33
    v_smfmac_f32_32x32x32_bf16 v[64:79], v[212:215], v[24:31], v4
    v_exp_f32 v34, v34
    v_exp_f32 v35, v35
    v_exp_f32 v36, v36
    s_waitcnt lgkmcnt(0)
    v_mfma_f32_32x32x16_bf16 v[16:31], v[12:15], v[8:11], v[48:63]
    ds_read_b128 v[12:15], v2 offset:0
    v_exp_f32 v37, v37
    v_exp_f32 v38, v38
    v_exp_f32 v39, v39
    v_exp_f32 v40, v40
    v_exp_f32 v41, v41
    v_smfmac_f32_32x32x32_bf16 v[64:79], v[216:219], v[32:39], v4
    v_exp_f32 v42, v42
    v_exp_f32 v43, v43
    v_exp_f32 v44, v44
    v_exp_f32 v45, v45
    v_exp_f32 v46, v46
    v_exp_f32 v47, v47
    v_exp_f32 v16, v16
    v_exp_f32 v17, v17
    v_smfmac_f32_32x32x32_bf16 v[64:79], v[220:223], v[40:47], v4
    v_exp_f32 v18, v18
    v_exp_f32 v19, v19
    v_exp_f32 v20, v20
    v_mfma_f32_32x32x16_bf16 v[32:47], v[116:119], v[8:11], v[48:63]
    v_exp_f32 v21, v21
    v_exp_f32 v22, v22
    v_exp_f32 v23, v23
    v_exp_f32 v24, v24
    v_exp_f32 v25, v25
    v_smfmac_f32_32x32x32_bf16 v[64:79], v[224:227], v[16:23], v4
    v_exp_f32 v26, v26
    v_exp_f32 v27, v27
    v_exp_f32 v28, v28
    v_exp_f32 v29, v29
    v_exp_f32 v30, v30
    v_exp_f32 v31, v31
    v_exp_f32 v32, v32
    v_exp_f32 v33, v33
    v_smfmac_f32_32x32x32_bf16 v[64:79], v[228:231], v[24:31], v4
    v_exp_f32 v34, v34
    v_exp_f32 v35, v35
    v_exp_f32 v36, v36
    v_mfma_f32_32x32x16_bf16 v[16:31], v[120:123], v[8:11], v[48:63]
    v_exp_f32 v37, v37
    v_exp_f32 v38, v38
    v_exp_f32 v39, v39
    v_exp_f32 v40, v40
    v_exp_f32 v41, v41
    v_smfmac_f32_32x32x32_bf16 v[64:79], v[232:235], v[32:39], v4
    v_exp_f32 v42, v42
    v_exp_f32 v43, v43
    v_exp_f32 v44, v44
    v_exp_f32 v45, v45
    v_exp_f32 v46, v46
    v_exp_f32 v47, v47
    v_exp_f32 v16, v16
    v_exp_f32 v17, v17
    v_smfmac_f32_32x32x32_bf16 v[64:79], v[236:239], v[40:47], v4
    v_exp_f32 v18, v18
    v_exp_f32 v19, v19
    v_exp_f32 v20, v20
    v_mfma_f32_32x32x16_bf16 v[32:47], v[124:127], v[8:11], v[48:63]
    v_exp_f32 v21, v21
    v_exp_f32 v22, v22
    v_exp_f32 v23, v23
    v_exp_f32 v24, v24
    v_exp_f32 v25, v25
    v_smfmac_f32_32x32x32_bf16 v[64:79], v[240:243], v[16:23], v4
    ds_read_b128 v[8:11], v7 offset:5120
    ds_read_b128 v[48:51], v6 offset:2560
    ds_read_b128 v[52:55], v6 offset:2560
    ds_read_b128 v[56:59], v6 offset:2560
    ds_read_b128 v[60:63], v6 offset:2560
    v_exp_f32 v26, v26
    v_exp_f32 v27, v27
    v_exp_f32 v28, v28
    v_exp_f32 v29, v29
    v_exp_f32 v30, v30
    v_exp_f32 v31, v31
    v_exp_f32 v32, v32
    v_exp_f32 v33, v33
    v_smfmac_f32_32x32x32_bf16 v[64:79], v[244:247], v[24:31], v4
    v_exp_f32 v34, v34
    v_exp_f32 v35, v35
    v_exp_f32 v36, v36
    s_waitcnt lgkmcnt(0)
    v_mfma_f32_32x32x16_bf16 v[16:31], v[12:15], v[8:11], v[48:63]
    ds_read_b128 v[12:15], v2 offset:1024
    v_exp_f32 v37, v37
    v_exp_f32 v38, v38
    v_exp_f32 v39, v39
    v_exp_f32 v40, v40
    v_exp_f32 v41, v41
    v_smfmac_f32_32x32x32_bf16 v[64:79], v[248:251], v[32:39], v4
    v_exp_f32 v42, v42
    v_exp_f32 v43, v43
    v_exp_f32 v44, v44
    v_exp_f32 v45, v45
    v_exp_f32 v46, v46
    v_exp_f32 v47, v47
    v_exp_f32 v16, v16
    v_exp_f32 v17, v17
    v_smfmac_f32_32x32x32_bf16 v[64:79], v[252:255], v[40:47], v4
    v_exp_f32 v18, v18
    v_exp_f32 v19, v19
    v_exp_f32 v20, v20
    v_mfma_f32_32x32x16_bf16 v[32:47], v[80:83], v[8:11], v[48:63]
    v_exp_f32 v21, v21
    v_exp_f32 v22, v22
    v_exp_f32 v23, v23
    v_exp_f32 v24, v24
    v_exp_f32 v25, v25
    v_exp_f32 v26, v26
    v_exp_f32 v27, v27
    v_exp_f32 v28, v28
    ds_write_b128 v3, v[64:67] offset:32768
    ds_write_b128 v3, v[68:71] offset:33792
    ds_write_addtid_b32 v72 offset:53248
    v_mfma_f32_32x32x8_bf16 v[64:79], v[0:1], v[4:5], 0
    v_exp_f32 v29, v29
    v_exp_f32 v30, v30
    v_exp_f32 v31, v31
    v_smfmac_f32_32x32x32_bf16 v[64:79], v[128:131], v[16:23], v4
    v_exp_f32 v32, v32
    v_exp_f32 v33, v33
    v_exp_f32 v34, v34
    v_smfmac_f32_32x32x32_bf16 v[64:79], v[132:135], v[24:31], v4
    v_exp_f32 v35, v35
    v_exp_f32 v36, v36
    v_mfma_f32_32x32x16_bf16 v[16:31], v[84:87], v[8:11], v[48:63]
    v_exp_f32 v37, v37
    v_exp_f32 v38, v38
    v_exp_f32 v39, v39
    v_exp_f32 v40, v40
    v_exp_f32 v41, v41
    v_smfmac_f32_32x32x32_bf16 v[64:79], v[136:139], v[32:39], v4
    v_exp_f32 v42, v42
    v_exp_f32 v43, v43
    v_exp_f32 v44, v44
    v_exp_f32 v45, v45
    v_exp_f32 v46, v46
    v_exp_f32 v47, v47
    v_exp_f32 v16, v16
    v_exp_f32 v17, v17
    v_smfmac_f32_32x32x32_bf16 v[64:79], v[140:143], v[40:47], v4
    v_exp_f32 v18, v18
    v_exp_f32 v19, v19
    v_exp_f32 v20, v20
    v_mfma_f32_32x32x16_bf16 v[32:47], v[88:91], v[8:11], v[48:63]
    v_exp_f32 v21, v21
    v_exp_f32 v22, v22
    v_exp_f32 v23, v23
    v_exp_f32 v24, v24
    v_exp_f32 v25, v25
    v_smfmac_f32_32x32x32_bf16 v[64:79], v[144:147], v[16:23], v4
    v_exp_f32 v26, v26
    v_exp_f32 v27, v27
    v_exp_f32 v28, v28
    v_exp_f32 v29, v29
    v_exp_f32 v30, v30
    v_exp_f32 v31, v31
    v_exp_f32 v32, v32
    v_exp_f32 v33, v33
    v_smfmac_f32_32x32x32_bf16 v[64:79], v[148:151], v[24:31], v4
    v_exp_f32 v34, v34
    v_exp_f32 v35, v35
    v_exp_f32 v36, v36
    s_waitcnt lgkmcnt(0)
    v_mfma_f32_32x32x16_bf16 v[16:31], v[12:15], v[8:11], v[48:63]
    ds_read_b128 v[12:15], v2 offset:8192
    v_exp_f32 v37, v37
    v_exp_f32 v38, v38
    v_exp_f32 v39, v39
    v_exp_f32 v40, v40
    v_exp_f32 v41, v41
    v_smfmac_f32_32x32x32_bf16 v[64:79], v[152:155], v[32:39], v4
    v_exp_f32 v42, v42
    v_exp_f32 v43, v43
    v_exp_f32 v44, v44
    v_exp_f32 v45, v45
    v_exp_f32 v46, v46
    v_exp_f32 v47, v47
    v_exp_f32 v16, v16
    v_exp_f32 v17, v17
    v_smfmac_f32_32x32x32_bf16 v[64:79], v[156:159], v[40:47], v4
    v_exp_f32 v18, v18
    v_exp_f32 v19, v19
    v_exp_f32 v20, v20
    v_mfma_f32_32x32x16_bf16 v[32:47], v[92:95], v[8:11], v[48:63]
    v_exp_f32 v21, v21
    v_exp_f32 v22, v22
    v_exp_f32 v23, v23
    v_exp_f32 v24, v24
    v_exp_f32 v25, v25
    v_smfmac_f32_32x32x32_bf16 v[64:79], v[160:163], v[16:23], v4
    v_exp_f32 v26, v26
    v_exp_f32 v27, v27
    v_exp_f32 v28, v28
    v_exp_f32 v29, v29
    v_exp_f32 v30, v30
    v_exp_f32 v31, v31
    v_exp_f32 v32, v32
    v_exp_f32 v33, v33
    v_smfmac_f32_32x32x32_bf16 v[64:79], v[164:167], v[24:31], v4
    v_exp_f32 v34, v34
    v_exp_f32 v35, v35
    v_exp_f32 v36, v36
    v_mfma_f32_32x32x16_bf16 v[16:31], v[96:99], v[8:11], v[48:63]
    v_exp_f32 v37, v37
    v_exp_f32 v38, v38
    v_exp_f32 v39, v39
    v_exp_f32 v40, v40
    v_exp_f32 v41, v41
    v_smfmac_f32_32x32x32_bf16 v[64:79], v[168:171], v[32:39], v4
    v_exp_f32 v42, v42
    v_exp_f32 v43, v43
    v_exp_f32 v44, v44
    v_exp_f32 v45, v45
    v_exp_f32 v46, v46
    v_exp_f32 v47, v47
    v_exp_f32 v16, v16
    v_exp_f32 v17, v17
    v_smfmac_f32_32x32x32_bf16 v[64:79], v[172:175], v[40:47], v4
    v_exp_f32 v18, v18
    v_exp_f32 v19, v19
    v_exp_f32 v20, v20
    v_mfma_f32_32x32x16_bf16 v[32:47], v[100:103], v[8:11], v[48:63]
    v_exp_f32 v21, v21
    v_exp_f32 v22, v22
    v_exp_f32 v23, v23
    v_exp_f32 v24, v24
    v_exp_f32 v25, v25
    v_smfmac_f32_32x32x32_bf16 v[64:79], v[176:179], v[16:23], v4
    v_exp_f32 v26, v26
    v_exp_f32 v27, v27
    v_exp_f32 v28, v28
    v_exp_f32 v29, v29
    v_exp_f32 v30, v30
    v_exp_f32 v31, v31
    v_exp_f32 v32, v32
    v_exp_f32 v33, v33
    v_smfmac_f32_32x32x32_bf16 v[64:79], v[180:183], v[24:31], v4
    v_exp_f32 v34, v34
    v_exp_f32 v35, v35
    v_exp_f32 v36, v36
    s_waitcnt lgkmcnt(0)
    v_mfma_f32_32x32x16_bf16 v[16:31], v[12:15], v[8:11], v[48:63]
    ds_read_b128 v[12:15], v2 offset:9216
    v_exp_f32 v37, v37
    v_exp_f32 v38, v38
    v_exp_f32 v39, v39
    v_exp_f32 v40, v40
    v_exp_f32 v41, v41
    v_smfmac_f32_32x32x32_bf16 v[64:79], v[184:187], v[32:39], v4
    v_exp_f32 v42, v42
    v_exp_f32 v43, v43
    v_exp_f32 v44, v44
    v_exp_f32 v45, v45
    v_exp_f32 v46, v46
    v_exp_f32 v47, v47
    v_exp_f32 v16, v16
    v_exp_f32 v17, v17
    v_smfmac_f32_32x32x32_bf16 v[64:79], v[188:191], v[40:47], v4
    v_exp_f32 v18, v18
    v_exp_f32 v19, v19
    v_exp_f32 v20, v20
    v_mfma_f32_32x32x16_bf16 v[32:47], v[104:107], v[8:11], v[48:63]
    v_exp_f32 v21, v21
    v_exp_f32 v22, v22
    v_exp_f32 v23, v23
    v_exp_f32 v24, v24
    v_exp_f32 v25, v25
    v_smfmac_f32_32x32x32_bf16 v[64:79], v[192:195], v[16:23], v4
    v_exp_f32 v26, v26
    v_exp_f32 v27, v27
    v_exp_f32 v28, v28
    v_exp_f32 v29, v29
    v_exp_f32 v30, v30
    v_exp_f32 v31, v31
    v_exp_f32 v32, v32
    v_exp_f32 v33, v33
    v_smfmac_f32_32x32x32_bf16 v[64:79], v[196:199], v[24:31], v4
    v_exp_f32 v34, v34
    v_exp_f32 v35, v35
    v_exp_f32 v36, v36
    v_mfma_f32_32x32x16_bf16 v[16:31], v[108:111], v[8:11], v[48:63]
    v_exp_f32 v37, v37
    v_exp_f32 v38, v38
    v_exp_f32 v39, v39
    v_exp_f32 v40, v40
    v_exp_f32 v41, v41
    v_smfmac_f32_32x32x32_bf16 v[64:79], v[200:203], v[32:39], v4
    v_exp_f32 v42, v42
    v_exp_f32 v43, v43
    v_exp_f32 v44, v44
    v_exp_f32 v45, v45
    v_exp_f32 v46, v46
    v_exp_f32 v47, v47
    v_exp_f32 v16, v16
    v_exp_f32 v17, v17
    v_smfmac_f32_32x32x32_bf16 v[64:79], v[204:207], v[40:47], v4
    v_exp_f32 v18, v18
    v_exp_f32 v19, v19
    v_exp_f32 v20, v20
    v_mfma_f32_32x32x16_bf16 v[32:47], v[112:115], v[8:11], v[48:63]
    v_exp_f32 v21, v21
    v_exp_f32 v22, v22
    v_exp_f32 v23, v23
    v_exp_f32 v24, v24
    v_exp_f32 v25, v25
    v_smfmac_f32_32x32x32_bf16 v[64:79], v[208:211], v[16:23], v4
    v_exp_f32 v26, v26
    v_exp_f32 v27, v27
    v_exp_f32 v28, v28
    v_exp_f32 v29, v29
    v_exp_f32 v30, v30
    v_exp_f32 v31, v31
    v_exp_f32 v32, v32
    v_exp_f32 v33, v33
    v_smfmac_f32_32x32x32_bf16 v[64:79], v[212:215], v[24:31], v4
    v_exp_f32 v34, v34
    v_exp_f32 v35, v35
    v_exp_f32 v36, v36
    s_waitcnt lgkmcnt(0)
    v_mfma_f32_32x32x16_bf16 v[16:31], v[12:15], v[8:11], v[48:63]
    ds_read_b128 v[12:15], v2 offset:0
    v_exp_f32 v37, v37
    v_exp_f32 v38, v38
    v_exp_f32 v39, v39
    v_exp_f32 v40, v40
    v_exp_f32 v41, v41
    v_smfmac_f32_32x32x32_bf16 v[64:79], v[216:219], v[32:39], v4
    v_exp_f32 v42, v42
    v_exp_f32 v43, v43
    v_exp_f32 v44, v44
    v_exp_f32 v45, v45
    v_exp_f32 v46, v46
    v_exp_f32 v47, v47
    v_exp_f32 v16, v16
    v_exp_f32 v17, v17
    v_smfmac_f32_32x32x32_bf16 v[64:79], v[220:223], v[40:47], v4
    v_exp_f32 v18, v18
    v_exp_f32 v19, v19
    v_exp_f32 v20, v20
    v_mfma_f32_32x32x16_bf16 v[32:47], v[116:119], v[8:11], v[48:63]
    v_exp_f32 v21, v21
    v_exp_f32 v22, v22
    v_exp_f32 v23, v23
    v_exp_f32 v24, v24
    v_exp_f32 v25, v25
    v_smfmac_f32_32x32x32_bf16 v[64:79], v[224:227], v[16:23], v4
    v_exp_f32 v26, v26
    v_exp_f32 v27, v27
    v_exp_f32 v28, v28
    v_exp_f32 v29, v29
    v_exp_f32 v30, v30
    v_exp_f32 v31, v31
    v_exp_f32 v32, v32
    v_exp_f32 v33, v33
    v_smfmac_f32_32x32x32_bf16 v[64:79], v[228:231], v[24:31], v4
    v_exp_f32 v34, v34
    v_exp_f32 v35, v35
    v_exp_f32 v36, v36
    v_mfma_f32_32x32x16_bf16 v[16:31], v[120:123], v[8:11], v[48:63]
    v_exp_f32 v37, v37
    v_exp_f32 v38, v38
    v_exp_f32 v39, v39
    v_exp_f32 v40, v40
    v_exp_f32 v41, v41
    v_smfmac_f32_32x32x32_bf16 v[64:79], v[232:235], v[32:39], v4
    v_exp_f32 v42, v42
    v_exp_f32 v43, v43
    v_exp_f32 v44, v44
    v_exp_f32 v45, v45
    v_exp_f32 v46, v46
    v_exp_f32 v47, v47
    v_exp_f32 v16, v16
    v_exp_f32 v17, v17
    v_smfmac_f32_32x32x32_bf16 v[64:79], v[236:239], v[40:47], v4
    v_exp_f32 v18, v18
    v_exp_f32 v19, v19
    v_exp_f32 v20, v20
    v_mfma_f32_32x32x16_bf16 v[32:47], v[124:127], v[8:11], v[48:63]
    v_exp_f32 v21, v21
    v_exp_f32 v22, v22
    v_exp_f32 v23, v23
    v_exp_f32 v24, v24
    v_exp_f32 v25, v25
    v_smfmac_f32_32x32x32_bf16 v[64:79], v[240:243], v[16:23], v4
    ds_read_b128 v[8:11], v7 offset:6144
    ds_read_b128 v[48:51], v6 offset:3072
    ds_read_b128 v[52:55], v6 offset:3072
    ds_read_b128 v[56:59], v6 offset:3072
    ds_read_b128 v[60:63], v6 offset:3072
    ds_read_b32 v5, v6 offset:4112
    v_exp_f32 v26, v26
    v_exp_f32 v27, v27
    v_exp_f32 v28, v28
    v_exp_f32 v29, v29
    v_exp_f32 v30, v30
    v_exp_f32 v31, v31
    v_exp_f32 v32, v32
    v_exp_f32 v33, v33
    v_smfmac_f32_32x32x32_bf16 v[64:79], v[244:247], v[24:31], v4
    v_exp_f32 v34, v34
    v_exp_f32 v35, v35
    v_exp_f32 v36, v36
    s_waitcnt lgkmcnt(0)
    v_mfma_f32_32x32x16_bf16 v[16:31], v[12:15], v[8:11], v[48:63]
    ds_read_b128 v[12:15], v2 offset:1024
    v_exp_f32 v37, v37
    v_exp_f32 v38, v38
    v_exp_f32 v39, v39
    v_exp_f32 v40, v40
    v_exp_f32 v41, v41
    v_smfmac_f32_32x32x32_bf16 v[64:79], v[248:251], v[32:39], v4
    v_exp_f32 v42, v42
    v_exp_f32 v43, v43
    v_exp_f32 v44, v44
    v_exp_f32 v45, v45
    v_exp_f32 v46, v46
    v_exp_f32 v47, v47
    v_exp_f32 v16, v16
    v_exp_f32 v17, v17
    v_smfmac_f32_32x32x32_bf16 v[64:79], v[252:255], v[40:47], v4
    v_exp_f32 v18, v18
    v_exp_f32 v19, v19
    v_exp_f32 v20, v20
    v_mfma_f32_32x32x16_bf16 v[32:47], v[80:83], v[8:11], v[48:63]
    v_exp_f32 v21, v21
    v_exp_f32 v22, v22
    v_readfirstlane_b32 s6, v5
    v_exp_f32 v23, v23
    v_exp_f32 v24, v24
    s_cmp_lt_u32 s6, 4
    s_cbranch_scc1 A_chk
A_back:
    v_exp_f32 v25, v25
    v_mov_b32 v5, v4
    v_exp_f32 v26, v26
    v_exp_f32 v27, v27
    v_exp_f32 v28, v28
    ds_write_b128 v3, v[64:67] offset:40960
    ds_write_b128 v3, v[68:71] offset:41984
    ds_write_addtid_b32 v72 offset:54272
    v_mfma_f32_32x32x8_bf16 v[64:79], v[0:1], v[4:5], 0
    v_exp_f32 v29, v29
    v_exp_f32 v30, v30
    v_exp_f32 v31, v31
    v_smfmac_f32_32x32x32_bf16 v[64:79], v[128:131], v[16:23], v4
    v_exp_f32 v32, v32
    v_exp_f32 v33, v33
    v_exp_f32 v34, v34
    v_smfmac_f32_32x32x32_bf16 v[64:79], v[132:135], v[24:31], v4
    v_exp_f32 v35, v35
    v_exp_f32 v36, v36
    v_mfma_f32_32x32x16_bf16 v[16:31], v[84:87], v[8:11], v[48:63]
    v_exp_f32 v37, v37
    v_exp_f32 v38, v38
    v_exp_f32 v39, v39
    v_exp_f32 v40, v40
    v_exp_f32 v41, v41
    v_smfmac_f32_32x32x32_bf16 v[64:79], v[136:139], v[32:39], v4
    v_exp_f32 v42, v42
    v_exp_f32 v43, v43
    v_exp_f32 v44, v44
    v_exp_f32 v45, v45
    v_exp_f32 v46, v46
    v_exp_f32 v47, v47
    v_exp_f32 v16, v16
    v_exp_f32 v17, v17
    v_smfmac_f32_32x32x32_bf16 v[64:79], v[140:143], v[40:47], v4
    v_exp_f32 v18, v18
    v_exp_f32 v19, v19
    v_exp_f32 v20, v20
    v_mfma_f32_32x32x16_bf16 v[32:47], v[88:91], v[8:11], v[48:63]
    v_exp_f32 v21, v21
    v_exp_f32 v22, v22
    v_exp_f32 v23, v23
    v_exp_f32 v24, v24
    v_exp_f32 v25, v25
    v_smfmac_f32_32x32x32_bf16 v[64:79], v[144:147], v[16:23], v4
    v_exp_f32 v26, v26
    v_exp_f32 v27, v27
    v_exp_f32 v28, v28
    v_exp_f32 v29, v29
    v_exp_f32 v30, v30
    v_exp_f32 v31, v31
    v_exp_f32 v32, v32
    v_exp_f32 v33, v33
    v_smfmac_f32_32x32x32_bf16 v[64:79], v[148:151], v[24:31], v4
    v_exp_f32 v34, v34
    v_exp_f32 v35, v35
    v_exp_f32 v36, v36
    s_waitcnt lgkmcnt(0)
    v_mfma_f32_32x32x16_bf16 v[16:31], v[12:15], v[8:11], v[48:63]
    ds_read_b128 v[12:15], v2 offset:8192
    v_exp_f32 v37, v37
    v_exp_f32 v38, v38
    v_exp_f32 v39, v39
    v_exp_f32 v40, v40
    v_exp_f32 v41, v41
    v_smfmac_f32_32x32x32_bf16 v[64:79], v[152:155], v[32:39], v4
    v_exp_f32 v42, v42
    v_exp_f32 v43, v43
    v_exp_f32 v44, v44
    v_exp_f32 v45, v45
    v_exp_f32 v46, v46
    v_exp_f32 v47, v47
    v_exp_f32 v16, v16
    v_exp_f32 v17, v17
    v_smfmac_f32_32x32x32_bf16 v[64:79], v[156:159], v[40:47], v4
    v_exp_f32 v18, v18
    v_exp_f32 v19, v19
    v_exp_f32 v20, v20
    v_mfma_f32_32x32x16_bf16 v[32:47], v[92:95], v[8:11], v[48:63]
    v_exp_f32 v21, v21
    v_exp_f32 v22, v22
    v_exp_f32 v23, v23
    v_exp_f32 v24, v24
    v_exp_f32 v25, v25
    v_smfmac_f32_32x32x32_bf16 v[64:79], v[160:163], v[16:23], v4
    v_exp_f32 v26, v26
    v_exp_f32 v27, v27
    v_exp_f32 v28, v28
    v_exp_f32 v29, v29
    v_exp_f32 v30, v30
    v_exp_f32 v31, v31
    v_exp_f32 v32, v32
    v_exp_f32 v33, v33
    v_smfmac_f32_32x32x32_bf16 v[64:79], v[164:167], v[24:31], v4
    v_exp_f32 v34, v34
    v_exp_f32 v35, v35
    v_exp_f32 v36, v36
    v_mfma_f32_32x32x16_bf16 v[16:31], v[96:99], v[8:11], v[48:63]
    v_exp_f32 v37, v37
    v_exp_f32 v38, v38
    v_exp_f32 v39, v39
    v_exp_f32 v40, v40
    v_exp_f32 v41, v41
    v_smfmac_f32_32x32x32_bf16 v[64:79], v[168:171], v[32:39], v4
    v_exp_f32 v42, v42
    v_exp_f32 v43, v43
    v_exp_f32 v44, v44
    v_exp_f32 v45, v45
    v_exp_f32 v46, v46
    v_exp_f32 v47, v47
    v_exp_f32 v16, v16
    v_exp_f32 v17, v17
    v_smfmac_f32_32x32x32_bf16 v[64:79], v[172:175], v[40:47], v4
    v_exp_f32 v18, v18
    v_exp_f32 v19, v19
    v_exp_f32 v20, v20
    v_mfma_f32_32x32x16_bf16 v[32:47], v[100:103], v[8:11], v[48:63]
    v_exp_f32 v21, v21
    v_exp_f32 v22, v22
    v_exp_f32 v23, v23
    v_exp_f32 v24, v24
    v_exp_f32 v25, v25
    v_smfmac_f32_32x32x32_bf16 v[64:79], v[176:179], v[16:23], v4
    v_exp_f32 v26, v26
    v_exp_f32 v27, v27
    v_exp_f32 v28, v28
    v_exp_f32 v29, v29
    v_exp_f32 v30, v30
    v_exp_f32 v31, v31
    v_exp_f32 v32, v32
    v_exp_f32 v33, v33
    v_smfmac_f32_32x32x32_bf16 v[64:79], v[180:183], v[24:31], v4
    v_exp_f32 v34, v34
    v_exp_f32 v35, v35
    v_exp_f32 v36, v36
    s_waitcnt lgkmcnt(0)
    v_mfma_f32_32x32x16_bf16 v[16:31], v[12:15], v[8:11], v[48:63]
    ds_read_b128 v[12:15], v2 offset:9216
    v_exp_f32 v37, v37
    v_exp_f32 v38, v38
    v_exp_f32 v39, v39
    v_exp_f32 v40, v40
    v_exp_f32 v41, v41
    v_smfmac_f32_32x32x32_bf16 v[64:79], v[184:187], v[32:39], v4
    v_exp_f32 v42, v42
    v_exp_f32 v43, v43
    v_exp_f32 v44, v44
    v_exp_f32 v45, v45
    v_exp_f32 v46, v46
    v_exp_f32 v47, v47
    v_exp_f32 v16, v16
    v_exp_f32 v17, v17
    v_smfmac_f32_32x32x32_bf16 v[64:79], v[188:191], v[40:47], v4
    v_exp_f32 v18, v18
    v_exp_f32 v19, v19
    v_exp_f32 v20, v20
    v_mfma_f32_32x32x16_bf16 v[32:47], v[104:107], v[8:11], v[48:63]
    v_exp_f32 v21, v21
    v_exp_f32 v22, v22
    v_exp_f32 v23, v23
    v_exp_f32 v24, v24
    v_exp_f32 v25, v25
    v_smfmac_f32_32x32x32_bf16 v[64:79], v[192:195], v[16:23], v4
    v_exp_f32 v26, v26
    v_exp_f32 v27, v27
    v_exp_f32 v28, v28
    v_exp_f32 v29, v29
    v_exp_f32 v30, v30
    v_exp_f32 v31, v31
    v_exp_f32 v32, v32
    v_exp_f32 v33, v33
    v_smfmac_f32_32x32x32_bf16 v[64:79], v[196:199], v[24:31], v4
    v_exp_f32 v34, v34
    v_exp_f32 v35, v35
    v_exp_f32 v36, v36
    v_mfma_f32_32x32x16_bf16 v[16:31], v[108:111], v[8:11], v[48:63]
    v_exp_f32 v37, v37
    v_exp_f32 v38, v38
    v_exp_f32 v39, v39
    v_exp_f32 v40, v40
    v_exp_f32 v41, v41
    v_smfmac_f32_32x32x32_bf16 v[64:79], v[200:203], v[32:39], v4
    v_exp_f32 v42, v42
    v_exp_f32 v43, v43
    v_exp_f32 v44, v44
    v_exp_f32 v45, v45
    v_exp_f32 v46, v46
    v_exp_f32 v47, v47
    v_exp_f32 v16, v16
    v_exp_f32 v17, v17
    v_smfmac_f32_32x32x32_bf16 v[64:79], v[204:207], v[40:47], v4
    v_exp_f32 v18, v18
    v_exp_f32 v19, v19
    v_exp_f32 v20, v20
    v_mfma_f32_32x32x16_bf16 v[32:47], v[112:115], v[8:11], v[48:63]
    v_exp_f32 v21, v21
    v_exp_f32 v22, v22
    v_exp_f32 v23, v23
    v_exp_f32 v24, v24
    v_exp_f32 v25, v25
    v_smfmac_f32_32x32x32_bf16 v[64:79], v[208:211], v[16:23], v4
    v_exp_f32 v26, v26
    v_exp_f32 v27, v27
    v_exp_f32 v28, v28
    v_exp_f32 v29, v29
    v_exp_f32 v30, v30
    v_exp_f32 v31, v31
    v_exp_f32 v32, v32
    v_exp_f32 v33, v33
    v_smfmac_f32_32x32x32_bf16 v[64:79], v[212:215], v[24:31], v4
    v_exp_f32 v34, v34
    v_exp_f32 v35, v35
    v_exp_f32 v36, v36
    s_waitcnt lgkmcnt(0)
    v_mfma_f32_32x32x16_bf16 v[16:31], v[12:15], v[8:11], v[48:63]
    ds_read_b128 v[12:15], v2 offset:0
    v_exp_f32 v37, v37
    v_exp_f32 v38, v38
    v_exp_f32 v39, v39
    v_exp_f32 v40, v40
    v_exp_f32 v41, v41
    v_smfmac_f32_32x32x32_bf16 v[64:79], v[216:219], v[32:39], v4
    v_exp_f32 v42, v42
    v_exp_f32 v43, v43
    v_exp_f32 v44, v44
    v_exp_f32 v45, v45
    v_exp_f32 v46, v46
    v_exp_f32 v47, v47
    v_exp_f32 v16, v16
    v_exp_f32 v17, v17
    v_smfmac_f32_32x32x32_bf16 v[64:79], v[220:223], v[40:47], v4
    v_exp_f32 v18, v18
    v_exp_f32 v19, v19
    v_exp_f32 v20, v20
    v_mfma_f32_32x32x16_bf16 v[32:47], v[116:119], v[8:11], v[48:63]
    v_exp_f32 v21, v21
    v_exp_f32 v22, v22
    v_exp_f32 v23, v23
    v_exp_f32 v24, v24
    v_exp_f32 v25, v25
    v_smfmac_f32_32x32x32_bf16 v[64:79], v[224:227], v[16:23], v4
    v_exp_f32 v26, v26
    v_exp_f32 v27, v27
    v_exp_f32 v28, v28
    v_exp_f32 v29, v29
    v_exp_f32 v30, v30
    v_exp_f32 v31, v31
    v_exp_f32 v32, v32
    v_exp_f32 v33, v33
    v_smfmac_f32_32x32x32_bf16 v[64:79], v[228:231], v[24:31], v4
    v_exp_f32 v34, v34
    v_exp_f32 v35, v35
    v_exp_f32 v36, v36
    v_mfma_f32_32x32x16_bf16 v[16:31], v[120:123], v[8:11], v[48:63]
    v_exp_f32 v37, v37
    v_exp_f32 v38, v38
    v_exp_f32 v39, v39
    v_exp_f32 v40, v40
    v_exp_f32 v41, v41
    v_smfmac_f32_32x32x32_bf16 v[64:79], v[232:235], v[32:39], v4
    v_exp_f32 v42, v42
    v_exp_f32 v43, v43
    v_exp_f32 v44, v44
    v_exp_f32 v45, v45
    v_exp_f32 v46, v46
    v_exp_f32 v47, v47
    v_exp_f32 v16, v16
    v_exp_f32 v17, v17
    v_smfmac_f32_32x32x32_bf16 v[64:79], v[236:239], v[40:47], v4
    v_exp_f32 v18, v18
    v_exp_f32 v19, v19
    v_exp_f32 v20, v20
    v_mfma_f32_32x32x16_bf16 v[32:47], v[124:127], v[8:11], v[48:63]
    v_exp_f32 v21, v21
    v_exp_f32 v22, v22
    v_exp_f32 v23, v23
    v_exp_f32 v24, v24
    v_exp_f32 v25, v25
    v_smfmac_f32_32x32x32_bf16 v[64:79], v[240:243], v[16:23], v4
    ds_read_b128 v[8:11], v7 offset:7168
    ds_read_b128 v[48:51], v6 offset:3584
    ds_read_b128 v[52:55], v6 offset:3584
    ds_read_b128 v[56:59], v6 offset:3584
    ds_read_b128 v[60:63], v6 offset:3584
    v_exp_f32 v26, v26
    v_exp_f32 v27, v27
    v_exp_f32 v28, v28
    v_exp_f32 v29, v29
    v_exp_f32 v30, v30
    v_exp_f32 v31, v31
    v_exp_f32 v32, v32
    v_exp_f32 v33, v33
    v_smfmac_f32_32x32x32_bf16 v[64:79], v[244:247], v[24:31], v4
    v_exp_f32 v34, v34
    v_exp_f32 v35, v35
    v_exp_f32 v36, v36
    s_waitcnt lgkmcnt(0)
    v_mfma_f32_32x32x16_bf16 v[16:31], v[12:15], v[8:11], v[48:63]
    ds_read_b128 v[12:15], v2 offset:1024
    v_exp_f32 v37, v37
    v_exp_f32 v38, v38
    v_exp_f32 v39, v39
    v_exp_f32 v40, v40
    v_exp_f32 v41, v41
    v_smfmac_f32_32x32x32_bf16 v[64:79], v[248:251], v[32:39], v4
    v_exp_f32 v42, v42
    v_exp_f32 v43, v43
    v_exp_f32 v44, v44
    v_exp_f32 v45, v45
    v_exp_f32 v46, v46
    v_exp_f32 v47, v47
    v_exp_f32 v16, v16
    v_exp_f32 v17, v17
    v_smfmac_f32_32x32x32_bf16 v[64:79], v[252:255], v[40:47], v4
    v_exp_f32 v18, v18
    v_exp_f32 v19, v19
    v_exp_f32 v20, v20
    v_mfma_f32_32x32x16_bf16 v[32:47], v[80:83], v[8:11], v[48:63]
    v_exp_f32 v21, v21
    v_exp_f32 v22, v22
    v_exp_f32 v23, v23
    v_exp_f32 v24, v24
    v_exp_f32 v25, v25
    v_exp_f32 v26, v26
    v_exp_f32 v27, v27
    v_exp_f32 v28, v28
    ds_write_b128 v3, v[64:67] offset:49152
    ds_write_b128 v3, v[68:71] offset:50176
    ds_write_addtid_b32 v72 offset:55296
    v_mfma_f32_32x32x8_bf16 v[64:79], v[0:1], v[4:5], 0
    v_exp_f32 v29, v29
    v_exp_f32 v30, v30
    v_exp_f32 v31, v31
    v_smfmac_f32_32x32x32_bf16 v[64:79], v[128:131], v[16:23], v4
    v_exp_f32 v32, v32
    v_exp_f32 v33, v33
    v_exp_f32 v34, v34
    v_smfmac_f32_32x32x32_bf16 v[64:79], v[132:135], v[24:31], v4
    v_exp_f32 v35, v35
    v_exp_f32 v36, v36
    v_mfma_f32_32x32x16_bf16 v[16:31], v[84:87], v[8:11], v[48:63]
    v_exp_f32 v37, v37
    v_exp_f32 v38, v38
    v_exp_f32 v39, v39
    v_exp_f32 v40, v40
    v_exp_f32 v41, v41
    v_smfmac_f32_32x32x32_bf16 v[64:79], v[136:139], v[32:39], v4
    v_exp_f32 v42, v42
    v_exp_f32 v43, v43
    v_exp_f32 v44, v44
    v_exp_f32 v45, v45
    v_exp_f32 v46, v46
    v_exp_f32 v47, v47
    v_exp_f32 v16, v16
    v_exp_f32 v17, v17
    v_smfmac_f32_32x32x32_bf16 v[64:79], v[140:143], v[40:47], v4
    v_exp_f32 v18, v18
    v_exp_f32 v19, v19
    v_exp_f32 v20, v20
    v_mfma_f32_32x32x16_bf16 v[32:47], v[88:91], v[8:11], v[48:63]
    v_exp_f32 v21, v21
    v_exp_f32 v22, v22
    v_exp_f32 v23, v23
    v_exp_f32 v24, v24
    v_exp_f32 v25, v25
    v_smfmac_f32_32x32x32_bf16 v[64:79], v[144:147], v[16:23], v4
    v_exp_f32 v26, v26
    v_exp_f32 v27, v27
    v_exp_f32 v28, v28
    v_exp_f32 v29, v29
    v_exp_f32 v30, v30
    v_exp_f32 v31, v31
    v_exp_f32 v32, v32
    v_exp_f32 v33, v33
    v_smfmac_f32_32x32x32_bf16 v[64:79], v[148:151], v[24:31], v4
    v_exp_f32 v34, v34
    v_exp_f32 v35, v35
    v_exp_f32 v36, v36
    s_waitcnt lgkmcnt(0)
    v_mfma_f32_32x32x16_bf16 v[16:31], v[12:15], v[8:11], v[48:63]
    ds_read_b128 v[12:15], v2 offset:8192
    v_exp_f32 v37, v37
    v_exp_f32 v38, v38
    v_exp_f32 v39, v39
    v_exp_f32 v40, v40
    v_exp_f32 v41, v41
    v_smfmac_f32_32x32x32_bf16 v[64:79], v[152:155], v[32:39], v4
    v_exp_f32 v42, v42
    v_exp_f32 v43, v43
    v_exp_f32 v44, v44
    v_exp_f32 v45, v45
    v_exp_f32 v46, v46
    v_exp_f32 v47, v47
    v_exp_f32 v16, v16
    v_exp_f32 v17, v17
    v_smfmac_f32_32x32x32_bf16 v[64:79], v[156:159], v[40:47], v4
    v_exp_f32 v18, v18
    v_exp_f32 v19, v19
    v_exp_f32 v20, v20
    v_mfma_f32_32x32x16_bf16 v[32:47], v[92:95], v[8:11], v[48:63]
    v_exp_f32 v21, v21
    v_exp_f32 v22, v22
    v_exp_f32 v23, v23
    v_exp_f32 v24, v24
    v_exp_f32 v25, v25
    v_smfmac_f32_32x32x32_bf16 v[64:79], v[160:163], v[16:23], v4
    v_exp_f32 v26, v26
    v_exp_f32 v27, v27
    v_exp_f32 v28, v28
    v_exp_f32 v29, v29
    v_exp_f32 v30, v30
    v_exp_f32 v31, v31
    v_exp_f32 v32, v32
    v_exp_f32 v33, v33
    v_smfmac_f32_32x32x32_bf16 v[64:79], v[164:167], v[24:31], v4
    v_exp_f32 v34, v34
    v_exp_f32 v35, v35
    v_exp_f32 v36, v36
    v_mfma_f32_32x32x16_bf16 v[16:31], v[96:99], v[8:11], v[48:63]
    v_exp_f32 v37, v37
    v_exp_f32 v38, v38
    v_exp_f32 v39, v39
    v_exp_f32 v40, v40
    v_exp_f32 v41, v41
    v_smfmac_f32_32x32x32_bf16 v[64:79], v[168:171], v[32:39], v4
    v_exp_f32 v42, v42
    v_exp_f32 v43, v43
    v_exp_f32 v44, v44
    v_exp_f32 v45, v45
    v_exp_f32 v46, v46
    v_exp_f32 v47, v47
    v_exp_f32 v16, v16
    v_exp_f32 v17, v17
    v_smfmac_f32_32x32x32_bf16 v[64:79], v[172:175], v[40:47], v4
    v_exp_f32 v18, v18
    v_exp_f32 v19, v19
    v_exp_f32 v20, v20
    v_mfma_f32_32x32x16_bf16 v[32:47], v[100:103], v[8:11], v[48:63]
    v_exp_f32 v21, v21
    v_exp_f32 v22, v22
    v_exp_f32 v23, v23
    v_exp_f32 v24, v24
    v_exp_f32 v25, v25
    v_smfmac_f32_32x32x32_bf16 v[64:79], v[176:179], v[16:23], v4
    v_exp_f32 v26, v26
    v_exp_f32 v27, v27
    v_exp_f32 v28, v28
    v_exp_f32 v29, v29
    v_exp_f32 v30, v30
    v_exp_f32 v31, v31
    v_exp_f32 v32, v32
    v_exp_f32 v33, v33
    v_smfmac_f32_32x32x32_bf16 v[64:79], v[180:183], v[24:31], v4
    v_exp_f32 v34, v34
    v_exp_f32 v35, v35
    v_exp_f32 v36, v36
    s_waitcnt lgkmcnt(0)
    v_mfma_f32_32x32x16_bf16 v[16:31], v[12:15], v[8:11], v[48:63]
    ds_read_b128 v[12:15], v2 offset:9216
    v_exp_f32 v37, v37
    v_exp_f32 v38, v38
    v_exp_f32 v39, v39
    v_exp_f32 v40, v40
    v_exp_f32 v41, v41
    v_smfmac_f32_32x32x32_bf16 v[64:79], v[184:187], v[32:39], v4
    v_exp_f32 v42, v42
    v_exp_f32 v43, v43
    v_exp_f32 v44, v44
    v_exp_f32 v45, v45
    v_exp_f32 v46, v46
    v_exp_f32 v47, v47
    v_exp_f32 v16, v16
    v_exp_f32 v17, v17
    v_smfmac_f32_32x32x32_bf16 v[64:79], v[188:191], v[40:47], v4
    v_exp_f32 v18, v18
    v_exp_f32 v19, v19
    v_exp_f32 v20, v20
    v_mfma_f32_32x32x16_bf16 v[32:47], v[104:107], v[8:11], v[48:63]
    v_exp_f32 v21, v21
    v_exp_f32 v22, v22
    v_exp_f32 v23, v23
    v_exp_f32 v24, v24
    v_exp_f32 v25, v25
    v_smfmac_f32_32x32x32_bf16 v[64:79], v[192:195], v[16:23], v4
    v_exp_f32 v26, v26
    v_exp_f32 v27, v27
    v_exp_f32 v28, v28
    v_exp_f32 v29, v29
    v_exp_f32 v30, v30
    v_exp_f32 v31, v31
    v_exp_f32 v32, v32
    v_exp_f32 v33, v33
    v_smfmac_f32_32x32x32_bf16 v[64:79], v[196:199], v[24:31], v4
    v_exp_f32 v34, v34
    v_exp_f32 v35, v35
    v_exp_f32 v36, v36
    v_mfma_f32_32x32x16_bf16 v[16:31], v[108:111], v[8:11], v[48:63]
    v_exp_f32 v37, v37
    v_exp_f32 v38, v38
    v_exp_f32 v39, v39
    v_exp_f32 v40, v40
    v_exp_f32 v41, v41
    v_smfmac_f32_32x32x32_bf16 v[64:79], v[200:203], v[32:39], v4
    v_exp_f32 v42, v42
    v_exp_f32 v43, v43
    v_exp_f32 v44, v44
    v_exp_f32 v45, v45
    v_exp_f32 v46, v46
    v_exp_f32 v47, v47
    v_exp_f32 v16, v16
    v_exp_f32 v17, v17
    v_smfmac_f32_32x32x32_bf16 v[64:79], v[204:207], v[40:47], v4
    v_exp_f32 v18, v18
    v_exp_f32 v19, v19
    v_exp_f32 v20, v20
    v_mfma_f32_32x32x16_bf16 v[32:47], v[112:115], v[8:11], v[48:63]
    v_exp_f32 v21, v21
    v_exp_f32 v22, v22
    v_exp_f32 v23, v23
    v_exp_f32 v24, v24
    v_exp_f32 v25, v25
    v_smfmac_f32_32x32x32_bf16 v[64:79], v[208:211], v[16:23], v4
    v_exp_f32 v26, v26
    v_exp_f32 v27, v27
    v_exp_f32 v28, v28
    v_exp_f32 v29, v29
    v_exp_f32 v30, v30
    v_exp_f32 v31, v31
    v_exp_f32 v32, v32
    v_exp_f32 v33, v33
    v_smfmac_f32_32x32x32_bf16 v[64:79], v[212:215], v[24:31], v4
    v_exp_f32 v34, v34
    v_exp_f32 v35, v35
    v_exp_f32 v36, v36
    s_waitcnt lgkmcnt(0)
    v_mfma_f32_32x32x16_bf16 v[16:31], v[12:15], v[8:11], v[48:63]
    v_exp_f32 v37, v37
    v_exp_f32 v38, v38
    v_exp_f32 v39, v39
    v_exp_f32 v40, v40
    v_exp_f32 v41, v41
    v_smfmac_f32_32x32x32_bf16 v[64:79], v[216:219], v[32:39], v4
    v_exp_f32 v42, v42
    v_exp_f32 v43, v43
    v_exp_f32 v44, v44
    v_exp_f32 v45, v45
    v_exp_f32 v46, v46
    v_exp_f32 v47, v47
    v_exp_f32 v16, v16
    v_exp_f32 v17, v17
    v_smfmac_f32_32x32x32_bf16 v[64:79], v[220:223], v[40:47], v4
    v_exp_f32 v18, v18
    v_exp_f32 v19, v19
    v_exp_f32 v20, v20
    v_mfma_f32_32x32x16_bf16 v[32:47], v[116:119], v[8:11], v[48:63]
    v_exp_f32 v21, v21
    v_exp_f32 v22, v22
    v_exp_f32 v23, v23
    v_exp_f32 v24, v24
    v_exp_f32 v25, v25
    v_smfmac_f32_32x32x32_bf16 v[64:79], v[224:227], v[16:23], v4
    v_exp_f32 v26, v26
    v_exp_f32 v27, v27
    v_exp_f32 v28, v28
    v_exp_f32 v29, v29
    v_exp_f32 v30, v30
    v_exp_f32 v31, v31
    v_exp_f32 v32, v32
    v_exp_f32 v33, v33
    v_smfmac_f32_32x32x32_bf16 v[64:79], v[228:231], v[24:31], v4
    v_exp_f32 v34, v34
    v_exp_f32 v35, v35
    v_exp_f32 v36, v36
    v_mfma_f32_32x32x16_bf16 v[16:31], v[120:123], v[8:11], v[48:63]
    v_exp_f32 v37, v37
    v_exp_f32 v38, v38
    v_exp_f32 v39, v39
    v_exp_f32 v40, v40
    v_exp_f32 v41, v41
    v_smfmac_f32_32x32x32_bf16 v[64:79], v[232:235], v[32:39], v4
    v_exp_f32 v42, v42
    v_exp_f32 v43, v43
    v_exp_f32 v44, v44
    v_exp_f32 v45, v45
    v_exp_f32 v46, v46
    v_exp_f32 v47, v47
    v_exp_f32 v16, v16
    v_exp_f32 v17, v17
    v_smfmac_f32_32x32x32_bf16 v[64:79], v[236:239], v[40:47], v4
    v_exp_f32 v18, v18
    v_exp_f32 v19, v19
    v_exp_f32 v20, v20
    v_mfma_f32_32x32x16_bf16 v[32:47], v[124:127], v[8:11], v[48:63]
    v_exp_f32 v21, v21
    v_exp_f32 v22, v22
    v_exp_f32 v23, v23
    v_exp_f32 v24, v24
    v_exp_f32 v25, v25
    v_smfmac_f32_32x32x32_bf16 v[64:79], v[240:243], v[16:23], v4
    v_exp_f32 v26, v26
    v_exp_f32 v27, v27
    v_exp_f32 v28, v28
    v_exp_f32 v29, v29
    v_exp_f32 v30, v30
    v_exp_f32 v31, v31
    v_exp_f32 v32, v32
    v_exp_f32 v33, v33
    v_smfmac_f32_32x32x32_bf16 v[64:79], v[244:247], v[24:31], v4
    v_exp_f32 v34, v34
    v_exp_f32 v35, v35
    v_exp_f32 v36, v36
    v_exp_f32 v37, v37
    v_exp_f32 v38, v38
    v_exp_f32 v39, v39
    v_exp_f32 v40, v40
    v_exp_f32 v41, v41
    v_smfmac_f32_32x32x32_bf16 v[64:79], v[248:251], v[32:39], v4
    v_exp_f32 v42, v42
    v_exp_f32 v43, v43
    v_exp_f32 v44, v44
    v_exp_f32 v45, v45
    v_exp_f32 v46, v46
    v_exp_f32 v47, v47
    s_nop 1
    v_smfmac_f32_32x32x32_bf16 v[64:79], v[252:255], v[40:47], v4
    s_nop 11
    ds_write_b128 v2, v[64:67] offset:0
    ds_write_b128 v2, v[68:71] offset:1024
    ds_write_addtid_b32 v72 offset:56320
    s_endpgm
A_chk:
    s_mov_b32 s54, 32768
A_x_top:
    ds_read_b32 v5, v6 offset:4112
    s_waitcnt lgkmcnt(0)
    v_readfirstlane_b32 s6, v5
    s_cmp_ge_u32 s6, 4
    s_cbranch_scc1 A_x_ok
    s_sleep 1
    s_sub_u32 s54, s54, 1
    s_cmp_lg_u32 s54, 0
    s_cbranch_scc1 A_x_top
A_x_ok:
    s_branch A_back
K_exit:
    s_endpgm
.p2align 6
G_start:
    s_and_b32 s6, s2, 7
    s_lshl_b32 s6, s6, 2
    s_lshr_b32 s6, 0x14735260, s6
    s_and_b32 s6, s6, 7
    s_lshr_b32 s7, s2, 3
    s_and_b32 s5, s7, 3
    s_and_b32 s4, s6, 1
    s_lshl2_add_u32 s5, s4, s5
    s_lshr_b32 s6, s6, 1
    s_lshr_b32 s7, s7, 2
    s_lshl3_add_u32 s4, s6, s7
    s_lshl3_add_u32 s30, s4, s5
    v_and_b32 v1, 63, v0
    s_sub_u32 s31, s3, 4
    v_mov_b32 v2, 160768
    v_lshl_add_u32 v12, v1, 2, v2
    v_mov_b32 v13, 0
    ds_write_b32 v12, v13
    v_lshrrev_b32 v8, 3, v1
    v_and_b32 v9, 7, v1
    v_lshrrev_b32 v10, 2, v1
    v_and_b32 v10, 4, v10
    v_xor_b32 v10, v9, v10
    v_lshlrev_b32 v4, 10, v8
    v_lshl_add_u32 v4, v10, 4, v4
    s_lshl_b32 s6, s5, 7
    v_add_u32 v4, s6, v4
    v_mov_b32 v3, 1
    s_mul_i32 s57, s5, 3
    s_cmp_eq_u32 s5, 7
    s_cselect_b32 s57, 20, s57
    s_add_u32 s57, s57, s31
    s_movk_i32 s6, 2752
    v_lshlrev_b32 v13, 4, v9
    v_mad_u32_u24 v5, v8, s6, v13
    s_lshl_b32 s60, s57, 7
    s_and_b32 s59, s4, 7
    s_lshl_b32 s62, s59, 13
    s_lshl_b32 s63, s31, 10
    s_waitcnt lgkmcnt(0)
    s_barrier
    s_add_u32 s6, s28, 3317760
    s_addc_u32 s7, s29, 0
    s_load_dwordx2 s[52:53], s[6:7], 0
    s_mov_b32 s36, s10
    s_and_b32 s37, s11, 0xffff
    s_mov_b32 s38, 524288
    s_mov_b32 s39, 0x20000
    s_mov_b32 s40, s20
    s_and_b32 s41, s21, 0xffff
    s_mov_b32 s42, 1409024
    s_mov_b32 s43, 0x20000
    s_lshr_b32 s6, s5, 1
    s_add_u32 s6, s6, s31
    s_cmp_eq_u32 s6, 5
    s_cselect_b32 s42, 0, s42
    s_cselect_b32 s64, 1, 0
    s_xor_b32 s6, s63, s62
    s_add_u32 m0, s6, 66560
    s_lshl_b32 s6, s6, 3
    buffer_load_dwordx4 v4, s[36:39], s6 offen lds
    s_add_u32 s63, s63, 3072
    s_xor_b32 s6, s63, s62
    s_add_u32 m0, s6, 66560
    s_lshl_b32 s6, s6, 3
    buffer_load_dwordx4 v4, s[36:39], s6 offen lds
    s_add_u32 s63, s63, 3072
    s_xor_b32 s6, s63, s62
    s_add_u32 m0, s6, 66560
    s_lshl_b32 s6, s6, 3
    buffer_load_dwordx4 v4, s[36:39], s6 offen lds
    s_add_u32 s63, s63, 3072
    s_xor_b32 s6, s63, s62
    s_add_u32 m0, s6, 66560
    s_lshl_b32 s6, s6, 3
    buffer_load_dwordx4 v4, s[36:39], s6 offen lds
    s_add_u32 s63, s63, 3072
    s_xor_b32 s6, s63, s62
    s_add_u32 m0, s6, 66560
    s_lshl_b32 s6, s6, 3
    buffer_load_dwordx4 v4, s[36:39], s6 offen lds
    s_add_u32 s63, s63, 3072
    s_xor_b32 s6, s63, s62
    s_add_u32 m0, s6, 66560
    s_lshl_b32 s6, s6, 3
    buffer_load_dwordx4 v4, s[36:39], s6 offen lds
    s_add_u32 s63, s63, 3072
    s_xor_b32 s6, s63, s62
    s_add_u32 m0, s6, 66560
    s_lshl_b32 s6, s6, 3
    buffer_load_dwordx4 v4, s[36:39], s6 offen lds
    s_add_u32 s63, s63, 3072
    s_xor_b32 s6, s63, s62
    s_add_u32 m0, s6, 66560
    s_lshl_b32 s6, s6, 3
    buffer_load_dwordx4 v4, s[36:39], s6 offen lds
    s_add_u32 s63, s63, 3072
    s_xor_b32 s6, s63, s62
    s_add_u32 m0, s6, 66560
    s_lshl_b32 s6, s6, 3
    buffer_load_dwordx4 v4, s[36:39], s6 offen lds
    s_add_u32 s63, s63, 3072
    s_xor_b32 s6, s63, s62
    s_add_u32 m0, s6, 66560
    s_lshl_b32 s6, s6, 3
    buffer_load_dwordx4 v4, s[36:39], s6 offen lds
    s_add_u32 s63, s63, 3072
    s_xor_b32 s6, s63, s62
    s_add_u32 m0, s6, 66560
    s_lshl_b32 s6, s6, 3
    buffer_load_dwordx4 v4, s[36:39], s6 offen lds
    s_add_u32 s63, s63, 3072
    s_xor_b32 s6, s63, s62
    s_add_u32 m0, s6, 66560
    s_lshl_b32 s6, s6, 3
    buffer_load_dwordx4 v4, s[36:39], s6 offen lds
    s_add_u32 s63, s63, 3072
    s_xor_b32 s6, s63, s62
    s_add_u32 m0, s6, 66560
    s_lshl_b32 s6, s6, 3
    buffer_load_dwordx4 v4, s[36:39], s6 offen lds
    s_add_u32 s63, s63, 3072
    s_xor_b32 s6, s63, s62
    s_add_u32 m0, s6, 66560
    s_lshl_b32 s6, s6, 3
    buffer_load_dwordx4 v4, s[36:39], s6 offen lds
    s_add_u32 s63, s63, 3072
    s_xor_b32 s6, s63, s62
    s_add_u32 m0, s6, 66560
    s_lshl_b32 s6, s6, 3
    buffer_load_dwordx4 v4, s[36:39], s6 offen lds
    s_add_u32 s63, s63, 3072
    s_xor_b32 s6, s63, s62
    s_add_u32 m0, s6, 66560
    s_lshl_b32 s6, s6, 3
    buffer_load_dwordx4 v4, s[36:39], s6 offen lds
    s_add_u32 s63, s63, 3072
    s_xor_b32 s6, s63, s62
    s_add_u32 m0, s6, 66560
    s_lshl_b32 s6, s6, 3
    buffer_load_dwordx4 v4, s[36:39], s6 offen lds
    s_add_u32 s63, s63, 3072
    s_xor_b32 s6, s63, s62
    s_add_u32 m0, s6, 66560
    s_lshl_b32 s6, s6, 3
    buffer_load_dwordx4 v4, s[36:39], s6 offen lds
    s_add_u32 s63, s63, 3072
    s_xor_b32 s6, s63, s62
    s_add_u32 m0, s6, 66560
    s_lshl_b32 s6, s6, 3
    buffer_load_dwordx4 v4, s[36:39], s6 offen lds
    s_add_u32 s63, s63, 3072
    s_xor_b32 s6, s63, s62
    s_add_u32 m0, s6, 66560
    s_lshl_b32 s6, s6, 3
    buffer_load_dwordx4 v4, s[36:39], s6 offen lds
    s_add_u32 s63, s63, 3072
    s_xor_b32 s6, s63, s62
    s_add_u32 m0, s6, 66560
    s_lshl_b32 s6, s6, 3
    buffer_load_dwordx4 v4, s[36:39], s6 offen lds
    s_mov_b32 s63, 64512
    s_xor_b32 s6, s63, s62
    s_add_u32 m0, s6, 66560
    s_lshl_b32 s6, s6, 3
    buffer_load_dwordx4 v4, s[36:39], s6 offen lds
    s_mov_b32 s44, s28
    s_and_b32 s45, s29, 0xffff
    s_mov_b32 s46, 16777216
    s_mov_b32 s47, 0x20000
    s_cmp_eq_u32 s64, 1
    s_cbranch_scc1 G_idle
    s_xor_b32 s6, s59, 0
    s_mul_i32 s6, s6, 176128
    s_add_u32 s58, s60, s6
    buffer_load_dwordx4 v[128:131], v5, s[40:43], s58 offen
    s_add_u32 s58, s58, 22016
    buffer_load_dwordx4 v[132:135], v5, s[40:43], s58 offen
    s_add_u32 s58, s58, 22016
    buffer_load_dwordx4 v[136:139], v5, s[40:43], s58 offen
    s_add_u32 s58, s58, 22016
    buffer_load_dwordx4 v[140:143], v5, s[40:43], s58 offen
    s_add_u32 s58, s58, 22016
    buffer_load_dwordx4 v[144:147], v5, s[40:43], s58 offen
    s_add_u32 s58, s58, 22016
    buffer_load_dwordx4 v[148:151], v5, s[40:43], s58 offen
    s_add_u32 s58, s58, 22016
    buffer_load_dwordx4 v[152:155], v5, s[40:43], s58 offen
    s_add_u32 s58, s58, 22016
    buffer_load_dwordx4 v[156:159], v5, s[40:43], s58 offen
    s_xor_b32 s6, s59, 1
    s_mul_i32 s6, s6, 176128
    s_add_u32 s58, s60, s6
    buffer_load_dwordx4 v[160:163], v5, s[40:43], s58 offen
    s_add_u32 s58, s58, 22016
    buffer_load_dwordx4 v[164:167], v5, s[40:43], s58 offen
    s_add_u32 s58, s58, 22016
    buffer_load_dwordx4 v[168:171], v5, s[40:43], s58 offen
    s_add_u32 s58, s58, 22016
    buffer_load_dwordx4 v[172:175], v5, s[40:43], s58 offen
    s_add_u32 s58, s58, 22016
G_f1:
    s_lshl_b32 s6, s31, 12
    s_add_u32 s6, s6, 132096
    v_lshlrev_b32 v6, 7, v8
    v_lshl_add_u32 v6, v10, 4, v6
    v_add_u32 v6, s6, v6
    v_lshrrev_b32 v13, 5, v1
    v_bfe_u32 v14, v1, 2, 2
    v_lshlrev_b32 v7, 10, v13
    v_lshl_add_u32 v7, v14, 7, v7
    v_bfe_u32 v15, v1, 4, 1
    v_lshl_add_u32 v7, v15, 5, v7
    v_and_b32 v15, 3, v1
    v_lshl_add_u32 v7, v15, 3, v7
    v_lshrrev_b32 v14, 1, v14
    v_lshl_add_u32 v7, v14, 6, v7
    v_xor_b32 v11, 64, v7
    v_add_u32 v7, s6, v7
    v_add_u32 v11, s6, v11
    v_and_b32 v14, 31, v1
    v_mul_u32_u24 v12, 1040, v14
    v_lshl_add_u32 v12, v13, 4, v12
    s_xor_b32 s6, s59, 0
    s_lshl_b32 s6, s6, 7
    v_add_u32 v48, s6, v12
    s_xor_b32 s6, s59, 1
    s_lshl_b32 s6, s6, 7
    v_add_u32 v49, s6, v12
    s_xor_b32 s6, s59, 2
    s_lshl_b32 s6, s6, 7
    v_add_u32 v50, s6, v12
    s_xor_b32 s6, s59, 3
    s_lshl_b32 s6, s6, 7
    v_add_u32 v51, s6, v12
    s_xor_b32 s6, s59, 4
    s_lshl_b32 s6, s6, 7
    v_add_u32 v52, s6, v12
    s_xor_b32 s6, s59, 5
    s_lshl_b32 s6, s6, 7
    v_add_u32 v53, s6, v12
    s_xor_b32 s6, s59, 6
    s_lshl_b32 s6, s6, 7
    v_add_u32 v54, s6, v12
    s_xor_b32 s6, s59, 7
    s_lshl_b32 s6, s6, 7
    v_add_u32 v55, s6, v12
    v_mov_b32 v56, -1
    v_mov_b32 v57, -1
    v_mov_b32 v58, -1
    v_mov_b32 v59, -1
    v_lshlrev_b32 v60, 4, v1
    s_lshl1_add_u32 s61, s30, s31
    s_lshl_b32 s61, s61, 12
    s_add_u32 s61, s61, 4194304
    s_waitcnt vmcnt(12)
    s_mov_b64 exec, 1
    ds_add_u32 v2, v3 offset:4
    s_mov_b64 exec, -1
    s_waitcnt vmcnt(11)
    ds_write_b128 v6, v[128:131] offset:0
    s_waitcnt vmcnt(10)
    ds_write_b128 v6, v[132:135] offset:1024
    s_waitcnt vmcnt(9)
    ds_write_b128 v6, v[136:139] offset:2048
    s_waitcnt vmcnt(8)
    ds_write_b128 v6, v[140:143] offset:3072
    ds_read_b64_tr_b16 v[16:17], v7 offset:0
    ds_read_b64_tr_b16 v[18:19], v7 offset:512
    ds_read_b64_tr_b16 v[20:21], v11 offset:0
    ds_read_b64_tr_b16 v[22:23], v11 offset:512
    s_waitcnt lgkmcnt(0)
    buffer_load_dwordx4 v[128:131], v5, s[40:43], s58 offen
    s_add_u32 s58, s58, 22016
    buffer_load_dwordx4 v[132:135], v5, s[40:43], s58 offen
    s_add_u32 s58, s58, 22016
    buffer_load_dwordx4 v[136:139], v5, s[40:43], s58 offen
    s_add_u32 s58, s58, 22016
    buffer_load_dwordx4 v[140:143], v5, s[40:43], s58 offen
    s_add_u32 s52, s52, 1
    s_addc_u32 s53, s53, 0
    s_mov_b32 s54, 32768
G_ln_top:
    ds_read_b32 v61, v2 offset:0
    s_waitcnt lgkmcnt(0)
    v_readfirstlane_b32 s6, v61
    s_cmp_ge_u32 s6, 4
    s_cbranch_scc1 G_ln_ok
    s_sleep 1
    s_sub_u32 s54, s54, 1
    s_cmp_lg_u32 s54, 0
    s_cbranch_scc1 G_ln_top
G_ln_ok:
    ds_read_b128 v[32:35], v48 offset:0
    ds_read_b128 v[36:39], v48 offset:33280
    s_waitcnt lgkmcnt(0)
    v_mfma_f32_32x32x16_bf16 v[64:79], v[16:19], v[32:35], 0
    ds_read_b64_tr_b16 v[24:25], v7 offset:2048
    ds_read_b64_tr_b16 v[26:27], v7 offset:2560
    ds_read_b128 v[40:43], v48 offset:32
    v_mfma_f32_32x32x16_bf16 v[80:95], v[16:19], v[36:39], 0
    ds_read_b64_tr_b16 v[28:29], v11 offset:2048
    ds_read_b64_tr_b16 v[30:31], v11 offset:2560
    ds_read_b128 v[44:47], v48 offset:33312
    v_mfma_f32_32x32x16_bf16 v[96:111], v[20:23], v[32:35], 0
    s_waitcnt vmcnt(11)
    ds_write_b128 v6, v[144:147] offset:0
    s_xor_b32 s6, s59, 2
    s_mul_i32 s6, s6, 176128
    s_add_u32 s58, s60, s6
    buffer_load_dwordx4 v[144:147], v5, s[40:43], s58 offen
    s_add_u32 s58, s58, 22016
    v_mfma_f32_32x32x16_bf16 v[112:127], v[20:23], v[36:39], 0
    s_waitcnt vmcnt(11)
    ds_write_b128 v6, v[148:151] offset:1024
    buffer_load_dwordx4 v[148:151], v5, s[40:43], s58 offen
    s_add_u32 s58, s58, 22016
    s_waitcnt lgkmcnt(2)
    v_mfma_f32_32x32x16_bf16 v[64:79], v[24:27], v[40:43], v[64:79]
    ds_read_b64_tr_b16 v[16:17], v7 offset:0
    ds_read_b64_tr_b16 v[18:19], v7 offset:512
    ds_read_b128 v[32:35], v48 offset:64
    v_mfma_f32_32x32x16_bf16 v[80:95], v[24:27], v[44:47], v[80:95]
    ds_read_b64_tr_b16 v[20:21], v11 offset:0
    ds_read_b64_tr_b16 v[22:23], v11 offset:512
    ds_read_b128 v[36:39], v48 offset:33344
    v_mfma_f32_32x32x16_bf16 v[96:111], v[28:31], v[40:43], v[96:111]
    s_waitcnt vmcnt(11)
    ds_write_b128 v6, v[152:155] offset:2048
    buffer_load_dwordx4 v[152:155], v5, s[40:43], s58 offen
    s_add_u32 s58, s58, 22016
    v_mfma_f32_32x32x16_bf16 v[112:127], v[28:31], v[44:47], v[112:127]
    s_waitcnt vmcnt(11)
    ds_write_b128 v6, v[156:159] offset:3072
    buffer_load_dwordx4 v[156:159], v5, s[40:43], s58 offen
    s_add_u32 s58, s58, 22016
    s_waitcnt lgkmcnt(2)
    v_mfma_f32_32x32x16_bf16 v[64:79], v[16:19], v[32:35], v[64:79]
    ds_read_b64_tr_b16 v[24:25], v7 offset:2048
    ds_read_b64_tr_b16 v[26:27], v7 offset:2560
    ds_read_b128 v[40:43], v48 offset:96
    v_mfma_f32_32x32x16_bf16 v[80:95], v[16:19], v[36:39], v[80:95]
    ds_read_b64_tr_b16 v[28:29], v11 offset:2048
    ds_read_b64_tr_b16 v[30:31], v11 offset:2560
    ds_read_b128 v[44:47], v48 offset:33376
    v_mfma_f32_32x32x16_bf16 v[96:111], v[20:23], v[32:35], v[96:111]
    s_waitcnt vmcnt(11)
    ds_write_b128 v6, v[160:163] offset:0
    buffer_load_dwordx4 v[160:163], v5, s[40:43], s58 offen
    s_add_u32 s58, s58, 22016
    v_mfma_f32_32x32x16_bf16 v[112:127], v[20:23], v[36:39], v[112:127]
    s_waitcnt vmcnt(11)
    ds_write_b128 v6, v[164:167] offset:1024
    buffer_load_dwordx4 v[164:167], v5, s[40:43], s58 offen
    s_add_u32 s58, s58, 22016
    s_waitcnt lgkmcnt(2)
    v_mfma_f32_32x32x16_bf16 v[64:79], v[24:27], v[40:43], v[64:79]
    ds_read_b64_tr_b16 v[16:17], v7 offset:0
    ds_read_b64_tr_b16 v[18:19], v7 offset:512
    ds_read_b128 v[32:35], v49 offset:0
    v_mfma_f32_32x32x16_bf16 v[80:95], v[24:27], v[44:47], v[80:95]
    ds_read_b64_tr_b16 v[20:21], v11 offset:0
    ds_read_b64_tr_b16 v[22:23], v11 offset:512
    ds_read_b128 v[36:39], v49 offset:33280
    v_mfma_f32_32x32x16_bf16 v[96:111], v[28:31], v[40:43], v[96:111]
    s_waitcnt vmcnt(11)
    ds_write_b128 v6, v[168:171] offset:2048
    buffer_load_dwordx4 v[168:171], v5, s[40:43], s58 offen
    s_add_u32 s58, s58, 22016
    v_mfma_f32_32x32x16_bf16 v[112:127], v[28:31], v[44:47], v[112:127]
    s_waitcnt vmcnt(11)
    ds_write_b128 v6, v[172:175] offset:3072
    buffer_load_dwordx4 v[172:175], v5, s[40:43], s58 offen
    s_waitcnt lgkmcnt(2)
    v_mfma_f32_32x32x16_bf16 v[64:79], v[16:19], v[32:35], v[64:79]
    ds_read_b64_tr_b16 v[24:25], v7 offset:2048
    ds_read_b64_tr_b16 v[26:27], v7 offset:2560
    ds_read_b128 v[40:43], v49 offset:32
    v_mfma_f32_32x32x16_bf16 v[80:95], v[16:19], v[36:39], v[80:95]
    ds_read_b64_tr_b16 v[28:29], v11 offset:2048
    ds_read_b64_tr_b16 v[30:31], v11 offset:2560
    ds_read_b128 v[44:47], v49 offset:33312
    v_mfma_f32_32x32x16_bf16 v[96:111], v[20:23], v[32:35], v[96:111]
    s_waitcnt vmcnt(11)
    ds_write_b128 v6, v[128:131] offset:0
    s_xor_b32 s6, s59, 3
    s_mul_i32 s6, s6, 176128
    s_add_u32 s58, s60, s6
    buffer_load_dwordx4 v[128:131], v5, s[40:43], s58 offen
    s_add_u32 s58, s58, 22016
    v_mfma_f32_32x32x16_bf16 v[112:127], v[20:23], v[36:39], v[112:127]
    s_waitcnt vmcnt(11)
    ds_write_b128 v6, v[132:135] offset:1024
    buffer_load_dwordx4 v[132:135], v5, s[40:43], s58 offen
    s_add_u32 s58, s58, 22016
    s_waitcnt lgkmcnt(2)
    v_mfma_f32_32x32x16_bf16 v[64:79], v[24:27], v[40:43], v[64:79]
    ds_read_b64_tr_b16 v[16:17], v7 offset:0
    ds_read_b64_tr_b16 v[18:19], v7 offset:512
    ds_read_b128 v[32:35], v49 offset:64
    v_mfma_f32_32x32x16_bf16 v[80:95], v[24:27], v[44:47], v[80:95]
    ds_read_b64_tr_b16 v[20:21], v11 offset:0
    ds_read_b64_tr_b16 v[22:23], v11 offset:512
    ds_read_b128 v[36:39], v49 offset:33344
    v_mfma_f32_32x32x16_bf16 v[96:111], v[28:31], v[40:43], v[96:111]
    s_waitcnt vmcnt(11)
    ds_write_b128 v6, v[136:139] offset:2048
    buffer_load_dwordx4 v[136:139], v5, s[40:43], s58 offen
    s_add_u32 s58, s58, 22016
    v_mfma_f32_32x32x16_bf16 v[112:127], v[28:31], v[44:47], v[112:127]
    s_waitcnt vmcnt(11)
    ds_write_b128 v6, v[140:143] offset:3072
    buffer_load_dwordx4 v[140:143], v5, s[40:43], s58 offen
    s_add_u32 s58, s58, 22016
    s_waitcnt lgkmcnt(2)
    v_mfma_f32_32x32x16_bf16 v[64:79], v[16:19], v[32:35], v[64:79]
    ds_read_b64_tr_b16 v[24:25], v7 offset:2048
    ds_read_b64_tr_b16 v[26:27], v7 offset:2560
    ds_read_b128 v[40:43], v49 offset:96
    v_mfma_f32_32x32x16_bf16 v[80:95], v[16:19], v[36:39], v[80:95]
    ds_read_b64_tr_b16 v[28:29], v11 offset:2048
    ds_read_b64_tr_b16 v[30:31], v11 offset:2560
    ds_read_b128 v[44:47], v49 offset:33376
    v_mfma_f32_32x32x16_bf16 v[96:111], v[20:23], v[32:35], v[96:111]
    s_waitcnt vmcnt(11)
    ds_write_b128 v6, v[144:147] offset:0
    buffer_load_dwordx4 v[144:147], v5, s[40:43], s58 offen
    s_add_u32 s58, s58, 22016
    v_mfma_f32_32x32x16_bf16 v[112:127], v[20:23], v[36:39], v[112:127]
    s_waitcnt vmcnt(11)
    ds_write_b128 v6, v[148:151] offset:1024
    buffer_load_dwordx4 v[148:151], v5, s[40:43], s58 offen
    s_add_u32 s58, s58, 22016
    s_waitcnt lgkmcnt(2)
    v_mfma_f32_32x32x16_bf16 v[64:79], v[24:27], v[40:43], v[64:79]
    ds_read_b64_tr_b16 v[16:17], v7 offset:0
    ds_read_b64_tr_b16 v[18:19], v7 offset:512
    ds_read_b128 v[32:35], v50 offset:0
    v_mfma_f32_32x32x16_bf16 v[80:95], v[24:27], v[44:47], v[80:95]
    ds_read_b64_tr_b16 v[20:21], v11 offset:0
    ds_read_b64_tr_b16 v[22:23], v11 offset:512
    ds_read_b128 v[36:39], v50 offset:33280
    v_mfma_f32_32x32x16_bf16 v[96:111], v[28:31], v[40:43], v[96:111]
    s_waitcnt vmcnt(11)
    ds_write_b128 v6, v[152:155] offset:2048
    buffer_load_dwordx4 v[152:155], v5, s[40:43], s58 offen
    s_add_u32 s58, s58, 22016
    v_mfma_f32_32x32x16_bf16 v[112:127], v[28:31], v[44:47], v[112:127]
    s_waitcnt vmcnt(11)
    ds_write_b128 v6, v[156:159] offset:3072
    buffer_load_dwordx4 v[156:159], v5, s[40:43], s58 offen
    s_waitcnt lgkmcnt(2)
    v_mfma_f32_32x32x16_bf16 v[64:79], v[16:19], v[32:35], v[64:79]
    ds_read_b64_tr_b16 v[24:25], v7 offset:2048
    ds_read_b64_tr_b16 v[26:27], v7 offset:2560
    ds_read_b128 v[40:43], v50 offset:32
    v_mfma_f32_32x32x16_bf16 v[80:95], v[16:19], v[36:39], v[80:95]
    ds_read_b64_tr_b16 v[28:29], v11 offset:2048
    ds_read_b64_tr_b16 v[30:31], v11 offset:2560
    ds_read_b128 v[44:47], v50 offset:33312
    v_mfma_f32_32x32x16_bf16 v[96:111], v[20:23], v[32:35], v[96:111]
    s_waitcnt vmcnt(11)
    ds_write_b128 v6, v[160:163] offset:0
    s_xor_b32 s6, s59, 4
    s_mul_i32 s6, s6, 176128
    s_add_u32 s58, s60, s6
    buffer_load_dwordx4 v[160:163], v5, s[40:43], s58 offen
    s_add_u32 s58, s58, 22016
    v_mfma_f32_32x32x16_bf16 v[112:127], v[20:23], v[36:39], v[112:127]
    s_waitcnt vmcnt(11)
    ds_write_b128 v6, v[164:167] offset:1024
    buffer_load_dwordx4 v[164:167], v5, s[40:43], s58 offen
    s_add_u32 s58, s58, 22016
    s_waitcnt lgkmcnt(2)
    v_mfma_f32_32x32x16_bf16 v[64:79], v[24:27], v[40:43], v[64:79]
    ds_read_b64_tr_b16 v[16:17], v7 offset:0
    ds_read_b64_tr_b16 v[18:19], v7 offset:512
    ds_read_b128 v[32:35], v50 offset:64
    v_mfma_f32_32x32x16_bf16 v[80:95], v[24:27], v[44:47], v[80:95]
    ds_read_b64_tr_b16 v[20:21], v11 offset:0
    ds_read_b64_tr_b16 v[22:23], v11 offset:512
    ds_read_b128 v[36:39], v50 offset:33344
    v_mfma_f32_32x32x16_bf16 v[96:111], v[28:31], v[40:43], v[96:111]
    s_waitcnt vmcnt(11)
    ds_write_b128 v6, v[168:171] offset:2048
    buffer_load_dwordx4 v[168:171], v5, s[40:43], s58 offen
    s_add_u32 s58, s58, 22016
    v_mfma_f32_32x32x16_bf16 v[112:127], v[28:31], v[44:47], v[112:127]
    s_waitcnt vmcnt(11)
    ds_write_b128 v6, v[172:175] offset:3072
    buffer_load_dwordx4 v[172:175], v5, s[40:43], s58 offen
    s_add_u32 s58, s58, 22016
    s_waitcnt lgkmcnt(2)
    v_mfma_f32_32x32x16_bf16 v[64:79], v[16:19], v[32:35], v[64:79]
    ds_read_b64_tr_b16 v[24:25], v7 offset:2048
    ds_read_b64_tr_b16 v[26:27], v7 offset:2560
    ds_read_b128 v[40:43], v50 offset:96
    v_mfma_f32_32x32x16_bf16 v[80:95], v[16:19], v[36:39], v[80:95]
    ds_read_b64_tr_b16 v[28:29], v11 offset:2048
    ds_read_b64_tr_b16 v[30:31], v11 offset:2560
    ds_read_b128 v[44:47], v50 offset:33376
    v_mfma_f32_32x32x16_bf16 v[96:111], v[20:23], v[32:35], v[96:111]
    s_waitcnt vmcnt(11)
    ds_write_b128 v6, v[128:131] offset:0
    buffer_load_dwordx4 v[128:131], v5, s[40:43], s58 offen
    s_add_u32 s58, s58, 22016
    v_mfma_f32_32x32x16_bf16 v[112:127], v[20:23], v[36:39], v[112:127]
    s_waitcnt vmcnt(11)
    ds_write_b128 v6, v[132:135] offset:1024
    buffer_load_dwordx4 v[132:135], v5, s[40:43], s58 offen
    s_add_u32 s58, s58, 22016
    s_waitcnt lgkmcnt(2)
    v_mfma_f32_32x32x16_bf16 v[64:79], v[24:27], v[40:43], v[64:79]
    ds_read_b64_tr_b16 v[16:17], v7 offset:0
    ds_read_b64_tr_b16 v[18:19], v7 offset:512
    ds_read_b128 v[32:35], v51 offset:0
    v_mfma_f32_32x32x16_bf16 v[80:95], v[24:27], v[44:47], v[80:95]
    ds_read_b64_tr_b16 v[20:21], v11 offset:0
    ds_read_b64_tr_b16 v[22:23], v11 offset:512
    ds_read_b128 v[36:39], v51 offset:33280
    v_mfma_f32_32x32x16_bf16 v[96:111], v[28:31], v[40:43], v[96:111]
    s_waitcnt vmcnt(11)
    ds_write_b128 v6, v[136:139] offset:2048
    buffer_load_dwordx4 v[136:139], v5, s[40:43], s58 offen
    s_add_u32 s58, s58, 22016
    v_mfma_f32_32x32x16_bf16 v[112:127], v[28:31], v[44:47], v[112:127]
    s_waitcnt vmcnt(11)
    ds_write_b128 v6, v[140:143] offset:3072
    buffer_load_dwordx4 v[140:143], v5, s[40:43], s58 offen
    s_waitcnt lgkmcnt(2)
    v_mfma_f32_32x32x16_bf16 v[64:79], v[16:19], v[32:35], v[64:79]
    ds_read_b64_tr_b16 v[24:25], v7 offset:2048
    ds_read_b64_tr_b16 v[26:27], v7 offset:2560
    ds_read_b128 v[40:43], v51 offset:32
    v_mfma_f32_32x32x16_bf16 v[80:95], v[16:19], v[36:39], v[80:95]
    ds_read_b64_tr_b16 v[28:29], v11 offset:2048
    ds_read_b64_tr_b16 v[30:31], v11 offset:2560
    ds_read_b128 v[44:47], v51 offset:33312
    v_mfma_f32_32x32x16_bf16 v[96:111], v[20:23], v[32:35], v[96:111]
    s_waitcnt vmcnt(11)
    ds_write_b128 v6, v[144:147] offset:0
    s_xor_b32 s6, s59, 5
    s_mul_i32 s6, s6, 176128
    s_add_u32 s58, s60, s6
    buffer_load_dwordx4 v[144:147], v5, s[40:43], s58 offen
    s_add_u32 s58, s58, 22016
    v_mfma_f32_32x32x16_bf16 v[112:127], v[20:23], v[36:39], v[112:127]
    s_waitcnt vmcnt(11)
    ds_write_b128 v6, v[148:151] offset:1024
    buffer_load_dwordx4 v[148:151], v5, s[40:43], s58 offen
    s_add_u32 s58, s58, 22016
    s_waitcnt lgkmcnt(2)
    v_mfma_f32_32x32x16_bf16 v[64:79], v[24:27], v[40:43], v[64:79]
    ds_read_b64_tr_b16 v[16:17], v7 offset:0
    ds_read_b64_tr_b16 v[18:19], v7 offset:512
    ds_read_b128 v[32:35], v51 offset:64
    v_mfma_f32_32x32x16_bf16 v[80:95], v[24:27], v[44:47], v[80:95]
    ds_read_b64_tr_b16 v[20:21], v11 offset:0
    ds_read_b64_tr_b16 v[22:23], v11 offset:512
    ds_read_b128 v[36:39], v51 offset:33344
    v_mfma_f32_32x32x16_bf16 v[96:111], v[28:31], v[40:43], v[96:111]
    s_waitcnt vmcnt(11)
    ds_write_b128 v6, v[152:155] offset:2048
    buffer_load_dwordx4 v[152:155], v5, s[40:43], s58 offen
    s_add_u32 s58, s58, 22016
    v_mfma_f32_32x32x16_bf16 v[112:127], v[28:31], v[44:47], v[112:127]
    s_waitcnt vmcnt(11)
    ds_write_b128 v6, v[156:159] offset:3072
    buffer_load_dwordx4 v[156:159], v5, s[40:43], s58 offen
    s_add_u32 s58, s58, 22016
    s_waitcnt lgkmcnt(2)
    v_mfma_f32_32x32x16_bf16 v[64:79], v[16:19], v[32:35], v[64:79]
    ds_read_b64_tr_b16 v[24:25], v7 offset:2048
    ds_read_b64_tr_b16 v[26:27], v7 offset:2560
    ds_read_b128 v[40:43], v51 offset:96
    v_mfma_f32_32x32x16_bf16 v[80:95], v[16:19], v[36:39], v[80:95]
    ds_read_b64_tr_b16 v[28:29], v11 offset:2048
    ds_read_b64_tr_b16 v[30:31], v11 offset:2560
    ds_read_b128 v[44:47], v51 offset:33376
    v_mfma_f32_32x32x16_bf16 v[96:111], v[20:23], v[32:35], v[96:111]
    s_waitcnt vmcnt(11)
    ds_write_b128 v6, v[160:163] offset:0
    buffer_load_dwordx4 v[160:163], v5, s[40:43], s58 offen
    s_add_u32 s58, s58, 22016
    v_mfma_f32_32x32x16_bf16 v[112:127], v[20:23], v[36:39], v[112:127]
    s_waitcnt vmcnt(11)
    ds_write_b128 v6, v[164:167] offset:1024
    buffer_load_dwordx4 v[164:167], v5, s[40:43], s58 offen
    s_add_u32 s58, s58, 22016
    s_waitcnt lgkmcnt(2)
    v_mfma_f32_32x32x16_bf16 v[64:79], v[24:27], v[40:43], v[64:79]
    ds_read_b64_tr_b16 v[16:17], v7 offset:0
    ds_read_b64_tr_b16 v[18:19], v7 offset:512
    ds_read_b128 v[32:35], v52 offset:0
    v_mfma_f32_32x32x16_bf16 v[80:95], v[24:27], v[44:47], v[80:95]
    ds_read_b64_tr_b16 v[20:21], v11 offset:0
    ds_read_b64_tr_b16 v[22:23], v11 offset:512
    ds_read_b128 v[36:39], v52 offset:33280
    v_mfma_f32_32x32x16_bf16 v[96:111], v[28:31], v[40:43], v[96:111]
    s_waitcnt vmcnt(11)
    ds_write_b128 v6, v[168:171] offset:2048
    buffer_load_dwordx4 v[168:171], v5, s[40:43], s58 offen
    s_add_u32 s58, s58, 22016
    v_mfma_f32_32x32x16_bf16 v[112:127], v[28:31], v[44:47], v[112:127]
    s_waitcnt vmcnt(11)
    ds_write_b128 v6, v[172:175] offset:3072
    buffer_load_dwordx4 v[172:175], v5, s[40:43], s58 offen
    s_waitcnt lgkmcnt(2)
    v_mfma_f32_32x32x16_bf16 v[64:79], v[16:19], v[32:35], v[64:79]
    ds_read_b64_tr_b16 v[24:25], v7 offset:2048
    ds_read_b64_tr_b16 v[26:27], v7 offset:2560
    ds_read_b128 v[40:43], v52 offset:32
    v_mfma_f32_32x32x16_bf16 v[80:95], v[16:19], v[36:39], v[80:95]
    ds_read_b64_tr_b16 v[28:29], v11 offset:2048
    ds_read_b64_tr_b16 v[30:31], v11 offset:2560
    ds_read_b128 v[44:47], v52 offset:33312
    v_mfma_f32_32x32x16_bf16 v[96:111], v[20:23], v[32:35], v[96:111]
    s_waitcnt vmcnt(11)
    ds_write_b128 v6, v[128:131] offset:0
    s_xor_b32 s6, s59, 6
    s_mul_i32 s6, s6, 176128
    s_add_u32 s58, s60, s6
    buffer_load_dwordx4 v[128:131], v5, s[40:43], s58 offen
    s_add_u32 s58, s58, 22016
    v_mfma_f32_32x32x16_bf16 v[112:127], v[20:23], v[36:39], v[112:127]
    s_waitcnt vmcnt(11)
    ds_write_b128 v6, v[132:135] offset:1024
    buffer_load_dwordx4 v[132:135], v5, s[40:43], s58 offen
    s_add_u32 s58, s58, 22016
    s_waitcnt lgkmcnt(2)
    v_mfma_f32_32x32x16_bf16 v[64:79], v[24:27], v[40:43], v[64:79]
    ds_read_b64_tr_b16 v[16:17], v7 offset:0
    ds_read_b64_tr_b16 v[18:19], v7 offset:512
    ds_read_b128 v[32:35], v52 offset:64
    v_mfma_f32_32x32x16_bf16 v[80:95], v[24:27], v[44:47], v[80:95]
    ds_read_b64_tr_b16 v[20:21], v11 offset:0
    ds_read_b64_tr_b16 v[22:23], v11 offset:512
    ds_read_b128 v[36:39], v52 offset:33344
    v_mfma_f32_32x32x16_bf16 v[96:111], v[28:31], v[40:43], v[96:111]
    s_waitcnt vmcnt(11)
    ds_write_b128 v6, v[136:139] offset:2048
    buffer_load_dwordx4 v[136:139], v5, s[40:43], s58 offen
    s_add_u32 s58, s58, 22016
    v_mfma_f32_32x32x16_bf16 v[112:127], v[28:31], v[44:47], v[112:127]
    s_waitcnt vmcnt(11)
    ds_write_b128 v6, v[140:143] offset:3072
    buffer_load_dwordx4 v[140:143], v5, s[40:43], s58 offen
    s_add_u32 s58, s58, 22016
    s_waitcnt lgkmcnt(2)
    v_mfma_f32_32x32x16_bf16 v[64:79], v[16:19], v[32:35], v[64:79]
    ds_read_b64_tr_b16 v[24:25], v7 offset:2048
    ds_read_b64_tr_b16 v[26:27], v7 offset:2560
    ds_read_b128 v[40:43], v52 offset:96
    v_mfma_f32_32x32x16_bf16 v[80:95], v[16:19], v[36:39], v[80:95]
    ds_read_b64_tr_b16 v[28:29], v11 offset:2048
    ds_read_b64_tr_b16 v[30:31], v11 offset:2560
    ds_read_b128 v[44:47], v52 offset:33376
    v_mfma_f32_32x32x16_bf16 v[96:111], v[20:23], v[32:35], v[96:111]
    s_waitcnt vmcnt(11)
    ds_write_b128 v6, v[144:147] offset:0
    buffer_load_dwordx4 v[144:147], v5, s[40:43], s58 offen
    s_add_u32 s58, s58, 22016
    v_mfma_f32_32x32x16_bf16 v[112:127], v[20:23], v[36:39], v[112:127]
    s_waitcnt vmcnt(11)
    ds_write_b128 v6, v[148:151] offset:1024
    buffer_load_dwordx4 v[148:151], v5, s[40:43], s58 offen
    s_add_u32 s58, s58, 22016
    s_waitcnt lgkmcnt(2)
    v_mfma_f32_32x32x16_bf16 v[64:79], v[24:27], v[40:43], v[64:79]
    ds_read_b64_tr_b16 v[16:17], v7 offset:0
    ds_read_b64_tr_b16 v[18:19], v7 offset:512
    ds_read_b128 v[32:35], v53 offset:0
    v_mfma_f32_32x32x16_bf16 v[80:95], v[24:27], v[44:47], v[80:95]
    ds_read_b64_tr_b16 v[20:21], v11 offset:0
    ds_read_b64_tr_b16 v[22:23], v11 offset:512
    ds_read_b128 v[36:39], v53 offset:33280
    v_mfma_f32_32x32x16_bf16 v[96:111], v[28:31], v[40:43], v[96:111]
    s_waitcnt vmcnt(11)
    ds_write_b128 v6, v[152:155] offset:2048
    buffer_load_dwordx4 v[152:155], v5, s[40:43], s58 offen
    s_add_u32 s58, s58, 22016
    v_mfma_f32_32x32x16_bf16 v[112:127], v[28:31], v[44:47], v[112:127]
    s_waitcnt vmcnt(11)
    ds_write_b128 v6, v[156:159] offset:3072
    buffer_load_dwordx4 v[156:159], v5, s[40:43], s58 offen
    s_waitcnt lgkmcnt(2)
    v_mfma_f32_32x32x16_bf16 v[64:79], v[16:19], v[32:35], v[64:79]
    ds_read_b64_tr_b16 v[24:25], v7 offset:2048
    ds_read_b64_tr_b16 v[26:27], v7 offset:2560
    ds_read_b128 v[40:43], v53 offset:32
    v_mfma_f32_32x32x16_bf16 v[80:95], v[16:19], v[36:39], v[80:95]
    ds_read_b64_tr_b16 v[28:29], v11 offset:2048
    ds_read_b64_tr_b16 v[30:31], v11 offset:2560
    ds_read_b128 v[44:47], v53 offset:33312
    v_mfma_f32_32x32x16_bf16 v[96:111], v[20:23], v[32:35], v[96:111]
    s_waitcnt vmcnt(11)
    ds_write_b128 v6, v[160:163] offset:0
    s_xor_b32 s6, s59, 7
    s_mul_i32 s6, s6, 176128
    s_add_u32 s58, s60, s6
    buffer_load_dwordx4 v[160:163], v5, s[40:43], s58 offen
    s_add_u32 s58, s58, 22016
    v_mfma_f32_32x32x16_bf16 v[112:127], v[20:23], v[36:39], v[112:127]
    s_waitcnt vmcnt(11)
    ds_write_b128 v6, v[164:167] offset:1024
    buffer_load_dwordx4 v[164:167], v5, s[40:43], s58 offen
    s_add_u32 s58, s58, 22016
    s_waitcnt lgkmcnt(2)
    v_mfma_f32_32x32x16_bf16 v[64:79], v[24:27], v[40:43], v[64:79]
    ds_read_b64_tr_b16 v[16:17], v7 offset:0
    ds_read_b64_tr_b16 v[18:19], v7 offset:512
    ds_read_b128 v[32:35], v53 offset:64
    v_mfma_f32_32x32x16_bf16 v[80:95], v[24:27], v[44:47], v[80:95]
    ds_read_b64_tr_b16 v[20:21], v11 offset:0
    ds_read_b64_tr_b16 v[22:23], v11 offset:512
    ds_read_b128 v[36:39], v53 offset:33344
    v_mfma_f32_32x32x16_bf16 v[96:111], v[28:31], v[40:43], v[96:111]
    s_waitcnt vmcnt(11)
    ds_write_b128 v6, v[168:171] offset:2048
    buffer_load_dwordx4 v[168:171], v5, s[40:43], s58 offen
    s_add_u32 s58, s58, 22016
    v_mfma_f32_32x32x16_bf16 v[112:127], v[28:31], v[44:47], v[112:127]
    s_waitcnt vmcnt(11)
    ds_write_b128 v6, v[172:175] offset:3072
    buffer_load_dwordx4 v[172:175], v5, s[40:43], s58 offen
    s_add_u32 s58, s58, 22016
    s_waitcnt lgkmcnt(2)
    v_mfma_f32_32x32x16_bf16 v[64:79], v[16:19], v[32:35], v[64:79]
    ds_read_b64_tr_b16 v[24:25], v7 offset:2048
    ds_read_b64_tr_b16 v[26:27], v7 offset:2560
    ds_read_b128 v[40:43], v53 offset:96
    v_mfma_f32_32x32x16_bf16 v[80:95], v[16:19], v[36:39], v[80:95]
    ds_read_b64_tr_b16 v[28:29], v11 offset:2048
    ds_read_b64_tr_b16 v[30:31], v11 offset:2560
    ds_read_b128 v[44:47], v53 offset:33376
    v_mfma_f32_32x32x16_bf16 v[96:111], v[20:23], v[32:35], v[96:111]
    s_waitcnt vmcnt(11)
    ds_write_b128 v6, v[128:131] offset:0
    buffer_load_dwordx4 v[128:131], v5, s[40:43], s58 offen
    s_add_u32 s58, s58, 22016
    v_mfma_f32_32x32x16_bf16 v[112:127], v[20:23], v[36:39], v[112:127]
    s_waitcnt vmcnt(11)
    ds_write_b128 v6, v[132:135] offset:1024
    buffer_load_dwordx4 v[132:135], v5, s[40:43], s58 offen
    s_add_u32 s58, s58, 22016
    s_waitcnt lgkmcnt(2)
    v_mfma_f32_32x32x16_bf16 v[64:79], v[24:27], v[40:43], v[64:79]
    ds_read_b64_tr_b16 v[16:17], v7 offset:0
    ds_read_b64_tr_b16 v[18:19], v7 offset:512
    ds_read_b128 v[32:35], v54 offset:0
    v_mfma_f32_32x32x16_bf16 v[80:95], v[24:27], v[44:47], v[80:95]
    ds_read_b64_tr_b16 v[20:21], v11 offset:0
    ds_read_b64_tr_b16 v[22:23], v11 offset:512
    ds_read_b128 v[36:39], v54 offset:33280
    v_mfma_f32_32x32x16_bf16 v[96:111], v[28:31], v[40:43], v[96:111]
    s_waitcnt vmcnt(11)
    ds_write_b128 v6, v[136:139] offset:2048
    buffer_load_dwordx4 v[136:139], v5, s[40:43], s58 offen
    s_add_u32 s58, s58, 22016
    v_mfma_f32_32x32x16_bf16 v[112:127], v[28:31], v[44:47], v[112:127]
    s_waitcnt vmcnt(11)
    ds_write_b128 v6, v[140:143] offset:3072
    buffer_load_dwordx4 v[140:143], v5, s[40:43], s58 offen
    s_waitcnt lgkmcnt(2)
    v_mfma_f32_32x32x16_bf16 v[64:79], v[16:19], v[32:35], v[64:79]
    ds_read_b64_tr_b16 v[24:25], v7 offset:2048
    ds_read_b64_tr_b16 v[26:27], v7 offset:2560
    ds_read_b128 v[40:43], v54 offset:32
    v_mfma_f32_32x32x16_bf16 v[80:95], v[16:19], v[36:39], v[80:95]
    ds_read_b64_tr_b16 v[28:29], v11 offset:2048
    ds_read_b64_tr_b16 v[30:31], v11 offset:2560
    ds_read_b128 v[44:47], v54 offset:33312
    v_mfma_f32_32x32x16_bf16 v[96:111], v[20:23], v[32:35], v[96:111]
    s_waitcnt vmcnt(11)
    ds_write_b128 v6, v[144:147] offset:0
    v_mfma_f32_32x32x16_bf16 v[112:127], v[20:23], v[36:39], v[112:127]
    s_waitcnt vmcnt(10)
    ds_write_b128 v6, v[148:151] offset:1024
    s_waitcnt lgkmcnt(2)
    v_mfma_f32_32x32x16_bf16 v[64:79], v[24:27], v[40:43], v[64:79]
    ds_read_b64_tr_b16 v[16:17], v7 offset:0
    ds_read_b64_tr_b16 v[18:19], v7 offset:512
    ds_read_b128 v[32:35], v54 offset:64
    v_mfma_f32_32x32x16_bf16 v[80:95], v[24:27], v[44:47], v[80:95]
    ds_read_b64_tr_b16 v[20:21], v11 offset:0
    ds_read_b64_tr_b16 v[22:23], v11 offset:512
    ds_read_b128 v[36:39], v54 offset:33344
    v_mfma_f32_32x32x16_bf16 v[96:111], v[28:31], v[40:43], v[96:111]
    s_waitcnt vmcnt(9)
    ds_write_b128 v6, v[152:155] offset:2048
    v_mfma_f32_32x32x16_bf16 v[112:127], v[28:31], v[44:47], v[112:127]
    s_waitcnt vmcnt(8)
    ds_write_b128 v6, v[156:159] offset:3072
    s_waitcnt lgkmcnt(2)
    v_mfma_f32_32x32x16_bf16 v[64:79], v[16:19], v[32:35], v[64:79]
    ds_read_b64_tr_b16 v[24:25], v7 offset:2048
    ds_read_b64_tr_b16 v[26:27], v7 offset:2560
    ds_read_b128 v[40:43], v54 offset:96
    v_mfma_f32_32x32x16_bf16 v[80:95], v[16:19], v[36:39], v[80:95]
    ds_read_b64_tr_b16 v[28:29], v11 offset:2048
    ds_read_b64_tr_b16 v[30:31], v11 offset:2560
    ds_read_b128 v[44:47], v54 offset:33376
    v_mfma_f32_32x32x16_bf16 v[96:111], v[20:23], v[32:35], v[96:111]
    s_waitcnt vmcnt(7)
    ds_write_b128 v6, v[160:163] offset:0
    v_mfma_f32_32x32x16_bf16 v[112:127], v[20:23], v[36:39], v[112:127]
    s_waitcnt vmcnt(6)
    ds_write_b128 v6, v[164:167] offset:1024
    s_waitcnt lgkmcnt(2)
    v_mfma_f32_32x32x16_bf16 v[64:79], v[24:27], v[40:43], v[64:79]
    ds_read_b64_tr_b16 v[16:17], v7 offset:0
    ds_read_b64_tr_b16 v[18:19], v7 offset:512
    ds_read_b128 v[32:35], v55 offset:0
    v_mfma_f32_32x32x16_bf16 v[80:95], v[24:27], v[44:47], v[80:95]
    ds_read_b64_tr_b16 v[20:21], v11 offset:0
    ds_read_b64_tr_b16 v[22:23], v11 offset:512
    ds_read_b128 v[36:39], v55 offset:33280
    v_mfma_f32_32x32x16_bf16 v[96:111], v[28:31], v[40:43], v[96:111]
    s_waitcnt vmcnt(5)
    ds_write_b128 v6, v[168:171] offset:2048
    v_mfma_f32_32x32x16_bf16 v[112:127], v[28:31], v[44:47], v[112:127]
    s_waitcnt vmcnt(4)
    ds_write_b128 v6, v[172:175] offset:3072
    s_waitcnt lgkmcnt(2)
    v_mfma_f32_32x32x16_bf16 v[64:79], v[16:19], v[32:35], v[64:79]
    ds_read_b64_tr_b16 v[24:25], v7 offset:2048
    ds_read_b64_tr_b16 v[26:27], v7 offset:2560
    ds_read_b128 v[40:43], v55 offset:32
    v_mfma_f32_32x32x16_bf16 v[80:95], v[16:19], v[36:39], v[80:95]
    ds_read_b64_tr_b16 v[28:29], v11 offset:2048
    ds_read_b64_tr_b16 v[30:31], v11 offset:2560
    ds_read_b128 v[44:47], v55 offset:33312
    v_mfma_f32_32x32x16_bf16 v[96:111], v[20:23], v[32:35], v[96:111]
    s_waitcnt vmcnt(3)
    ds_write_b128 v6, v[128:131] offset:0
    v_mfma_f32_32x32x16_bf16 v[112:127], v[20:23], v[36:39], v[112:127]
    s_waitcnt vmcnt(2)
    ds_write_b128 v6, v[132:135] offset:1024
    s_waitcnt lgkmcnt(2)
    v_mfma_f32_32x32x16_bf16 v[64:79], v[24:27], v[40:43], v[64:79]
    ds_read_b64_tr_b16 v[16:17], v7 offset:0
    ds_read_b64_tr_b16 v[18:19], v7 offset:512
    ds_read_b128 v[32:35], v55 offset:64
    v_mfma_f32_32x32x16_bf16 v[80:95], v[24:27], v[44:47], v[80:95]
    ds_read_b64_tr_b16 v[20:21], v11 offset:0
    ds_read_b64_tr_b16 v[22:23], v11 offset:512
    ds_read_b128 v[36:39], v55 offset:33344
    v_mfma_f32_32x32x16_bf16 v[96:111], v[28:31], v[40:43], v[96:111]
    s_waitcnt vmcnt(1)
    ds_write_b128 v6, v[136:139] offset:2048
    v_mfma_f32_32x32x16_bf16 v[112:127], v[28:31], v[44:47], v[112:127]
    s_waitcnt vmcnt(0)
    ds_write_b128 v6, v[140:143] offset:3072
    s_waitcnt lgkmcnt(2)
    v_mfma_f32_32x32x16_bf16 v[64:79], v[16:19], v[32:35], v[64:79]
    ds_read_b64_tr_b16 v[24:25], v7 offset:2048
    ds_read_b64_tr_b16 v[26:27], v7 offset:2560
    ds_read_b128 v[40:43], v55 offset:96
    v_mfma_f32_32x32x16_bf16 v[80:95], v[16:19], v[36:39], v[80:95]
    ds_read_b64_tr_b16 v[28:29], v11 offset:2048
    ds_read_b64_tr_b16 v[30:31], v11 offset:2560
    ds_read_b128 v[44:47], v55 offset:33376
    v_mfma_f32_32x32x16_bf16 v[96:111], v[20:23], v[32:35], v[96:111]
    v_mfma_f32_32x32x16_bf16 v[112:127], v[20:23], v[36:39], v[112:127]
    s_waitcnt lgkmcnt(0)
    v_mfma_f32_32x32x16_bf16 v[64:79], v[24:27], v[40:43], v[64:79]
    v_mfma_f32_32x32x16_bf16 v[80:95], v[24:27], v[44:47], v[80:95]
    v_mfma_f32_32x32x16_bf16 v[96:111], v[28:31], v[40:43], v[96:111]
    v_mfma_f32_32x32x16_bf16 v[112:127], v[28:31], v[44:47], v[112:127]
    s_setprio 3
    s_mov_b64 exec, 1
    ds_add_u32 v2, v3 offset:16
    s_mov_b64 exec, -1
    s_cmp_ge_u32 s31, 2
    s_cbranch_scc1 G_nop
    buffer_store_dwordx4 v[56:59], v60, s[44:47], s61 offen offset:0 sc1
    buffer_store_dwordx4 v[56:59], v60, s[44:47], s61 offen offset:1024 sc1
    buffer_store_dwordx4 v[56:59], v60, s[44:47], s61 offen offset:2048 sc1
    buffer_store_dwordx4 v[56:59], v60, s[44:47], s61 offen offset:3072 sc1
G_nop:
    v_lshlrev_b32 v8, 4, v1
    s_mul_i32 s6, s4, 176
    s_lshl2_add_u32 s6, s57, s6
    s_lshl_b32 s6, s6, 10
    s_add_u32 s6, s6, 6291456
    s_add_u32 s7, s6, 90112
    v_cvt_pk_bf16_f32 v128, v64, v65 clamp
    v_cvt_pk_bf16_f32 v129, v66, v67 clamp
    v_cvt_pk_bf16_f32 v130, v68, v69 clamp
    v_cvt_pk_bf16_f32 v131, v70, v71 clamp
    buffer_store_dwordx4 v[128:131], v8, s[44:47], s6 offen offset:0 sc1
    v_cvt_pk_bf16_f32 v132, v72, v73 clamp
    v_cvt_pk_bf16_f32 v133, v74, v75 clamp
    v_cvt_pk_bf16_f32 v134, v76, v77 clamp
    v_cvt_pk_bf16_f32 v135, v78, v79 clamp
    buffer_store_dwordx4 v[132:135], v8, s[44:47], s6 offen offset:1024 sc1
    v_cvt_pk_bf16_f32 v136, v80, v81 clamp
    v_cvt_pk_bf16_f32 v137, v82, v83 clamp
    v_cvt_pk_bf16_f32 v138, v84, v85 clamp
    v_cvt_pk_bf16_f32 v139, v86, v87 clamp
    buffer_store_dwordx4 v[136:139], v8, s[44:47], s7 offen offset:0 sc1
    v_cvt_pk_bf16_f32 v140, v88, v89 clamp
    v_cvt_pk_bf16_f32 v141, v90, v91 clamp
    v_cvt_pk_bf16_f32 v142, v92, v93 clamp
    v_cvt_pk_bf16_f32 v143, v94, v95 clamp
    buffer_store_dwordx4 v[140:143], v8, s[44:47], s7 offen offset:1024 sc1
    v_cvt_pk_bf16_f32 v144, v96, v97 clamp
    v_cvt_pk_bf16_f32 v145, v98, v99 clamp
    v_cvt_pk_bf16_f32 v146, v100, v101 clamp
    v_cvt_pk_bf16_f32 v147, v102, v103 clamp
    buffer_store_dwordx4 v[144:147], v8, s[44:47], s6 offen offset:2048 sc1
    v_cvt_pk_bf16_f32 v148, v104, v105 clamp
    v_cvt_pk_bf16_f32 v149, v106, v107 clamp
    v_cvt_pk_bf16_f32 v150, v108, v109 clamp
    v_cvt_pk_bf16_f32 v151, v110, v111 clamp
    buffer_store_dwordx4 v[148:151], v8, s[44:47], s6 offen offset:3072 sc1
    v_cvt_pk_bf16_f32 v152, v112, v113 clamp
    v_cvt_pk_bf16_f32 v153, v114, v115 clamp
    v_cvt_pk_bf16_f32 v154, v116, v117 clamp
    v_cvt_pk_bf16_f32 v155, v118, v119 clamp
    buffer_store_dwordx4 v[152:155], v8, s[44:47], s7 offen offset:2048 sc1
    v_cvt_pk_bf16_f32 v156, v120, v121 clamp
    v_cvt_pk_bf16_f32 v157, v122, v123 clamp
    v_cvt_pk_bf16_f32 v158, v124, v125 clamp
    v_cvt_pk_bf16_f32 v159, v126, v127 clamp
    buffer_store_dwordx4 v[156:159], v8, s[44:47], s7 offen offset:3072 sc1
G_hpub:
    s_lshl_b32 s6, s4, 7
    s_lshl3_add_u32 s6, s5, s6
    s_add_u32 s7, s6, 3309568
    v_mov_b32 v16, s52
    v_mov_b32 v17, s53
    s_mov_b64 exec, 1
    s_waitcnt vmcnt(0)
    ds_add_rtn_u32 v18, v2, v3 offset:20
    s_waitcnt lgkmcnt(0)
    v_readfirstlane_b32 s6, v18
    s_cmp_eq_u32 s6, 2
    s_cbranch_scc0 G_pubh_skip
    buffer_store_dwordx2 v[16:17], off, s[44:47], s7 sc1
G_pubh_skip:
    s_mov_b64 exec, -1
G_ffn2:
    s_setprio 3
    s_lshl_b32 s63, s31, 14
    s_mul_i32 s56, s31, 12288
    s_add_u32 s56, s56, 0
    s_mov_b32 s36, s22
    s_and_b32 s37, s23, 0xffff
    s_mov_b32 s38, 1409024
    s_mov_b32 s39, 0x20000
    s_mov_b32 s32, s8
    s_and_b32 s33, s9, 0xffff
    s_mov_b32 s34, 2097152
    s_mov_b32 s35, 0x20000
    s_mov_b32 s48, s24
    s_and_b32 s49, s25, 0xffff
    s_mov_b32 s50, 2097152
    s_mov_b32 s51, 0x20000
    v_add_u32 v5, 7168, v4
    s_lshl1_add_u32 s6, s5, s4
    s_and_b32 s6, s6, 7
    s_mul_i32 s6, s6, 11
    s_lshr_b32 s6, s6, 2
    s_lshl_b32 s59, s6, 12
    s_lshl_b32 s58, s6, 16
    s_add_u32 s58, s58, s63
    s_and_b32 s60, s31, 1
    s_lshr_b32 s61, s31, 1
    v_and_b32 v8, 31, v1
    v_lshrrev_b32 v9, 5, v1
    v_lshlrev_b32 v10, 10, v8
    v_lshl_add_u32 v10, v9, 5, v10
    s_lshl_b32 s6, s4, 16
    s_lshl_b32 s7, s61, 15
    s_add_u32 s62, s6, s7
    s_lshl_b32 s6, s5, 7
    s_lshl_b32 s7, s60, 6
    s_add_u32 s6, s6, s7
    s_add_u32 s62, s62, s6
    buffer_load_dwordx4 v[144:147], v10, s[32:35], s62 offen offset:0
    buffer_load_dwordx4 v[148:151], v10, s[32:35], s62 offen offset:16
    v_lshlrev_b32 v13, 4, v1
    s_mul_i32 s65, s4, 180224
    s_lshl_b32 s6, s31, 10
    s_add_u32 s65, s65, s6
    s_add_u32 s65, s65, 6291456
    s_mul_i32 s6, s61, 90112
    s_add_u32 s7, s6, s65
    v_add_u32 v6, s7, v13
    s_sub_u32 s6, 90112, s6
    s_add_u32 s7, s6, s65
    v_add_u32 v7, s7, v13
    v_bfe_u32 v16, v1, 2, 2
    v_lshl_add_u32 v14, v9, 2, v16
    v_lshlrev_b32 v14, 7, v14
    v_bfe_u32 v15, v1, 4, 1
    v_lshl_add_u32 v14, v15, 4, v14
    v_and_b32 v15, 1, v1
    v_lshl_add_u32 v14, v15, 5, v14
    v_bfe_u32 v15, v1, 1, 1
    v_lshl_add_u32 v14, v15, 3, v14
    v_lshrrev_b32 v16, 1, v16
    v_xor_b32 v16, s60, v16
    v_lshl_add_u32 v14, v16, 6, v14
    v_xor_b32 v12, 64, v14
    v_add_u32 v11, s56, v14
    v_add_u32 v12, s56, v12
    v_and_b32 v16, 3, v1
    v_lshl_add_u32 v16, v16, 2, v2
    s_mov_b32 s54, 32768
G_cf_top:
    ds_read_b32 v17, v16 offset:32
    s_waitcnt lgkmcnt(0)
    v_cmp_eq_u32 vcc, 0, v17
    s_nop 0
    s_cbranch_vccz G_cf_ok
    s_sleep 2
    s_sub_u32 s54, s54, 1
    s_cmp_lg_u32 s54, 0
    s_cbranch_scc1 G_cf_top
G_cf_ok:
    s_mov_b32 s54, 32768
G_wo_top:
    ds_read_b32 v16, v2 offset:52
    s_waitcnt lgkmcnt(0)
    v_readfirstlane_b32 s6, v16
    s_cmp_ge_u32 s6, 1
    s_cbranch_scc1 G_wo_ok
    s_sleep 3
    s_sub_u32 s54, s54, 1
    s_cmp_lg_u32 s54, 0
    s_cbranch_scc1 G_wo_top
G_wo_ok:
    ds_read_b64_tr_b16 v[160:161], v14 offset:0
    ds_read_b64_tr_b16 v[162:163], v14 offset:1024
    ds_read_b64_tr_b16 v[164:165], v14 offset:2048
    ds_read_b64_tr_b16 v[166:167], v14 offset:3072
    ds_read_b64_tr_b16 v[168:169], v14 offset:4096
    ds_read_b64_tr_b16 v[170:171], v14 offset:5120
    ds_read_b64_tr_b16 v[172:173], v14 offset:6144
    ds_read_b64_tr_b16 v[174:175], v14 offset:7168
    s_waitcnt lgkmcnt(4)
    ds_read_b64_tr_b16 v[176:177], v14 offset:8192
    ds_read_b64_tr_b16 v[178:179], v14 offset:9216
    ds_read_b64_tr_b16 v[180:181], v14 offset:10240
    ds_read_b64_tr_b16 v[182:183], v14 offset:11264
    ds_read_b64_tr_b16 v[184:185], v14 offset:12288
    ds_read_b64_tr_b16 v[186:187], v14 offset:13312
    ds_read_b64_tr_b16 v[188:189], v14 offset:14336
    ds_read_b64_tr_b16 v[190:191], v14 offset:15360
    s_waitcnt lgkmcnt(4)
    ds_read_b64_tr_b16 v[192:193], v14 offset:16384
    ds_read_b64_tr_b16 v[194:195], v14 offset:17408
    ds_read_b64_tr_b16 v[196:197], v14 offset:18432
    ds_read_b64_tr_b16 v[198:199], v14 offset:19456
    ds_read_b64_tr_b16 v[200:201], v14 offset:20480
    ds_read_b64_tr_b16 v[202:203], v14 offset:21504
    ds_read_b64_tr_b16 v[204:205], v14 offset:22528
    ds_read_b64_tr_b16 v[206:207], v14 offset:23552
    s_waitcnt lgkmcnt(4)
    ds_read_b64_tr_b16 v[208:209], v14 offset:24576
    ds_read_b64_tr_b16 v[210:211], v14 offset:25600
    ds_read_b64_tr_b16 v[212:213], v14 offset:26624
    ds_read_b64_tr_b16 v[214:215], v14 offset:27648
    ds_read_b64_tr_b16 v[216:217], v14 offset:28672
    ds_read_b64_tr_b16 v[218:219], v14 offset:29696
    ds_read_b64_tr_b16 v[220:221], v14 offset:30720
    ds_read_b64_tr_b16 v[222:223], v14 offset:31744
    s_waitcnt lgkmcnt(4)
    ds_read_b64_tr_b16 v[224:225], v14 offset:32768
    ds_read_b64_tr_b16 v[226:227], v14 offset:33792
    ds_read_b64_tr_b16 v[228:229], v14 offset:34816
    ds_read_b64_tr_b16 v[230:231], v14 offset:35840
    ds_read_b64_tr_b16 v[232:233], v14 offset:36864
    ds_read_b64_tr_b16 v[234:235], v14 offset:37888
    ds_read_b64_tr_b16 v[236:237], v14 offset:38912
    ds_read_b64_tr_b16 v[238:239], v14 offset:39936
    s_waitcnt lgkmcnt(4)
    ds_read_b64_tr_b16 v[240:241], v14 offset:40960
    ds_read_b64_tr_b16 v[242:243], v14 offset:41984
    ds_read_b64_tr_b16 v[244:245], v14 offset:43008
    ds_read_b64_tr_b16 v[246:247], v14 offset:44032
    ds_read_b64_tr_b16 v[248:249], v14 offset:45056
    ds_read_b64_tr_b16 v[250:251], v14 offset:46080
    ds_read_b64_tr_b16 v[252:253], v14 offset:47104
    ds_read_b64_tr_b16 v[254:255], v14 offset:48128
    s_waitcnt lgkmcnt(4)
    s_waitcnt vmcnt(0) lgkmcnt(0)
    s_mov_b64 exec, 1
    ds_add_u32 v2, v3 offset:48
    s_mov_b64 exec, -1
    v_and_b32 v15, 7, v1
    v_lshlrev_b32 v15, 3, v15
    s_mov_b32 s54, 32768
G_r2_top:
    ds_read_b32 v16, v2 offset:48
    s_waitcnt lgkmcnt(0)
    v_readfirstlane_b32 s6, v16
    s_cmp_ge_u32 s6, 4
    s_cbranch_scc1 G_r2_ok
    s_sleep 1
    s_sub_u32 s54, s54, 1
    s_cmp_lg_u32 s54, 0
    s_cbranch_scc1 G_r2_top
G_r2_ok:
    s_add_u32 m0, s56, 0
    s_nop 0
    buffer_load_dwordx4 v4, s[36:39], s58 offen lds
    buffer_load_dwordx4 v5, s[36:39], s58 offen offset:1024 lds
    s_add_u32 s58, s58, 65536
    s_cmp_ge_u32 s58, 1441792
    s_cselect_b32 s58, s63, s58
    s_add_u32 m0, s56, 2048
    s_nop 0
    buffer_load_dwordx4 v4, s[36:39], s58 offen lds
    buffer_load_dwordx4 v5, s[36:39], s58 offen offset:1024 lds
    s_add_u32 s58, s58, 65536
    s_cmp_ge_u32 s58, 1441792
    s_cselect_b32 s58, s63, s58
    s_add_u32 m0, s56, 4096
    s_nop 0
    buffer_load_dwordx4 v4, s[36:39], s58 offen lds
    buffer_load_dwordx4 v5, s[36:39], s58 offen offset:1024 lds
    s_add_u32 s58, s58, 65536
    s_cmp_ge_u32 s58, 1441792
    s_cselect_b32 s58, s63, s58
    s_add_u32 m0, s56, 6144
    s_nop 0
    buffer_load_dwordx4 v4, s[36:39], s58 offen lds
    buffer_load_dwordx4 v5, s[36:39], s58 offen offset:1024 lds
    s_add_u32 s58, s58, 65536
    s_cmp_ge_u32 s58, 1441792
    s_cselect_b32 s58, s63, s58
    s_add_u32 m0, s56, 8192
    s_nop 0
    buffer_load_dwordx4 v4, s[36:39], s58 offen lds
    buffer_load_dwordx4 v5, s[36:39], s58 offen offset:1024 lds
    s_add_u32 s58, s58, 65536
    s_cmp_ge_u32 s58, 1441792
    s_cselect_b32 s58, s63, s58
    s_lshl_b32 s7, s4, 7
    s_add_u32 s7, s7, 3309568
    s_mov_b32 s54, 32768
G_h_top:
    buffer_load_dwordx2 v[16:17], v15, s[44:47], s7 offen sc1
    s_waitcnt vmcnt(0)
    v_cmp_ne_u64 vcc, s[52:53], v[16:17]
    s_nop 0
    s_cbranch_vccz G_h_ok
    s_sleep 4
    s_sub_u32 s54, s54, 1
    s_cmp_lg_u32 s54, 0
    s_cbranch_scc1 G_h_top
G_h_ok:
    buffer_load_dwordx4 v[32:35], v6, s[44:47], s59 offen sc1
    buffer_load_dwordx4 v[36:39], v7, s[44:47], s59 offen sc1
    s_add_u32 s59, s59, 4096
    s_cmp_ge_u32 s59, 90112
    s_cselect_b32 s59, 0, s59
    buffer_load_dwordx4 v[40:43], v6, s[44:47], s59 offen sc1
    buffer_load_dwordx4 v[44:47], v7, s[44:47], s59 offen sc1
    s_add_u32 s59, s59, 4096
    s_cmp_ge_u32 s59, 90112
    s_cselect_b32 s59, 0, s59
    buffer_load_dwordx4 v[48:51], v6, s[44:47], s59 offen sc1
    buffer_load_dwordx4 v[52:55], v7, s[44:47], s59 offen sc1
    s_add_u32 s59, s59, 4096
    s_cmp_ge_u32 s59, 90112
    s_cselect_b32 s59, 0, s59
    buffer_load_dwordx4 v[56:59], v6, s[44:47], s59 offen sc1
    buffer_load_dwordx4 v[60:63], v7, s[44:47], s59 offen sc1
    s_add_u32 s59, s59, 4096
    s_cmp_ge_u32 s59, 90112
    s_cselect_b32 s59, 0, s59
    buffer_load_dwordx4 v[128:131], v6, s[44:47], s59 offen sc1
    buffer_load_dwordx4 v[132:135], v7, s[44:47], s59 offen sc1
    s_add_u32 s59, s59, 4096
    s_cmp_ge_u32 s59, 90112
    s_cselect_b32 s59, 0, s59
    s_waitcnt vmcnt(8)
    ds_read_b64_tr_b16 v[20:21], v12 offset:0
    ds_read_b64_tr_b16 v[22:23], v12 offset:1024
    ds_read_b64_tr_b16 v[16:17], v11 offset:0
    ds_read_b64_tr_b16 v[18:19], v11 offset:1024
    s_setprio 0
    s_waitcnt lgkmcnt(0)
    v_mfma_f32_32x32x16_bf16 v[112:127], v[20:23], v[36:39], 0
    s_waitcnt vmcnt(6)
    ds_read_b64_tr_b16 v[28:29], v12 offset:2048
    ds_read_b64_tr_b16 v[30:31], v12 offset:3072
    v_mfma_f32_32x32x16_bf16 v[96:111], v[16:19], v[36:39], 0
    ds_read_b64_tr_b16 v[24:25], v11 offset:2048
    ds_read_b64_tr_b16 v[26:27], v11 offset:3072
    v_mfma_f32_32x32x16_bf16 v[80:95], v[20:23], v[32:35], 0
    s_add_u32 m0, s56, 10240
    s_nop 0
    buffer_load_dwordx4 v4, s[36:39], s58 offen lds
    buffer_load_dwordx4 v5, s[36:39], s58 offen offset:1024 lds
    s_add_u32 s58, s58, 65536
    s_cmp_ge_u32 s58, 1441792
    s_cselect_b32 s58, s63, s58
    v_mfma_f32_32x32x16_bf16 v[64:79], v[16:19], v[32:35], 0
    buffer_load_dwordx4 v[136:139], v6, s[44:47], s59 offen sc1
    buffer_load_dwordx4 v[140:143], v7, s[44:47], s59 offen sc1
    s_add_u32 s59, s59, 4096
    s_cmp_ge_u32 s59, 90112
    s_cselect_b32 s59, 0, s59
    s_waitcnt lgkmcnt(0)
    v_mfma_f32_32x32x16_bf16 v[112:127], v[28:31], v[44:47], v[112:127]
    s_waitcnt vmcnt(8)
    ds_read_b64_tr_b16 v[20:21], v12 offset:4096
    ds_read_b64_tr_b16 v[22:23], v12 offset:5120
    v_mfma_f32_32x32x16_bf16 v[96:111], v[24:27], v[44:47], v[96:111]
    ds_read_b64_tr_b16 v[16:17], v11 offset:4096
    ds_read_b64_tr_b16 v[18:19], v11 offset:5120
    v_mfma_f32_32x32x16_bf16 v[80:95], v[28:31], v[40:43], v[80:95]
    s_add_u32 m0, s56, 0
    s_nop 0
    buffer_load_dwordx4 v4, s[36:39], s58 offen lds
    buffer_load_dwordx4 v5, s[36:39], s58 offen offset:1024 lds
    s_add_u32 s58, s58, 65536
    s_cmp_ge_u32 s58, 1441792
    s_cselect_b32 s58, s63, s58
    v_mfma_f32_32x32x16_bf16 v[64:79], v[24:27], v[40:43], v[64:79]
    buffer_load_dwordx4 v[32:35], v6, s[44:47], s59 offen sc1
    buffer_load_dwordx4 v[36:39], v7, s[44:47], s59 offen sc1
    s_add_u32 s59, s59, 4096
    s_cmp_ge_u32 s59, 90112
    s_cselect_b32 s59, 0, s59
    s_waitcnt lgkmcnt(0)
    v_mfma_f32_32x32x16_bf16 v[112:127], v[20:23], v[52:55], v[112:127]
    s_waitcnt vmcnt(10)
    ds_read_b64_tr_b16 v[28:29], v12 offset:6144
    ds_read_b64_tr_b16 v[30:31], v12 offset:7168
    v_mfma_f32_32x32x16_bf16 v[96:111], v[16:19], v[52:55], v[96:111]
    ds_read_b64_tr_b16 v[24:25], v11 offset:6144
    ds_read_b64_tr_b16 v[26:27], v11 offset:7168
    v_mfma_f32_32x32x16_bf16 v[80:95], v[20:23], v[48:51], v[80:95]
    s_add_u32 m0, s56, 2048
    s_nop 0
    buffer_load_dwordx4 v4, s[36:39], s58 offen lds
    buffer_load_dwordx4 v5, s[36:39], s58 offen offset:1024 lds
    s_add_u32 s58, s58, 65536
    s_cmp_ge_u32 s58, 1441792
    s_cselect_b32 s58, s63, s58
    v_mfma_f32_32x32x16_bf16 v[64:79], v[16:19], v[48:51], v[64:79]
    buffer_load_dwordx4 v[40:43], v6, s[44:47], s59 offen sc1
    buffer_load_dwordx4 v[44:47], v7, s[44:47], s59 offen sc1
    s_add_u32 s59, s59, 4096
    s_cmp_ge_u32 s59, 90112
    s_cselect_b32 s59, 0, s59
    s_waitcnt lgkmcnt(0)
    v_mfma_f32_32x32x16_bf16 v[112:127], v[28:31], v[60:63], v[112:127]
    s_waitcnt vmcnt(12)
    ds_read_b64_tr_b16 v[20:21], v12 offset:8192
    ds_read_b64_tr_b16 v[22:23], v12 offset:9216
    v_mfma_f32_32x32x16_bf16 v[96:111], v[24:27], v[60:63], v[96:111]
    ds_read_b64_tr_b16 v[16:17], v11 offset:8192
    ds_read_b64_tr_b16 v[18:19], v11 offset:9216
    v_mfma_f32_32x32x16_bf16 v[80:95], v[28:31], v[56:59], v[80:95]
    s_add_u32 m0, s56, 4096
    s_nop 0
    buffer_load_dwordx4 v4, s[36:39], s58 offen lds
    buffer_load_dwordx4 v5, s[36:39], s58 offen offset:1024 lds
    s_add_u32 s58, s58, 65536
    s_cmp_ge_u32 s58, 1441792
    s_cselect_b32 s58, s63, s58
    v_mfma_f32_32x32x16_bf16 v[64:79], v[24:27], v[56:59], v[64:79]
    buffer_load_dwordx4 v[48:51], v6, s[44:47], s59 offen sc1
    buffer_load_dwordx4 v[52:55], v7, s[44:47], s59 offen sc1
    s_add_u32 s59, s59, 4096
    s_cmp_ge_u32 s59, 90112
    s_cselect_b32 s59, 0, s59
    s_waitcnt lgkmcnt(0)
    v_mfma_f32_32x32x16_bf16 v[112:127], v[20:23], v[132:135], v[112:127]
    s_waitcnt vmcnt(12)
    ds_read_b64_tr_b16 v[28:29], v12 offset:10240
    ds_read_b64_tr_b16 v[30:31], v12 offset:11264
    v_mfma_f32_32x32x16_bf16 v[96:111], v[16:19], v[132:135], v[96:111]
    ds_read_b64_tr_b16 v[24:25], v11 offset:10240
    ds_read_b64_tr_b16 v[26:27], v11 offset:11264
    v_mfma_f32_32x32x16_bf16 v[80:95], v[20:23], v[128:131], v[80:95]
    s_add_u32 m0, s56, 6144
    s_nop 0
    buffer_load_dwordx4 v4, s[36:39], s58 offen lds
    buffer_load_dwordx4 v5, s[36:39], s58 offen offset:1024 lds
    s_add_u32 s58, s58, 65536
    s_cmp_ge_u32 s58, 1441792
    s_cselect_b32 s58, s63, s58
    v_mfma_f32_32x32x16_bf16 v[64:79], v[16:19], v[128:131], v[64:79]
    buffer_load_dwordx4 v[56:59], v6, s[44:47], s59 offen sc1
    buffer_load_dwordx4 v[60:63], v7, s[44:47], s59 offen sc1
    s_add_u32 s59, s59, 4096
    s_cmp_ge_u32 s59, 90112
    s_cselect_b32 s59, 0, s59
    s_waitcnt lgkmcnt(0)
    v_mfma_f32_32x32x16_bf16 v[112:127], v[28:31], v[140:143], v[112:127]
    s_waitcnt vmcnt(12)
    ds_read_b64_tr_b16 v[20:21], v12 offset:0
    ds_read_b64_tr_b16 v[22:23], v12 offset:1024
    v_mfma_f32_32x32x16_bf16 v[96:111], v[24:27], v[140:143], v[96:111]
    ds_read_b64_tr_b16 v[16:17], v11 offset:0
    ds_read_b64_tr_b16 v[18:19], v11 offset:1024
    v_mfma_f32_32x32x16_bf16 v[80:95], v[28:31], v[136:139], v[80:95]
    s_add_u32 m0, s56, 8192
    s_nop 0
    buffer_load_dwordx4 v4, s[36:39], s58 offen lds
    buffer_load_dwordx4 v5, s[36:39], s58 offen offset:1024 lds
    s_add_u32 s58, s58, 65536
    s_cmp_ge_u32 s58, 1441792
    s_cselect_b32 s58, s63, s58
    v_mfma_f32_32x32x16_bf16 v[64:79], v[24:27], v[136:139], v[64:79]
    buffer_load_dwordx4 v[128:131], v6, s[44:47], s59 offen sc1
    buffer_load_dwordx4 v[132:135], v7, s[44:47], s59 offen sc1
    s_add_u32 s59, s59, 4096
    s_cmp_ge_u32 s59, 90112
    s_cselect_b32 s59, 0, s59
    s_waitcnt lgkmcnt(0)
    v_mfma_f32_32x32x16_bf16 v[112:127], v[20:23], v[36:39], v[112:127]
    s_waitcnt vmcnt(12)
    ds_read_b64_tr_b16 v[28:29], v12 offset:2048
    ds_read_b64_tr_b16 v[30:31], v12 offset:3072
    v_mfma_f32_32x32x16_bf16 v[96:111], v[16:19], v[36:39], v[96:111]
    ds_read_b64_tr_b16 v[24:25], v11 offset:2048
    ds_read_b64_tr_b16 v[26:27], v11 offset:3072
    v_mfma_f32_32x32x16_bf16 v[80:95], v[20:23], v[32:35], v[80:95]
    s_add_u32 m0, s56, 10240
    s_nop 0
    buffer_load_dwordx4 v4, s[36:39], s58 offen lds
    buffer_load_dwordx4 v5, s[36:39], s58 offen offset:1024 lds
    s_add_u32 s58, s58, 65536
    s_cmp_ge_u32 s58, 1441792
    s_cselect_b32 s58, s63, s58
    v_mfma_f32_32x32x16_bf16 v[64:79], v[16:19], v[32:35], v[64:79]
    buffer_load_dwordx4 v[136:139], v6, s[44:47], s59 offen sc1
    buffer_load_dwordx4 v[140:143], v7, s[44:47], s59 offen sc1
    s_add_u32 s59, s59, 4096
    s_cmp_ge_u32 s59, 90112
    s_cselect_b32 s59, 0, s59
    s_waitcnt lgkmcnt(0)
    v_mfma_f32_32x32x16_bf16 v[112:127], v[28:31], v[44:47], v[112:127]
    s_waitcnt vmcnt(12)
    ds_read_b64_tr_b16 v[20:21], v12 offset:4096
    ds_read_b64_tr_b16 v[22:23], v12 offset:5120
    v_mfma_f32_32x32x16_bf16 v[96:111], v[24:27], v[44:47], v[96:111]
    ds_read_b64_tr_b16 v[16:17], v11 offset:4096
    ds_read_b64_tr_b16 v[18:19], v11 offset:5120
    v_mfma_f32_32x32x16_bf16 v[80:95], v[28:31], v[40:43], v[80:95]
    s_add_u32 m0, s56, 0
    s_nop 0
    buffer_load_dwordx4 v4, s[36:39], s58 offen lds
    buffer_load_dwordx4 v5, s[36:39], s58 offen offset:1024 lds
    s_add_u32 s58, s58, 65536
    s_cmp_ge_u32 s58, 1441792
    s_cselect_b32 s58, s63, s58
    v_mfma_f32_32x32x16_bf16 v[64:79], v[24:27], v[40:43], v[64:79]
    buffer_load_dwordx4 v[32:35], v6, s[44:47], s59 offen sc1
    buffer_load_dwordx4 v[36:39], v7, s[44:47], s59 offen sc1
    s_add_u32 s59, s59, 4096
    s_cmp_ge_u32 s59, 90112
    s_cselect_b32 s59, 0, s59
    s_waitcnt lgkmcnt(0)
    v_mfma_f32_32x32x16_bf16 v[112:127], v[20:23], v[52:55], v[112:127]
    s_waitcnt vmcnt(12)
    ds_read_b64_tr_b16 v[28:29], v12 offset:6144
    ds_read_b64_tr_b16 v[30:31], v12 offset:7168
    v_mfma_f32_32x32x16_bf16 v[96:111], v[16:19], v[52:55], v[96:111]
    ds_read_b64_tr_b16 v[24:25], v11 offset:6144
    ds_read_b64_tr_b16 v[26:27], v11 offset:7168
    v_mfma_f32_32x32x16_bf16 v[80:95], v[20:23], v[48:51], v[80:95]
    s_add_u32 m0, s56, 2048
    s_nop 0
    buffer_load_dwordx4 v4, s[36:39], s58 offen lds
    buffer_load_dwordx4 v5, s[36:39], s58 offen offset:1024 lds
    s_add_u32 s58, s58, 65536
    s_cmp_ge_u32 s58, 1441792
    s_cselect_b32 s58, s63, s58
    v_mfma_f32_32x32x16_bf16 v[64:79], v[16:19], v[48:51], v[64:79]
    buffer_load_dwordx4 v[40:43], v6, s[44:47], s59 offen sc1
    buffer_load_dwordx4 v[44:47], v7, s[44:47], s59 offen sc1
    s_add_u32 s59, s59, 4096
    s_cmp_ge_u32 s59, 90112
    s_cselect_b32 s59, 0, s59
    s_waitcnt lgkmcnt(0)
    v_mfma_f32_32x32x16_bf16 v[112:127], v[28:31], v[60:63], v[112:127]
    s_waitcnt vmcnt(12)
    ds_read_b64_tr_b16 v[20:21], v12 offset:8192
    ds_read_b64_tr_b16 v[22:23], v12 offset:9216
    v_mfma_f32_32x32x16_bf16 v[96:111], v[24:27], v[60:63], v[96:111]
    ds_read_b64_tr_b16 v[16:17], v11 offset:8192
    ds_read_b64_tr_b16 v[18:19], v11 offset:9216
    v_mfma_f32_32x32x16_bf16 v[80:95], v[28:31], v[56:59], v[80:95]
    s_add_u32 m0, s56, 4096
    s_nop 0
    buffer_load_dwordx4 v4, s[36:39], s58 offen lds
    buffer_load_dwordx4 v5, s[36:39], s58 offen offset:1024 lds
    s_add_u32 s58, s58, 65536
    s_cmp_ge_u32 s58, 1441792
    s_cselect_b32 s58, s63, s58
    v_mfma_f32_32x32x16_bf16 v[64:79], v[24:27], v[56:59], v[64:79]
    buffer_load_dwordx4 v[48:51], v6, s[44:47], s59 offen sc1
    buffer_load_dwordx4 v[52:55], v7, s[44:47], s59 offen sc1
    s_add_u32 s59, s59, 4096
    s_cmp_ge_u32 s59, 90112
    s_cselect_b32 s59, 0, s59
    s_waitcnt lgkmcnt(0)
    v_mfma_f32_32x32x16_bf16 v[112:127], v[20:23], v[132:135], v[112:127]
    s_waitcnt vmcnt(12)
    ds_read_b64_tr_b16 v[28:29], v12 offset:10240
    ds_read_b64_tr_b16 v[30:31], v12 offset:11264
    v_mfma_f32_32x32x16_bf16 v[96:111], v[16:19], v[132:135], v[96:111]
    ds_read_b64_tr_b16 v[24:25], v11 offset:10240
    ds_read_b64_tr_b16 v[26:27], v11 offset:11264
    v_mfma_f32_32x32x16_bf16 v[80:95], v[20:23], v[128:131], v[80:95]
    s_add_u32 m0, s56, 6144
    s_nop 0
    buffer_load_dwordx4 v4, s[36:39], s58 offen lds
    buffer_load_dwordx4 v5, s[36:39], s58 offen offset:1024 lds
    s_add_u32 s58, s58, 65536
    s_cmp_ge_u32 s58, 1441792
    s_cselect_b32 s58, s63, s58
    v_mfma_f32_32x32x16_bf16 v[64:79], v[16:19], v[128:131], v[64:79]
    buffer_load_dwordx4 v[56:59], v6, s[44:47], s59 offen sc1
    buffer_load_dwordx4 v[60:63], v7, s[44:47], s59 offen sc1
    s_add_u32 s59, s59, 4096
    s_cmp_ge_u32 s59, 90112
    s_cselect_b32 s59, 0, s59
    s_waitcnt lgkmcnt(0)
    v_mfma_f32_32x32x16_bf16 v[112:127], v[28:31], v[140:143], v[112:127]
    s_waitcnt vmcnt(12)
    ds_read_b64_tr_b16 v[20:21], v12 offset:0
    ds_read_b64_tr_b16 v[22:23], v12 offset:1024
    v_mfma_f32_32x32x16_bf16 v[96:111], v[24:27], v[140:143], v[96:111]
    ds_read_b64_tr_b16 v[16:17], v11 offset:0
    ds_read_b64_tr_b16 v[18:19], v11 offset:1024
    v_mfma_f32_32x32x16_bf16 v[80:95], v[28:31], v[136:139], v[80:95]
    s_add_u32 m0, s56, 8192
    s_nop 0
    buffer_load_dwordx4 v4, s[36:39], s58 offen lds
    buffer_load_dwordx4 v5, s[36:39], s58 offen offset:1024 lds
    s_add_u32 s58, s58, 65536
    s_cmp_ge_u32 s58, 1441792
    s_cselect_b32 s58, s63, s58
    v_mfma_f32_32x32x16_bf16 v[64:79], v[24:27], v[136:139], v[64:79]
    buffer_load_dwordx4 v[128:131], v6, s[44:47], s59 offen sc1
    buffer_load_dwordx4 v[132:135], v7, s[44:47], s59 offen sc1
    s_add_u32 s59, s59, 4096
    s_cmp_ge_u32 s59, 90112
    s_cselect_b32 s59, 0, s59
    s_waitcnt lgkmcnt(0)
    v_mfma_f32_32x32x16_bf16 v[112:127], v[20:23], v[36:39], v[112:127]
    s_waitcnt vmcnt(12)
    ds_read_b64_tr_b16 v[28:29], v12 offset:2048
    ds_read_b64_tr_b16 v[30:31], v12 offset:3072
    v_mfma_f32_32x32x16_bf16 v[96:111], v[16:19], v[36:39], v[96:111]
    ds_read_b64_tr_b16 v[24:25], v11 offset:2048
    ds_read_b64_tr_b16 v[26:27], v11 offset:3072
    v_mfma_f32_32x32x16_bf16 v[80:95], v[20:23], v[32:35], v[80:95]
    s_add_u32 m0, s56, 10240
    s_nop 0
    buffer_load_dwordx4 v4, s[36:39], s58 offen lds
    buffer_load_dwordx4 v5, s[36:39], s58 offen offset:1024 lds
    s_add_u32 s58, s58, 65536
    s_cmp_ge_u32 s58, 1441792
    s_cselect_b32 s58, s63, s58
    v_mfma_f32_32x32x16_bf16 v[64:79], v[16:19], v[32:35], v[64:79]
    buffer_load_dwordx4 v[136:139], v6, s[44:47], s59 offen sc1
    buffer_load_dwordx4 v[140:143], v7, s[44:47], s59 offen sc1
    s_add_u32 s59, s59, 4096
    s_cmp_ge_u32 s59, 90112
    s_cselect_b32 s59, 0, s59
    s_waitcnt lgkmcnt(0)
    v_mfma_f32_32x32x16_bf16 v[112:127], v[28:31], v[44:47], v[112:127]
    s_waitcnt vmcnt(12)
    ds_read_b64_tr_b16 v[20:21], v12 offset:4096
    ds_read_b64_tr_b16 v[22:23], v12 offset:5120
    v_mfma_f32_32x32x16_bf16 v[96:111], v[24:27], v[44:47], v[96:111]
    ds_read_b64_tr_b16 v[16:17], v11 offset:4096
    ds_read_b64_tr_b16 v[18:19], v11 offset:5120
    v_mfma_f32_32x32x16_bf16 v[80:95], v[28:31], v[40:43], v[80:95]
    s_add_u32 m0, s56, 0
    s_nop 0
    buffer_load_dwordx4 v4, s[36:39], s58 offen lds
    buffer_load_dwordx4 v5, s[36:39], s58 offen offset:1024 lds
    s_add_u32 s58, s58, 65536
    s_cmp_ge_u32 s58, 1441792
    s_cselect_b32 s58, s63, s58
    v_mfma_f32_32x32x16_bf16 v[64:79], v[24:27], v[40:43], v[64:79]
    buffer_load_dwordx4 v[32:35], v6, s[44:47], s59 offen sc1
    buffer_load_dwordx4 v[36:39], v7, s[44:47], s59 offen sc1
    s_add_u32 s59, s59, 4096
    s_cmp_ge_u32 s59, 90112
    s_cselect_b32 s59, 0, s59
    s_waitcnt lgkmcnt(0)
    v_mfma_f32_32x32x16_bf16 v[112:127], v[20:23], v[52:55], v[112:127]
    s_waitcnt vmcnt(12)
    ds_read_b64_tr_b16 v[28:29], v12 offset:6144
    ds_read_b64_tr_b16 v[30:31], v12 offset:7168
    v_mfma_f32_32x32x16_bf16 v[96:111], v[16:19], v[52:55], v[96:111]
    ds_read_b64_tr_b16 v[24:25], v11 offset:6144
    ds_read_b64_tr_b16 v[26:27], v11 offset:7168
    v_mfma_f32_32x32x16_bf16 v[80:95], v[20:23], v[48:51], v[80:95]
    s_add_u32 m0, s56, 2048
    s_nop 0
    buffer_load_dwordx4 v4, s[36:39], s58 offen lds
    buffer_load_dwordx4 v5, s[36:39], s58 offen offset:1024 lds
    s_add_u32 s58, s58, 65536
    s_cmp_ge_u32 s58, 1441792
    s_cselect_b32 s58, s63, s58
    v_mfma_f32_32x32x16_bf16 v[64:79], v[16:19], v[48:51], v[64:79]
    buffer_load_dwordx4 v[40:43], v6, s[44:47], s59 offen sc1
    buffer_load_dwordx4 v[44:47], v7, s[44:47], s59 offen sc1
    s_add_u32 s59, s59, 4096
    s_cmp_ge_u32 s59, 90112
    s_cselect_b32 s59, 0, s59
    s_waitcnt lgkmcnt(0)
    v_mfma_f32_32x32x16_bf16 v[112:127], v[28:31], v[60:63], v[112:127]
    s_waitcnt vmcnt(12)
    ds_read_b64_tr_b16 v[20:21], v12 offset:8192
    ds_read_b64_tr_b16 v[22:23], v12 offset:9216
    v_mfma_f32_32x32x16_bf16 v[96:111], v[24:27], v[60:63], v[96:111]
    ds_read_b64_tr_b16 v[16:17], v11 offset:8192
    ds_read_b64_tr_b16 v[18:19], v11 offset:9216
    v_mfma_f32_32x32x16_bf16 v[80:95], v[28:31], v[56:59], v[80:95]
    s_add_u32 m0, s56, 4096
    s_nop 0
    buffer_load_dwordx4 v4, s[36:39], s58 offen lds
    buffer_load_dwordx4 v5, s[36:39], s58 offen offset:1024 lds
    s_add_u32 s58, s58, 65536
    s_cmp_ge_u32 s58, 1441792
    s_cselect_b32 s58, s63, s58
    v_mfma_f32_32x32x16_bf16 v[64:79], v[24:27], v[56:59], v[64:79]
    buffer_load_dwordx4 v[48:51], v6, s[44:47], s59 offen sc1
    buffer_load_dwordx4 v[52:55], v7, s[44:47], s59 offen sc1
    s_add_u32 s59, s59, 4096
    s_cmp_ge_u32 s59, 90112
    s_cselect_b32 s59, 0, s59
    s_waitcnt lgkmcnt(0)
    v_mfma_f32_32x32x16_bf16 v[112:127], v[20:23], v[132:135], v[112:127]
    s_waitcnt vmcnt(12)
    ds_read_b64_tr_b16 v[28:29], v12 offset:10240
    ds_read_b64_tr_b16 v[30:31], v12 offset:11264
    v_mfma_f32_32x32x16_bf16 v[96:111], v[16:19], v[132:135], v[96:111]
    ds_read_b64_tr_b16 v[24:25], v11 offset:10240
    ds_read_b64_tr_b16 v[26:27], v11 offset:11264
    v_mfma_f32_32x32x16_bf16 v[80:95], v[20:23], v[128:131], v[80:95]
    s_add_u32 m0, s56, 6144
    s_nop 0
    buffer_load_dwordx4 v4, s[36:39], s58 offen lds
    buffer_load_dwordx4 v5, s[36:39], s58 offen offset:1024 lds
    s_add_u32 s58, s58, 65536
    s_cmp_ge_u32 s58, 1441792
    s_cselect_b32 s58, s63, s58
    v_mfma_f32_32x32x16_bf16 v[64:79], v[16:19], v[128:131], v[64:79]
    buffer_load_dwordx4 v[56:59], v6, s[44:47], s59 offen sc1
    buffer_load_dwordx4 v[60:63], v7, s[44:47], s59 offen sc1
    s_add_u32 s59, s59, 4096
    s_cmp_ge_u32 s59, 90112
    s_cselect_b32 s59, 0, s59
    s_waitcnt lgkmcnt(0)
    v_mfma_f32_32x32x16_bf16 v[112:127], v[28:31], v[140:143], v[112:127]
    s_waitcnt vmcnt(12)
    ds_read_b64_tr_b16 v[20:21], v12 offset:0
    ds_read_b64_tr_b16 v[22:23], v12 offset:1024
    v_mfma_f32_32x32x16_bf16 v[96:111], v[24:27], v[140:143], v[96:111]
    ds_read_b64_tr_b16 v[16:17], v11 offset:0
    ds_read_b64_tr_b16 v[18:19], v11 offset:1024
    v_mfma_f32_32x32x16_bf16 v[80:95], v[28:31], v[136:139], v[80:95]
    v_mfma_f32_32x32x16_bf16 v[64:79], v[24:27], v[136:139], v[64:79]
    s_waitcnt lgkmcnt(0)
    v_mfma_f32_32x32x16_bf16 v[112:127], v[20:23], v[36:39], v[112:127]
    s_waitcnt vmcnt(8)
    ds_read_b64_tr_b16 v[28:29], v12 offset:2048
    ds_read_b64_tr_b16 v[30:31], v12 offset:3072
    v_mfma_f32_32x32x16_bf16 v[96:111], v[16:19], v[36:39], v[96:111]
    ds_read_b64_tr_b16 v[24:25], v11 offset:2048
    ds_read_b64_tr_b16 v[26:27], v11 offset:3072
    v_mfma_f32_32x32x16_bf16 v[80:95], v[20:23], v[32:35], v[80:95]
    v_mfma_f32_32x32x16_bf16 v[64:79], v[16:19], v[32:35], v[64:79]
    s_waitcnt lgkmcnt(0)
    v_mfma_f32_32x32x16_bf16 v[112:127], v[28:31], v[44:47], v[112:127]
    s_waitcnt vmcnt(4)
    ds_read_b64_tr_b16 v[20:21], v12 offset:4096
    ds_read_b64_tr_b16 v[22:23], v12 offset:5120
    v_mfma_f32_32x32x16_bf16 v[96:111], v[24:27], v[44:47], v[96:111]
    ds_read_b64_tr_b16 v[16:17], v11 offset:4096
    ds_read_b64_tr_b16 v[18:19], v11 offset:5120
    v_mfma_f32_32x32x16_bf16 v[80:95], v[28:31], v[40:43], v[80:95]
    v_mfma_f32_32x32x16_bf16 v[64:79], v[24:27], v[40:43], v[64:79]
    s_waitcnt lgkmcnt(0)
    v_mfma_f32_32x32x16_bf16 v[112:127], v[20:23], v[52:55], v[112:127]
    s_waitcnt vmcnt(0)
    ds_read_b64_tr_b16 v[28:29], v12 offset:6144
    ds_read_b64_tr_b16 v[30:31], v12 offset:7168
    v_mfma_f32_32x32x16_bf16 v[96:111], v[16:19], v[52:55], v[96:111]
    ds_read_b64_tr_b16 v[24:25], v11 offset:6144
    ds_read_b64_tr_b16 v[26:27], v11 offset:7168
    v_mfma_f32_32x32x16_bf16 v[80:95], v[20:23], v[48:51], v[80:95]
    v_mfma_f32_32x32x16_bf16 v[64:79], v[16:19], v[48:51], v[64:79]
    s_waitcnt lgkmcnt(0)
    v_mfma_f32_32x32x16_bf16 v[112:127], v[28:31], v[60:63], v[112:127]
    v_mfma_f32_32x32x16_bf16 v[96:111], v[24:27], v[60:63], v[96:111]
    v_mfma_f32_32x32x16_bf16 v[80:95], v[28:31], v[56:59], v[80:95]
    v_mfma_f32_32x32x16_bf16 v[64:79], v[24:27], v[56:59], v[64:79]
    s_setprio 3
    v_add_u32 v152, s56, v13
    s_nop 3
    s_lshl_b32 s6, s61, 7
    v_lshl_add_u32 v12, v8, 2, v2
    v_add_u32 v12, s6, v12
    s_lshl_b32 s6, s31, 13
    s_add_u32 s6, s6, 91136
    v_add_u32 v5, s6, v13
    ds_write_b128 v152, v[112:115] offset:8192
    ds_write_b128 v152, v[116:119] offset:9216
    ds_write_b128 v152, v[120:123] offset:10240
    ds_write_b128 v152, v[124:127] offset:11264
    ds_write_b128 v152, v[96:99] offset:4096
    ds_write_b128 v152, v[100:103] offset:5120
    ds_write_b128 v152, v[104:107] offset:6144
    ds_write_b128 v152, v[108:111] offset:7168
    ds_write_b128 v152, v[80:83] offset:0
    ds_write_b128 v152, v[84:87] offset:1024
    ds_write_b128 v152, v[88:91] offset:2048
    ds_write_b128 v152, v[92:95] offset:3072
    s_mov_b64 exec, 1
    ds_add_u32 v2, v3 offset:28
    s_mov_b64 exec, -1
    ds_read_b32 v12, v12 offset:256
    s_lshl_b32 s6, s31, 10
    s_add_u32 s7, s6, 82944
    v_lshlrev_b32 v6, 2, v8
    v_add_u32 v6, s7, v6
    v_and_b32 v15, 3, v1
    v_lshlrev_b32 v15, 8, v15
    v_add_u32 v7, s7, v15
    s_lshl_b32 s7, s61, 10
    s_add_u32 s59, s7, 82944
    v_add_u32 v15, 83968, v15
    s_lshl_b32 s57, s30, 13
    s_add_u32 s57, s57, s6
    s_add_u32 s57, s57, 4194304
    s_lshl_b32 s59, s4, 16
    s_add_u32 s59, s59, s7
    s_add_u32 s59, s59, 4194304
    s_mov_b32 s60, 0x7b800000
    s_mov_b32 s54, 32768
G_o0_top:
    ds_read_b32 v52, v7 offset:128
    s_waitcnt lgkmcnt(0)
    v_cmp_eq_u32 vcc, 0, v52
    s_nop 0
    s_cbranch_vccz G_o0_ok
    s_sleep 2
    s_sub_u32 s54, s54, 1
    s_cmp_lg_u32 s54, 0
    s_cbranch_scc1 G_o0_top
G_o0_ok:
    ds_read2st64_b32 v[48:49], v6 offset0:0 offset1:1
    ds_read2st64_b32 v[50:51], v6 offset0:2 offset1:3
    ds_read_b128 v[16:19], v5 offset:0
    ds_read_b128 v[20:23], v5 offset:1024
    ds_read_b128 v[24:27], v5 offset:2048
    ds_read_b128 v[28:31], v5 offset:3072
    ds_read_b128 v[32:35], v5 offset:4096
    ds_read_b128 v[36:39], v5 offset:5120
    ds_read_b128 v[40:43], v5 offset:6144
    ds_read_b128 v[44:47], v5 offset:7168
    s_cmp_eq_u32 s31, 3
    s_mov_b32 s6, 32768
    s_cselect_b32 s6, 4294918144, s6
    v_add_u32 v5, s6, v5
    s_add_u32 s64, s31, 0
    s_waitcnt lgkmcnt(8)
    v_pk_add_f32 v[48:49], v[48:49], v[50:51]
    s_waitcnt lgkmcnt(4)
    v_add_f32 v48, v48, v49
    v_pk_add_f32 v[16:17], v[16:17], v[24:25]
    v_pk_add_f32 v[18:19], v[18:19], v[26:27]
    v_pk_add_f32 v[20:21], v[20:21], v[28:29]
    v_pk_add_f32 v[22:23], v[22:23], v[30:31]
    v_rcp_f32 v50, v48
    s_waitcnt lgkmcnt(0)
    v_pk_add_f32 v[32:33], v[32:33], v[40:41]
    v_pk_add_f32 v[34:35], v[34:35], v[42:43]
    v_pk_add_f32 v[36:37], v[36:37], v[44:45]
    v_pk_add_f32 v[38:39], v[38:39], v[46:47]
    v_pk_add_f32 v[16:17], v[16:17], v[32:33]
    v_pk_add_f32 v[18:19], v[18:19], v[34:35]
    v_pk_add_f32 v[20:21], v[20:21], v[36:37]
    v_pk_add_f32 v[22:23], v[22:23], v[38:39]
    v_maximum3_f32 v48, |v16|, |v17|, v48
    v_maximum3_f32 v48, |v18|, |v19|, v48
    v_maximum3_f32 v48, |v20|, |v21|, v48
    v_maximum3_f32 v48, |v22|, |v23|, v48
    v_cmp_ngt_f32 vcc, s60, v48
    s_nop 0
    s_cbranch_vccnz G_fb
G_ret0:
    v_pk_mul_f32 v[16:17], v[16:17], v[50:51] op_sel_hi:[1,0]
    v_pk_mul_f32 v[18:19], v[18:19], v[50:51] op_sel_hi:[1,0]
    v_pk_mul_f32 v[20:21], v[20:21], v[50:51] op_sel_hi:[1,0]
    v_pk_mul_f32 v[22:23], v[22:23], v[50:51] op_sel_hi:[1,0]
    v_cvt_pk_bf16_f32 v24, v16, v17
    v_cvt_pk_bf16_f32 v25, v18, v19
    v_cvt_pk_bf16_f32 v26, v20, v21
    v_cvt_pk_bf16_f32 v27, v22, v23
    buffer_store_dwordx4 v[24:27], v13, s[44:47], s57 offen sc1
    s_add_u32 s36, s59, 6144
    s_add_u32 s37, s59, 14336
    s_add_u32 s38, s59, 22528
    s_add_u32 s39, s59, 30720
    s_add_u32 s40, s59, 38912
    s_add_u32 s41, s59, 47104
    s_add_u32 s42, s59, 55296
    s_add_u32 s43, s59, 63488
    s_cmp_eq_u32 s31, 3
    s_cbranch_scc1 G_x3
    v_pk_mul_f32 v[64:65], v[64:65], v[12:13] op_sel_hi:[1,0]
    v_pk_mul_f32 v[66:67], v[66:67], v[12:13] op_sel_hi:[1,0]
    v_pk_mul_f32 v[68:69], v[68:69], v[12:13] op_sel_hi:[1,0]
    v_pk_mul_f32 v[70:71], v[70:71], v[12:13] op_sel_hi:[1,0]
    v_pk_mul_f32 v[72:73], v[72:73], v[12:13] op_sel_hi:[1,0]
    v_pk_mul_f32 v[74:75], v[74:75], v[12:13] op_sel_hi:[1,0]
    v_pk_mul_f32 v[76:77], v[76:77], v[12:13] op_sel_hi:[1,0]
    v_pk_mul_f32 v[78:79], v[78:79], v[12:13] op_sel_hi:[1,0]
G_red1:
    s_mov_b32 s54, 32768
G_o1_top:
    ds_read_b32 v52, v7 offset:4224
    s_waitcnt lgkmcnt(0)
    v_cmp_eq_u32 vcc, 0, v52
    s_nop 0
    s_cbranch_vccz G_o1_ok
    s_cmp_eq_u32 s31, 3
    s_cbranch_scc1 G_o1_ns
    s_sleep 3
G_o1_ns:
    s_sleep 0
    s_sub_u32 s54, s54, 1
    s_cmp_lg_u32 s54, 0
    s_cbranch_scc1 G_o1_top
G_o1_ok:
    ds_read2st64_b32 v[48:49], v6 offset0:16 offset1:17
    ds_read2st64_b32 v[50:51], v6 offset0:18 offset1:19
    ds_read_b128 v[16:19], v5 offset:0
    ds_read_b128 v[20:23], v5 offset:1024
    ds_read_b128 v[24:27], v5 offset:2048
    ds_read_b128 v[28:31], v5 offset:3072
    ds_read_b128 v[32:35], v5 offset:4096
    ds_read_b128 v[36:39], v5 offset:5120
    ds_read_b128 v[40:43], v5 offset:6144
    ds_read_b128 v[44:47], v5 offset:7168
    s_add_u32 s64, s31, 4
    s_waitcnt lgkmcnt(8)
    v_pk_add_f32 v[48:49], v[48:49], v[50:51]
    s_waitcnt lgkmcnt(4)
    v_add_f32 v48, v48, v49
    v_pk_add_f32 v[16:17], v[16:17], v[24:25]
    v_pk_add_f32 v[18:19], v[18:19], v[26:27]
    v_pk_add_f32 v[20:21], v[20:21], v[28:29]
    v_pk_add_f32 v[22:23], v[22:23], v[30:31]
    v_rcp_f32 v50, v48
    s_waitcnt lgkmcnt(0)
    v_pk_add_f32 v[32:33], v[32:33], v[40:41]
    v_pk_add_f32 v[34:35], v[34:35], v[42:43]
    v_pk_add_f32 v[36:37], v[36:37], v[44:45]
    v_pk_add_f32 v[38:39], v[38:39], v[46:47]
    v_pk_add_f32 v[16:17], v[16:17], v[32:33]
    v_pk_add_f32 v[18:19], v[18:19], v[34:35]
    v_pk_add_f32 v[20:21], v[20:21], v[36:37]
    v_pk_add_f32 v[22:23], v[22:23], v[38:39]
    v_maximum3_f32 v48, |v16|, |v17|, v48
    v_maximum3_f32 v48, |v18|, |v19|, v48
    v_maximum3_f32 v48, |v20|, |v21|, v48
    v_maximum3_f32 v48, |v22|, |v23|, v48
    v_cmp_ngt_f32 vcc, s60, v48
    s_nop 0
    s_cbranch_vccnz G_fb
G_ret1:
    v_pk_mul_f32 v[16:17], v[16:17], v[50:51] op_sel_hi:[1,0]
    v_pk_mul_f32 v[18:19], v[18:19], v[50:51] op_sel_hi:[1,0]
    v_pk_mul_f32 v[20:21], v[20:21], v[50:51] op_sel_hi:[1,0]
    v_pk_mul_f32 v[22:23], v[22:23], v[50:51] op_sel_hi:[1,0]
    v_cvt_pk_bf16_f32 v24, v16, v17
    v_cvt_pk_bf16_f32 v25, v18, v19
    v_cvt_pk_bf16_f32 v26, v20, v21
    v_cvt_pk_bf16_f32 v27, v22, v23
    s_add_u32 s57, s57, 4096
    buffer_store_dwordx4 v[24:27], v13, s[44:47], s57 offen sc1
    s_cmp_eq_u32 s31, 3
    s_cbranch_scc0 G_n3
    s_add_u32 s6, s59, 6144
    buffer_load_dwordx4 v[128:131], v13, s[44:47], s6 offen offset:0 sc1
    s_add_u32 s6, s6, 8192
    buffer_load_dwordx4 v[132:135], v13, s[44:47], s6 offen offset:0 sc1
    s_add_u32 s6, s6, 8192
    buffer_load_dwordx4 v[136:139], v13, s[44:47], s6 offen offset:0 sc1
    s_add_u32 s6, s6, 8192
    buffer_load_dwordx4 v[140:143], v13, s[44:47], s6 offen offset:0 sc1
    s_add_u32 s6, s6, 8192
    buffer_load_dwordx4 v[144:147], v13, s[44:47], s6 offen offset:0 sc1
    s_add_u32 s6, s6, 8192
    buffer_load_dwordx4 v[148:151], v13, s[44:47], s6 offen offset:0 sc1
    s_add_u32 s6, s6, 8192
    buffer_load_dwordx4 v[152:155], v13, s[44:47], s6 offen offset:0 sc1
    s_add_u32 s6, s6, 8192
    buffer_load_dwordx4 v[156:159], v13, s[44:47], s6 offen offset:0 sc1
    s_cmp_eq_u32 s58, 0
    s_cbranch_scc1 G_s2
    s_branch G_k3
G_n3:
    v_and_b32 v5, 3, v1
    v_bfe_u32 v6, v1, 2, 3
    v_min_u32 v5, 2, v5
    v_lshlrev_b32 v6, 13, v6
    v_lshl_add_u32 v6, v5, 11, v6
    s_mov_b32 s54, 32768
G_pp_top:
    buffer_load_dword v7, v6, s[44:47], s59 offen offset:1020 sc1
    s_waitcnt vmcnt(0)
    v_cmp_eq_u32 vcc, -1, v7
    s_nop 0
    s_cbranch_vccz G_pp_ok
    s_sleep 4
    s_sub_u32 s54, s54, 1
    s_cmp_lg_u32 s54, 0
    s_cbranch_scc1 G_pp_top
G_pp_ok:
    s_add_u32 s6, s59, 0
    buffer_load_dwordx4 v[80:83], v13, s[44:47], s6 offen offset:0 sc1
    buffer_load_dwordx4 v[16:19], v13, s[44:47], s6 offen offset:2048 sc1
    s_add_u32 s6, s6, 8192
    buffer_load_dwordx4 v[84:87], v13, s[44:47], s6 offen offset:0 sc1
    buffer_load_dwordx4 v[20:23], v13, s[44:47], s6 offen offset:2048 sc1
    s_add_u32 s6, s6, 8192
    buffer_load_dwordx4 v[88:91], v13, s[44:47], s6 offen offset:0 sc1
    buffer_load_dwordx4 v[24:27], v13, s[44:47], s6 offen offset:2048 sc1
    s_add_u32 s6, s6, 8192
    buffer_load_dwordx4 v[92:95], v13, s[44:47], s6 offen offset:0 sc1
    buffer_load_dwordx4 v[28:31], v13, s[44:47], s6 offen offset:2048 sc1
    s_add_u32 s6, s6, 8192
    buffer_load_dwordx4 v[96:99], v13, s[44:47], s6 offen offset:0 sc1
    buffer_load_dwordx4 v[32:35], v13, s[44:47], s6 offen offset:2048 sc1
    s_add_u32 s6, s6, 8192
    buffer_load_dwordx4 v[100:103], v13, s[44:47], s6 offen offset:0 sc1
    buffer_load_dwordx4 v[36:39], v13, s[44:47], s6 offen offset:2048 sc1
    s_add_u32 s6, s6, 8192
    buffer_load_dwordx4 v[104:107], v13, s[44:47], s6 offen offset:0 sc1
    buffer_load_dwordx4 v[40:43], v13, s[44:47], s6 offen offset:2048 sc1
    s_add_u32 s6, s6, 8192
    buffer_load_dwordx4 v[108:111], v13, s[44:47], s6 offen offset:0 sc1
    buffer_load_dwordx4 v[44:47], v13, s[44:47], s6 offen offset:2048 sc1
    s_add_u32 s6, s59, 4096
    buffer_load_dwordx4 v[48:51], v13, s[44:47], s6 offen offset:0 sc1
    s_add_u32 s6, s6, 8192
    buffer_load_dwordx4 v[52:55], v13, s[44:47], s6 offen offset:0 sc1
    s_add_u32 s6, s6, 8192
    buffer_load_dwordx4 v[56:59], v13, s[44:47], s6 offen offset:0 sc1
    s_add_u32 s6, s6, 8192
    buffer_load_dwordx4 v[60:63], v13, s[44:47], s6 offen offset:0 sc1
    s_add_u32 s6, s6, 8192
    buffer_load_dwordx4 v[112:115], v13, s[44:47], s6 offen offset:0 sc1
    s_add_u32 s6, s6, 8192
    buffer_load_dwordx4 v[116:119], v13, s[44:47], s6 offen offset:0 sc1
    s_add_u32 s6, s6, 8192
    buffer_load_dwordx4 v[120:123], v13, s[44:47], s6 offen offset:0 sc1
    s_add_u32 s6, s6, 8192
    buffer_load_dwordx4 v[124:127], v13, s[44:47], s6 offen offset:0 sc1
    s_mov_b32 s54, 32768
G_r1b_top:
    ds_read_b32 v5, v2 offset:28
    s_waitcnt lgkmcnt(0)
    v_readfirstlane_b32 s6, v5
    s_cmp_ge_u32 s6, 4
    s_cbranch_scc1 G_r1b_ok
    s_sleep 1
    s_sub_u32 s54, s54, 1
    s_cmp_lg_u32 s54, 0
    s_cbranch_scc1 G_r1b_top
G_r1b_ok:
    s_mov_b32 s66, 0x00003f80
    s_mov_b32 s67, 0x3f800000
    s_mov_b32 s54, 32768
G_g3_top:
    ds_read_b32 v5, v15 offset:6272
    s_waitcnt lgkmcnt(0)
    v_cmp_eq_u32 vcc, 0, v5
    s_nop 0
    s_cbranch_vccz G_g3_ok
    s_sleep 2
    s_sub_u32 s54, s54, 1
    s_cmp_lg_u32 s54, 0
    s_cbranch_scc1 G_g3_top
G_g3_ok:
    v_dot2_f32_bf16 v64, v144, s66, v64
    v_dot2_f32_bf16 v65, v144, s67, v65
    v_dot2_f32_bf16 v66, v145, s66, v66
    v_dot2_f32_bf16 v67, v145, s67, v67
    v_dot2_f32_bf16 v68, v146, s66, v68
    v_dot2_f32_bf16 v69, v146, s67, v69
    v_dot2_f32_bf16 v70, v147, s66, v70
    v_dot2_f32_bf16 v71, v147, s67, v71
    v_dot2_f32_bf16 v72, v148, s66, v72
    v_dot2_f32_bf16 v73, v148, s67, v73
    v_dot2_f32_bf16 v74, v149, s66, v74
    v_dot2_f32_bf16 v75, v149, s67, v75
    v_dot2_f32_bf16 v76, v150, s66, v76
    v_dot2_f32_bf16 v77, v150, s67, v77
    v_dot2_f32_bf16 v78, v151, s66, v78
    v_dot2_f32_bf16 v79, v151, s67, v79
    s_waitcnt vmcnt(0)
    v_max3_u32 v5, v80, v81, v82
    v_max_u32 v5, v5, v83
    v_max3_u32 v5, v84, v85, v5
    v_max3_u32 v5, v86, v87, v5
    v_max3_u32 v5, v88, v89, v5
    v_max3_u32 v5, v90, v91, v5
    v_max3_u32 v5, v92, v93, v5
    v_max3_u32 v5, v94, v95, v5
    v_max3_u32 v5, v96, v97, v5
    v_max3_u32 v5, v98, v99, v5
    v_max3_u32 v5, v100, v101, v5
    v_max3_u32 v5, v102, v103, v5
    v_max3_u32 v5, v104, v105, v5
    v_max3_u32 v5, v106, v107, v5
    v_max3_u32 v5, v108, v109, v5
    v_max3_u32 v5, v110, v111, v5
    v_cmp_eq_u32 vcc, -1, v5
    s_nop 0
    s_cbranch_vccnz G_s0
G_b0:
    v_mfma_f32_32x32x16_bf16 v[64:79], v[160:163], v[80:83], v[64:79]
    v_max3_u32 v5, v16, v17, v18
    v_max_u32 v5, v5, v19
    v_max3_u32 v5, v48, v49, v5
    v_max3_u32 v5, v50, v51, v5
    v_mfma_f32_32x32x16_bf16 v[64:79], v[164:167], v[84:87], v[64:79]
    v_max3_u32 v5, v20, v21, v5
    v_max3_u32 v5, v22, v23, v5
    v_max3_u32 v5, v52, v53, v5
    v_max3_u32 v5, v54, v55, v5
    v_mfma_f32_32x32x16_bf16 v[64:79], v[168:171], v[88:91], v[64:79]
    v_max3_u32 v5, v24, v25, v5
    v_max3_u32 v5, v26, v27, v5
    v_max3_u32 v5, v56, v57, v5
    v_max3_u32 v5, v58, v59, v5
    v_mfma_f32_32x32x16_bf16 v[64:79], v[172:175], v[92:95], v[64:79]
    v_max3_u32 v5, v28, v29, v5
    v_max3_u32 v5, v30, v31, v5
    v_max3_u32 v5, v60, v61, v5
    v_max3_u32 v5, v62, v63, v5
    v_mfma_f32_32x32x16_bf16 v[64:79], v[176:179], v[96:99], v[64:79]
    v_max3_u32 v5, v32, v33, v5
    v_max3_u32 v5, v34, v35, v5
    v_max3_u32 v5, v112, v113, v5
    v_max3_u32 v5, v114, v115, v5
    s_add_u32 s6, s59, 6144
    buffer_load_dwordx4 v[128:131], v13, s[44:47], s6 offen offset:0 sc1
    s_add_u32 s6, s6, 8192
    buffer_load_dwordx4 v[132:135], v13, s[44:47], s6 offen offset:0 sc1
    s_add_u32 s6, s6, 8192
    buffer_load_dwordx4 v[136:139], v13, s[44:47], s6 offen offset:0 sc1
    s_add_u32 s6, s6, 8192
    buffer_load_dwordx4 v[140:143], v13, s[44:47], s6 offen offset:0 sc1
    s_add_u32 s6, s6, 8192
    buffer_load_dwordx4 v[144:147], v13, s[44:47], s6 offen offset:0 sc1
    s_add_u32 s6, s6, 8192
    buffer_load_dwordx4 v[148:151], v13, s[44:47], s6 offen offset:0 sc1
    s_add_u32 s6, s6, 8192
    buffer_load_dwordx4 v[152:155], v13, s[44:47], s6 offen offset:0 sc1
    s_add_u32 s6, s6, 8192
    buffer_load_dwordx4 v[156:159], v13, s[44:47], s6 offen offset:0 sc1
    v_mfma_f32_32x32x16_bf16 v[64:79], v[180:183], v[100:103], v[64:79]
    v_max3_u32 v5, v36, v37, v5
    v_max3_u32 v5, v38, v39, v5
    v_max3_u32 v5, v116, v117, v5
    v_max3_u32 v5, v118, v119, v5
    v_mfma_f32_32x32x16_bf16 v[64:79], v[184:187], v[104:107], v[64:79]
    v_max3_u32 v5, v40, v41, v5
    v_max3_u32 v5, v42, v43, v5
    v_max3_u32 v5, v120, v121, v5
    v_max3_u32 v5, v122, v123, v5
    v_mfma_f32_32x32x16_bf16 v[64:79], v[188:191], v[108:111], v[64:79]
    v_max3_u32 v5, v44, v45, v5
    v_max3_u32 v5, v46, v47, v5
    v_max3_u32 v5, v124, v125, v5
    v_max3_u32 v5, v126, v127, v5
    v_cmp_eq_u32 vcc, -1, v5
    s_nop 0
    s_cbranch_vccnz G_s1
G_b1:
    v_mfma_f32_32x32x16_bf16 v[64:79], v[192:195], v[16:19], v[64:79]
    s_xor_b32 s6, s31, 1
    s_mul_i32 s6, s6, 12288
    v_add_u32 v5, s6, v13
    ds_read_b64_tr_b16 v[160:161], v14 offset:49152
    ds_read_b64_tr_b16 v[162:163], v14 offset:50176
    v_mfma_f32_32x32x16_bf16 v[64:79], v[196:199], v[20:23], v[64:79]
    s_xor_b32 s6, s31, 2
    s_mul_i32 s6, s6, 12288
    v_add_u32 v6, s6, v13
    ds_read_b64_tr_b16 v[164:165], v14 offset:51200
    ds_read_b64_tr_b16 v[166:167], v14 offset:52224
    v_mfma_f32_32x32x16_bf16 v[64:79], v[200:203], v[24:27], v[64:79]
    s_xor_b32 s6, s31, 3
    s_mul_i32 s6, s6, 12288
    v_add_u32 v7, s6, v13
    ds_read_b64_tr_b16 v[168:169], v14 offset:53248
    ds_read_b64_tr_b16 v[170:171], v14 offset:54272
    v_mfma_f32_32x32x16_bf16 v[64:79], v[204:207], v[28:31], v[64:79]
    ds_read_b64_tr_b16 v[172:173], v14 offset:55296
    ds_read_b64_tr_b16 v[174:175], v14 offset:56320
    v_mfma_f32_32x32x16_bf16 v[64:79], v[208:211], v[32:35], v[64:79]
    ds_read_b64_tr_b16 v[176:177], v14 offset:57344
    ds_read_b64_tr_b16 v[178:179], v14 offset:58368
    v_mfma_f32_32x32x16_bf16 v[64:79], v[212:215], v[36:39], v[64:79]
    ds_read_b64_tr_b16 v[180:181], v14 offset:59392
    ds_read_b64_tr_b16 v[182:183], v14 offset:60416
    v_mfma_f32_32x32x16_bf16 v[64:79], v[216:219], v[40:43], v[64:79]
    ds_read_b64_tr_b16 v[184:185], v14 offset:61440
    ds_read_b64_tr_b16 v[186:187], v14 offset:62464
    s_waitcnt lgkmcnt(8)
    v_mfma_f32_32x32x16_bf16 v[64:79], v[220:223], v[44:47], v[64:79]
    ds_read_b64_tr_b16 v[188:189], v14 offset:63488
    ds_read_b64_tr_b16 v[190:191], v14 offset:64512
    s_waitcnt lgkmcnt(2)
    ds_read_b128 v[88:91], v5 offset:0
    ds_read_b128 v[92:95], v5 offset:1024
    ds_read_b128 v[96:99], v5 offset:2048
    ds_read_b128 v[100:103], v5 offset:3072
    ds_read_b128 v[16:19], v6 offset:4096
    ds_read_b128 v[20:23], v6 offset:5120
    ds_read_b128 v[24:27], v6 offset:6144
    ds_read_b128 v[28:31], v6 offset:7168
    ds_read_b128 v[32:35], v7 offset:8192
    ds_read_b128 v[36:39], v7 offset:9216
    ds_read_b128 v[40:43], v7 offset:10240
    ds_read_b128 v[44:47], v7 offset:11264
    v_mfma_f32_32x32x16_bf16 v[64:79], v[224:227], v[48:51], v[64:79]
    v_mfma_f32_32x32x16_bf16 v[64:79], v[228:231], v[52:55], v[64:79]
    v_mfma_f32_32x32x16_bf16 v[64:79], v[232:235], v[56:59], v[64:79]
    s_waitcnt lgkmcnt(4)
    v_pk_add_f32 v[88:89], v[88:89], v[16:17]
    v_pk_add_f32 v[90:91], v[90:91], v[18:19]
    v_pk_add_f32 v[92:93], v[92:93], v[20:21]
    v_mfma_f32_32x32x16_bf16 v[64:79], v[236:239], v[60:63], v[64:79]
    v_pk_add_f32 v[94:95], v[94:95], v[22:23]
    v_pk_add_f32 v[96:97], v[96:97], v[24:25]
    v_pk_add_f32 v[98:99], v[98:99], v[26:27]
    v_mfma_f32_32x32x16_bf16 v[64:79], v[240:243], v[112:115], v[64:79]
    v_pk_add_f32 v[100:101], v[100:101], v[28:29]
    v_pk_add_f32 v[102:103], v[102:103], v[30:31]
    v_mfma_f32_32x32x16_bf16 v[64:79], v[244:247], v[116:119], v[64:79]
    s_waitcnt lgkmcnt(0)
    v_pk_add_f32 v[88:89], v[88:89], v[32:33]
    v_pk_add_f32 v[90:91], v[90:91], v[34:35]
    v_pk_add_f32 v[92:93], v[92:93], v[36:37]
    v_mfma_f32_32x32x16_bf16 v[64:79], v[248:251], v[120:123], v[64:79]
    v_pk_add_f32 v[94:95], v[94:95], v[38:39]
    v_pk_add_f32 v[96:97], v[96:97], v[40:41]
    v_pk_add_f32 v[98:99], v[98:99], v[42:43]
    v_mfma_f32_32x32x16_bf16 v[64:79], v[252:255], v[124:127], v[64:79]
    v_pk_add_f32 v[100:101], v[100:101], v[44:45]
    v_pk_add_f32 v[102:103], v[102:103], v[46:47]
    s_nop 9
    v_pk_fma_f32 v[64:65], v[88:89], v[12:13], v[64:65] op_sel_hi:[1,0,1]
    v_pk_fma_f32 v[66:67], v[90:91], v[12:13], v[66:67] op_sel_hi:[1,0,1]
    v_pk_fma_f32 v[68:69], v[92:93], v[12:13], v[68:69] op_sel_hi:[1,0,1]
    v_pk_fma_f32 v[70:71], v[94:95], v[12:13], v[70:71] op_sel_hi:[1,0,1]
    v_pk_fma_f32 v[72:73], v[96:97], v[12:13], v[72:73] op_sel_hi:[1,0,1]
    v_pk_fma_f32 v[74:75], v[98:99], v[12:13], v[74:75] op_sel_hi:[1,0,1]
    v_pk_fma_f32 v[76:77], v[100:101], v[12:13], v[76:77] op_sel_hi:[1,0,1]
    v_pk_fma_f32 v[78:79], v[102:103], v[12:13], v[78:79] op_sel_hi:[1,0,1]
G_k3:
    s_waitcnt vmcnt(7)
    v_max3_u32 v52, v128, v129, v130
    v_max_u32 v52, v52, v131
    v_cmp_eq_u32 s[8:9], -1, v52
    s_waitcnt vmcnt(6)
    v_max3_u32 v53, v132, v133, v134
    v_max_u32 v53, v53, v135
    v_cmp_eq_u32 s[10:11], -1, v53
    s_or_b64 s[6:7], s[8:9], s[8:9]
    s_waitcnt vmcnt(5)
    v_max3_u32 v52, v136, v137, v138
    v_max_u32 v52, v52, v139
    v_cmp_eq_u32 s[12:13], -1, v52
    s_or_b64 s[6:7], s[6:7], s[10:11]
    s_waitcnt vmcnt(4)
    v_max3_u32 v53, v140, v141, v142
    v_max_u32 v53, v53, v143
    v_cmp_eq_u32 s[14:15], -1, v53
    s_or_b64 s[6:7], s[6:7], s[12:13]
    s_waitcnt vmcnt(3)
    v_max3_u32 v52, v144, v145, v146
    v_max_u32 v52, v52, v147
    v_cmp_eq_u32 s[16:17], -1, v52
    s_or_b64 s[6:7], s[6:7], s[14:15]
    s_waitcnt vmcnt(2)
    v_max3_u32 v53, v148, v149, v150
    v_max_u32 v53, v53, v151
    v_cmp_eq_u32 s[18:19], -1, v53
    s_or_b64 s[6:7], s[6:7], s[16:17]
    s_waitcnt vmcnt(1)
    v_max3_u32 v52, v152, v153, v154
    v_max_u32 v52, v52, v155
    v_cmp_eq_u32 s[20:21], -1, v52
    s_or_b64 s[6:7], s[6:7], s[18:19]
    s_waitcnt vmcnt(0)
    v_max3_u32 v53, v156, v157, v158
    v_max_u32 v53, v53, v159
    v_cmp_eq_u32 s[22:23], -1, v53
    s_or_b64 s[6:7], s[6:7], s[20:21]
    s_or_b64 s[6:7], s[6:7], s[22:23]
    s_cbranch_scc0 G_c3_ok
    s_mov_b32 s54, 32768
G_c3_top:
    s_mov_b64 exec, s[8:9]
    buffer_load_dwordx4 v[128:131], v13, s[44:47], s36 offen sc1
    s_mov_b64 exec, s[10:11]
    buffer_load_dwordx4 v[132:135], v13, s[44:47], s37 offen sc1
    s_mov_b64 exec, s[12:13]
    buffer_load_dwordx4 v[136:139], v13, s[44:47], s38 offen sc1
    s_mov_b64 exec, s[14:15]
    buffer_load_dwordx4 v[140:143], v13, s[44:47], s39 offen sc1
    s_mov_b64 exec, s[16:17]
    buffer_load_dwordx4 v[144:147], v13, s[44:47], s40 offen sc1
    s_mov_b64 exec, s[18:19]
    buffer_load_dwordx4 v[148:151], v13, s[44:47], s41 offen sc1
    s_mov_b64 exec, s[20:21]
    buffer_load_dwordx4 v[152:155], v13, s[44:47], s42 offen sc1
    s_mov_b64 exec, s[22:23]
    buffer_load_dwordx4 v[156:159], v13, s[44:47], s43 offen sc1
    s_mov_b64 exec, -1
    s_waitcnt vmcnt(7)
    v_max3_u32 v52, v128, v129, v130
    v_max_u32 v52, v52, v131
    v_cmp_eq_u32 s[8:9], -1, v52
    s_waitcnt vmcnt(6)
    v_max3_u32 v53, v132, v133, v134
    v_max_u32 v53, v53, v135
    v_cmp_eq_u32 s[10:11], -1, v53
    s_or_b64 s[6:7], s[8:9], s[8:9]
    s_waitcnt vmcnt(5)
    v_max3_u32 v52, v136, v137, v138
    v_max_u32 v52, v52, v139
    v_cmp_eq_u32 s[12:13], -1, v52
    s_or_b64 s[6:7], s[6:7], s[10:11]
    s_waitcnt vmcnt(4)
    v_max3_u32 v53, v140, v141, v142
    v_max_u32 v53, v53, v143
    v_cmp_eq_u32 s[14:15], -1, v53
    s_or_b64 s[6:7], s[6:7], s[12:13]
    s_waitcnt vmcnt(3)
    v_max3_u32 v52, v144, v145, v146
    v_max_u32 v52, v52, v147
    v_cmp_eq_u32 s[16:17], -1, v52
    s_or_b64 s[6:7], s[6:7], s[14:15]
    s_waitcnt vmcnt(2)
    v_max3_u32 v53, v148, v149, v150
    v_max_u32 v53, v53, v151
    v_cmp_eq_u32 s[18:19], -1, v53
    s_or_b64 s[6:7], s[6:7], s[16:17]
    s_waitcnt vmcnt(1)
    v_max3_u32 v52, v152, v153, v154
    v_max_u32 v52, v52, v155
    v_cmp_eq_u32 s[20:21], -1, v52
    s_or_b64 s[6:7], s[6:7], s[18:19]
    s_waitcnt vmcnt(0)
    v_max3_u32 v53, v156, v157, v158
    v_max_u32 v53, v53, v159
    v_cmp_eq_u32 s[22:23], -1, v53
    s_or_b64 s[6:7], s[6:7], s[20:21]
    s_or_b64 s[6:7], s[6:7], s[22:23]
    s_cbranch_scc0 G_c3_ok
    s_sleep 0
    s_sub_u32 s54, s54, 1
    s_cmp_lg_u32 s54, 0
    s_cbranch_scc1 G_c3_top
G_c3_ok:
    v_mfma_f32_32x32x16_bf16 v[64:79], v[160:163], v[128:131], v[64:79]
    v_mfma_f32_32x32x16_bf16 v[64:79], v[164:167], v[132:135], v[64:79]
    v_mfma_f32_32x32x16_bf16 v[64:79], v[168:171], v[136:139], v[64:79]
    v_mfma_f32_32x32x16_bf16 v[64:79], v[172:175], v[140:143], v[64:79]
    v_mfma_f32_32x32x16_bf16 v[64:79], v[176:179], v[144:147], v[64:79]
    v_mfma_f32_32x32x16_bf16 v[64:79], v[180:183], v[148:151], v[64:79]
    v_mfma_f32_32x32x16_bf16 v[64:79], v[184:187], v[152:155], v[64:79]
    v_mfma_f32_32x32x16_bf16 v[64:79], v[188:191], v[156:159], v[64:79]
    s_nop 11
    v_cvt_pk_bf16_f32 v16, v64, v65
    v_cvt_pk_bf16_f32 v17, v66, v67
    v_cvt_pk_bf16_f32 v18, v68, v69
    v_cvt_pk_bf16_f32 v19, v70, v71
    buffer_store_dwordx4 v[16:19], v10, s[48:51], s62 offen offset:0
    v_cvt_pk_bf16_f32 v20, v72, v73
    v_cvt_pk_bf16_f32 v21, v74, v75
    v_cvt_pk_bf16_f32 v22, v76, v77
    v_cvt_pk_bf16_f32 v23, v78, v79
    buffer_store_dwordx4 v[20:23], v10, s[48:51], s62 offen offset:16
    s_add_u32 s6, s2, s31
    s_cmp_eq_u32 s6, 0
    s_cbranch_scc0 G_end
    s_mov_b64 exec, 1
    v_mov_b32 v56, s52
    v_mov_b32 v57, s53
    s_mov_b32 s6, 3317760
    buffer_store_dwordx2 v[56:57], off, s[44:47], s6 sc1
G_end:
    s_endpgm
G_x3:
    v_add_u32 v153, 24576, v13
    v_add_u32 v154, 12288, v13
    v_add_u32 v155, 0, v13
    v_lshlrev_b32 v128, 16, v144
    v_and_b32 v129, 0xffff0000, v144
    v_lshlrev_b32 v130, 16, v145
    v_and_b32 v131, 0xffff0000, v145
    v_lshlrev_b32 v132, 16, v146
    v_and_b32 v133, 0xffff0000, v146
    v_lshlrev_b32 v134, 16, v147
    v_and_b32 v135, 0xffff0000, v147
    v_lshlrev_b32 v136, 16, v148
    v_and_b32 v137, 0xffff0000, v148
    v_lshlrev_b32 v138, 16, v149
    v_and_b32 v139, 0xffff0000, v149
    v_lshlrev_b32 v140, 16, v150
    v_and_b32 v141, 0xffff0000, v150
    v_lshlrev_b32 v142, 16, v151
    v_and_b32 v143, 0xffff0000, v151
    s_mov_b32 s54, 32768
G_r1_top:
    ds_read_b32 v52, v2 offset:28
    s_waitcnt lgkmcnt(0)
    v_readfirstlane_b32 s6, v52
    s_cmp_ge_u32 s6, 4
    s_cbranch_scc1 G_r1_ok
    s_sleep 1
    s_sub_u32 s54, s54, 1
    s_cmp_lg_u32 s54, 0
    s_cbranch_scc1 G_r1_top
G_r1_ok:
    ds_read_b128 v[80:83], v153 offset:0
    ds_read_b128 v[84:87], v153 offset:1024
    ds_read_b128 v[88:91], v153 offset:2048
    ds_read_b128 v[92:95], v153 offset:3072
    ds_read_b128 v[96:99], v154 offset:4096
    ds_read_b128 v[100:103], v154 offset:5120
    ds_read_b128 v[104:107], v154 offset:6144
    ds_read_b128 v[108:111], v154 offset:7168
    ds_read_b128 v[112:115], v155 offset:8192
    ds_read_b128 v[116:119], v155 offset:9216
    ds_read_b128 v[120:123], v155 offset:10240
    ds_read_b128 v[124:127], v155 offset:11264
    s_waitcnt lgkmcnt(4)
    v_pk_add_f32 v[64:65], v[64:65], v[80:81]
    v_pk_add_f32 v[66:67], v[66:67], v[82:83]
    v_pk_add_f32 v[68:69], v[68:69], v[84:85]
    v_pk_add_f32 v[70:71], v[70:71], v[86:87]
    v_pk_add_f32 v[72:73], v[72:73], v[88:89]
    v_pk_add_f32 v[74:75], v[74:75], v[90:91]
    v_pk_add_f32 v[76:77], v[76:77], v[92:93]
    v_pk_add_f32 v[78:79], v[78:79], v[94:95]
    v_pk_add_f32 v[64:65], v[64:65], v[96:97]
    v_pk_add_f32 v[66:67], v[66:67], v[98:99]
    v_pk_add_f32 v[68:69], v[68:69], v[100:101]
    v_pk_add_f32 v[70:71], v[70:71], v[102:103]
    v_pk_add_f32 v[72:73], v[72:73], v[104:105]
    v_pk_add_f32 v[74:75], v[74:75], v[106:107]
    v_pk_add_f32 v[76:77], v[76:77], v[108:109]
    v_pk_add_f32 v[78:79], v[78:79], v[110:111]
    s_waitcnt lgkmcnt(0)
    v_pk_add_f32 v[64:65], v[64:65], v[112:113]
    v_pk_add_f32 v[66:67], v[66:67], v[114:115]
    v_pk_add_f32 v[68:69], v[68:69], v[116:117]
    v_pk_add_f32 v[70:71], v[70:71], v[118:119]
    v_pk_add_f32 v[72:73], v[72:73], v[120:121]
    v_pk_add_f32 v[74:75], v[74:75], v[122:123]
    v_pk_add_f32 v[76:77], v[76:77], v[124:125]
    v_pk_add_f32 v[78:79], v[78:79], v[126:127]
    v_pk_fma_f32 v[64:65], v[64:65], v[12:13], v[128:129] op_sel_hi:[1,0,1]
    v_pk_fma_f32 v[66:67], v[66:67], v[12:13], v[130:131] op_sel_hi:[1,0,1]
    v_pk_fma_f32 v[68:69], v[68:69], v[12:13], v[132:133] op_sel_hi:[1,0,1]
    v_pk_fma_f32 v[70:71], v[70:71], v[12:13], v[134:135] op_sel_hi:[1,0,1]
    v_pk_fma_f32 v[72:73], v[72:73], v[12:13], v[136:137] op_sel_hi:[1,0,1]
    v_pk_fma_f32 v[74:75], v[74:75], v[12:13], v[138:139] op_sel_hi:[1,0,1]
    v_pk_fma_f32 v[76:77], v[76:77], v[12:13], v[140:141] op_sel_hi:[1,0,1]
    v_pk_fma_f32 v[78:79], v[78:79], v[12:13], v[142:143] op_sel_hi:[1,0,1]
    s_mov_b32 s54, 32768
G_c01_top:
    s_add_u32 s6, s59, 0
    buffer_load_dwordx4 v[80:83], v13, s[44:47], s6 offen offset:0 sc1
    buffer_load_dwordx4 v[16:19], v13, s[44:47], s6 offen offset:2048 sc1
    s_add_u32 s6, s6, 8192
    buffer_load_dwordx4 v[84:87], v13, s[44:47], s6 offen offset:0 sc1
    buffer_load_dwordx4 v[20:23], v13, s[44:47], s6 offen offset:2048 sc1
    s_add_u32 s6, s6, 8192
    buffer_load_dwordx4 v[88:91], v13, s[44:47], s6 offen offset:0 sc1
    buffer_load_dwordx4 v[24:27], v13, s[44:47], s6 offen offset:2048 sc1
    s_add_u32 s6, s6, 8192
    buffer_load_dwordx4 v[92:95], v13, s[44:47], s6 offen offset:0 sc1
    buffer_load_dwordx4 v[28:31], v13, s[44:47], s6 offen offset:2048 sc1
    s_add_u32 s6, s6, 8192
    buffer_load_dwordx4 v[96:99], v13, s[44:47], s6 offen offset:0 sc1
    buffer_load_dwordx4 v[32:35], v13, s[44:47], s6 offen offset:2048 sc1
    s_add_u32 s6, s6, 8192
    buffer_load_dwordx4 v[100:103], v13, s[44:47], s6 offen offset:0 sc1
    buffer_load_dwordx4 v[36:39], v13, s[44:47], s6 offen offset:2048 sc1
    s_add_u32 s6, s6, 8192
    buffer_load_dwordx4 v[104:107], v13, s[44:47], s6 offen offset:0 sc1
    buffer_load_dwordx4 v[40:43], v13, s[44:47], s6 offen offset:2048 sc1
    s_add_u32 s6, s6, 8192
    buffer_load_dwordx4 v[108:111], v13, s[44:47], s6 offen offset:0 sc1
    buffer_load_dwordx4 v[44:47], v13, s[44:47], s6 offen offset:2048 sc1
    s_waitcnt vmcnt(15)
    v_max3_u32 v52, v80, v81, v82
    v_max_u32 v52, v52, v83
    s_waitcnt vmcnt(14)
    v_max3_u32 v52, v16, v17, v52
    v_max3_u32 v52, v18, v19, v52
    s_waitcnt vmcnt(13)
    v_max3_u32 v52, v84, v85, v52
    v_max3_u32 v52, v86, v87, v52
    s_waitcnt vmcnt(12)
    v_max3_u32 v52, v20, v21, v52
    v_max3_u32 v52, v22, v23, v52
    s_waitcnt vmcnt(11)
    v_max3_u32 v52, v88, v89, v52
    v_max3_u32 v52, v90, v91, v52
    s_waitcnt vmcnt(10)
    v_max3_u32 v52, v24, v25, v52
    v_max3_u32 v52, v26, v27, v52
    s_waitcnt vmcnt(9)
    v_max3_u32 v52, v92, v93, v52
    v_max3_u32 v52, v94, v95, v52
    s_waitcnt vmcnt(8)
    v_max3_u32 v52, v28, v29, v52
    v_max3_u32 v52, v30, v31, v52
    s_waitcnt vmcnt(7)
    v_max3_u32 v52, v96, v97, v52
    v_max3_u32 v52, v98, v99, v52
    s_waitcnt vmcnt(6)
    v_max3_u32 v52, v32, v33, v52
    v_max3_u32 v52, v34, v35, v52
    s_waitcnt vmcnt(5)
    v_max3_u32 v52, v100, v101, v52
    v_max3_u32 v52, v102, v103, v52
    s_waitcnt vmcnt(4)
    v_max3_u32 v52, v36, v37, v52
    v_max3_u32 v52, v38, v39, v52
    s_waitcnt vmcnt(3)
    v_max3_u32 v52, v104, v105, v52
    v_max3_u32 v52, v106, v107, v52
    s_waitcnt vmcnt(2)
    v_max3_u32 v52, v40, v41, v52
    v_max3_u32 v52, v42, v43, v52
    s_waitcnt vmcnt(1)
    v_max3_u32 v52, v108, v109, v52
    v_max3_u32 v52, v110, v111, v52
    s_waitcnt vmcnt(0)
    v_max3_u32 v52, v44, v45, v52
    v_max3_u32 v52, v46, v47, v52
    v_cmp_eq_u32 vcc, -1, v52
    s_nop 0
    s_cbranch_vccz G_c01_ok
    s_sleep 4
    s_sub_u32 s54, s54, 1
    s_cmp_lg_u32 s54, 0
    s_cbranch_scc1 G_c01_top
G_c01_ok:
    s_setprio 0
    v_mfma_f32_32x32x16_bf16 v[64:79], v[160:163], v[80:83], v[64:79]
    v_mfma_f32_32x32x16_bf16 v[64:79], v[164:167], v[84:87], v[64:79]
    v_mfma_f32_32x32x16_bf16 v[64:79], v[168:171], v[88:91], v[64:79]
    v_mfma_f32_32x32x16_bf16 v[64:79], v[172:175], v[92:95], v[64:79]
    v_mfma_f32_32x32x16_bf16 v[64:79], v[176:179], v[96:99], v[64:79]
    v_mfma_f32_32x32x16_bf16 v[64:79], v[180:183], v[100:103], v[64:79]
    v_mfma_f32_32x32x16_bf16 v[64:79], v[184:187], v[104:107], v[64:79]
    v_mfma_f32_32x32x16_bf16 v[64:79], v[188:191], v[108:111], v[64:79]
    s_add_u32 s6, s59, 4096
    buffer_load_dwordx4 v[80:83], v13, s[44:47], s6 offen offset:0 sc1
    s_add_u32 s6, s6, 8192
    buffer_load_dwordx4 v[84:87], v13, s[44:47], s6 offen offset:0 sc1
    s_add_u32 s6, s6, 8192
    buffer_load_dwordx4 v[88:91], v13, s[44:47], s6 offen offset:0 sc1
    s_add_u32 s6, s6, 8192
    buffer_load_dwordx4 v[92:95], v13, s[44:47], s6 offen offset:0 sc1
    s_add_u32 s6, s6, 8192
    buffer_load_dwordx4 v[96:99], v13, s[44:47], s6 offen offset:0 sc1
    s_add_u32 s6, s6, 8192
    buffer_load_dwordx4 v[100:103], v13, s[44:47], s6 offen offset:0 sc1
    s_add_u32 s6, s6, 8192
    buffer_load_dwordx4 v[104:107], v13, s[44:47], s6 offen offset:0 sc1
    s_add_u32 s6, s6, 8192
    buffer_load_dwordx4 v[108:111], v13, s[44:47], s6 offen offset:0 sc1
    v_mfma_f32_32x32x16_bf16 v[64:79], v[192:195], v[16:19], v[64:79]
    v_mfma_f32_32x32x16_bf16 v[64:79], v[196:199], v[20:23], v[64:79]
    v_mfma_f32_32x32x16_bf16 v[64:79], v[200:203], v[24:27], v[64:79]
    v_mfma_f32_32x32x16_bf16 v[64:79], v[204:207], v[28:31], v[64:79]
    v_mfma_f32_32x32x16_bf16 v[64:79], v[208:211], v[32:35], v[64:79]
    v_mfma_f32_32x32x16_bf16 v[64:79], v[212:215], v[36:39], v[64:79]
    v_mfma_f32_32x32x16_bf16 v[64:79], v[216:219], v[40:43], v[64:79]
    v_mfma_f32_32x32x16_bf16 v[64:79], v[220:223], v[44:47], v[64:79]
    ds_read_b64_tr_b16 v[160:161], v14 offset:49152
    ds_read_b64_tr_b16 v[162:163], v14 offset:50176
    ds_read_b64_tr_b16 v[164:165], v14 offset:51200
    ds_read_b64_tr_b16 v[166:167], v14 offset:52224
    ds_read_b64_tr_b16 v[168:169], v14 offset:53248
    ds_read_b64_tr_b16 v[170:171], v14 offset:54272
    ds_read_b64_tr_b16 v[172:173], v14 offset:55296
    ds_read_b64_tr_b16 v[174:175], v14 offset:56320
    s_waitcnt lgkmcnt(4)
    ds_read_b64_tr_b16 v[176:177], v14 offset:57344
    ds_read_b64_tr_b16 v[178:179], v14 offset:58368
    ds_read_b64_tr_b16 v[180:181], v14 offset:59392
    ds_read_b64_tr_b16 v[182:183], v14 offset:60416
    ds_read_b64_tr_b16 v[184:185], v14 offset:61440
    ds_read_b64_tr_b16 v[186:187], v14 offset:62464
    ds_read_b64_tr_b16 v[188:189], v14 offset:63488
    ds_read_b64_tr_b16 v[190:191], v14 offset:64512
    s_waitcnt lgkmcnt(4)
    s_setprio 3
    s_waitcnt vmcnt(7)
    v_max3_u32 v52, v80, v81, v82
    v_max_u32 v52, v52, v83
    s_waitcnt vmcnt(6)
    v_max3_u32 v52, v84, v85, v52
    v_max3_u32 v52, v86, v87, v52
    s_waitcnt vmcnt(5)
    v_max3_u32 v52, v88, v89, v52
    v_max3_u32 v52, v90, v91, v52
    s_waitcnt vmcnt(4)
    v_max3_u32 v52, v92, v93, v52
    v_max3_u32 v52, v94, v95, v52
    s_waitcnt vmcnt(3)
    v_max3_u32 v52, v96, v97, v52
    v_max3_u32 v52, v98, v99, v52
    s_waitcnt vmcnt(2)
    v_max3_u32 v52, v100, v101, v52
    v_max3_u32 v52, v102, v103, v52
    s_waitcnt vmcnt(1)
    v_max3_u32 v52, v104, v105, v52
    v_max3_u32 v52, v106, v107, v52
    s_waitcnt vmcnt(0)
    v_max3_u32 v52, v108, v109, v52
    v_max3_u32 v52, v110, v111, v52
    v_cmp_eq_u32 vcc, -1, v52
    s_nop 0
    s_mov_b32 s58, 0
    s_cbranch_vccnz G_red1
    s_mov_b32 s58, 1
    v_mfma_f32_32x32x16_bf16 v[64:79], v[224:227], v[80:83], v[64:79]
    v_mfma_f32_32x32x16_bf16 v[64:79], v[228:231], v[84:87], v[64:79]
    v_mfma_f32_32x32x16_bf16 v[64:79], v[232:235], v[88:91], v[64:79]
    v_mfma_f32_32x32x16_bf16 v[64:79], v[236:239], v[92:95], v[64:79]
    v_mfma_f32_32x32x16_bf16 v[64:79], v[240:243], v[96:99], v[64:79]
    v_mfma_f32_32x32x16_bf16 v[64:79], v[244:247], v[100:103], v[64:79]
    v_mfma_f32_32x32x16_bf16 v[64:79], v[248:251], v[104:107], v[64:79]
    v_mfma_f32_32x32x16_bf16 v[64:79], v[252:255], v[108:111], v[64:79]
    s_branch G_red1
G_s0:
    s_mov_b32 s54, 32768
G_d0_top:
    s_add_u32 s6, s59, 0
    buffer_load_dwordx4 v[80:83], v13, s[44:47], s6 offen offset:0 sc1
    s_add_u32 s6, s6, 8192
    buffer_load_dwordx4 v[84:87], v13, s[44:47], s6 offen offset:0 sc1
    s_add_u32 s6, s6, 8192
    buffer_load_dwordx4 v[88:91], v13, s[44:47], s6 offen offset:0 sc1
    s_add_u32 s6, s6, 8192
    buffer_load_dwordx4 v[92:95], v13, s[44:47], s6 offen offset:0 sc1
    s_add_u32 s6, s6, 8192
    buffer_load_dwordx4 v[96:99], v13, s[44:47], s6 offen offset:0 sc1
    s_add_u32 s6, s6, 8192
    buffer_load_dwordx4 v[100:103], v13, s[44:47], s6 offen offset:0 sc1
    s_add_u32 s6, s6, 8192
    buffer_load_dwordx4 v[104:107], v13, s[44:47], s6 offen offset:0 sc1
    s_add_u32 s6, s6, 8192
    buffer_load_dwordx4 v[108:111], v13, s[44:47], s6 offen offset:0 sc1
    s_waitcnt vmcnt(7)
    v_max3_u32 v5, v80, v81, v82
    v_max_u32 v5, v5, v83
    s_waitcnt vmcnt(6)
    v_max3_u32 v5, v84, v85, v5
    v_max3_u32 v5, v86, v87, v5
    s_waitcnt vmcnt(5)
    v_max3_u32 v5, v88, v89, v5
    v_max3_u32 v5, v90, v91, v5
    s_waitcnt vmcnt(4)
    v_max3_u32 v5, v92, v93, v5
    v_max3_u32 v5, v94, v95, v5
    s_waitcnt vmcnt(3)
    v_max3_u32 v5, v96, v97, v5
    v_max3_u32 v5, v98, v99, v5
    s_waitcnt vmcnt(2)
    v_max3_u32 v5, v100, v101, v5
    v_max3_u32 v5, v102, v103, v5
    s_waitcnt vmcnt(1)
    v_max3_u32 v5, v104, v105, v5
    v_max3_u32 v5, v106, v107, v5
    s_waitcnt vmcnt(0)
    v_max3_u32 v5, v108, v109, v5
    v_max3_u32 v5, v110, v111, v5
    v_cmp_eq_u32 vcc, -1, v5
    s_nop 0
    s_cbranch_vccz G_d0_ok
    s_sleep 2
    s_sub_u32 s54, s54, 1
    s_cmp_lg_u32 s54, 0
    s_cbranch_scc1 G_d0_top
G_d0_ok:
    s_branch G_b0
G_s1:
    s_mov_b32 s54, 32768
G_d1_top:
    s_add_u32 s6, s59, 2048
    buffer_load_dwordx4 v[16:19], v13, s[44:47], s6 offen offset:0 sc1
    s_add_u32 s6, s6, 8192
    buffer_load_dwordx4 v[20:23], v13, s[44:47], s6 offen offset:0 sc1
    s_add_u32 s6, s6, 8192
    buffer_load_dwordx4 v[24:27], v13, s[44:47], s6 offen offset:0 sc1
    s_add_u32 s6, s6, 8192
    buffer_load_dwordx4 v[28:31], v13, s[44:47], s6 offen offset:0 sc1
    s_add_u32 s6, s6, 8192
    buffer_load_dwordx4 v[32:35], v13, s[44:47], s6 offen offset:0 sc1
    s_add_u32 s6, s6, 8192
    buffer_load_dwordx4 v[36:39], v13, s[44:47], s6 offen offset:0 sc1
    s_add_u32 s6, s6, 8192
    buffer_load_dwordx4 v[40:43], v13, s[44:47], s6 offen offset:0 sc1
    s_add_u32 s6, s6, 8192
    buffer_load_dwordx4 v[44:47], v13, s[44:47], s6 offen offset:0 sc1
    s_waitcnt vmcnt(7)
    v_max3_u32 v5, v16, v17, v18
    v_max_u32 v5, v5, v19
    s_waitcnt vmcnt(6)
    v_max3_u32 v5, v20, v21, v5
    v_max3_u32 v5, v22, v23, v5
    s_waitcnt vmcnt(5)
    v_max3_u32 v5, v24, v25, v5
    v_max3_u32 v5, v26, v27, v5
    s_waitcnt vmcnt(4)
    v_max3_u32 v5, v28, v29, v5
    v_max3_u32 v5, v30, v31, v5
    s_waitcnt vmcnt(3)
    v_max3_u32 v5, v32, v33, v5
    v_max3_u32 v5, v34, v35, v5
    s_waitcnt vmcnt(2)
    v_max3_u32 v5, v36, v37, v5
    v_max3_u32 v5, v38, v39, v5
    s_waitcnt vmcnt(1)
    v_max3_u32 v5, v40, v41, v5
    v_max3_u32 v5, v42, v43, v5
    s_waitcnt vmcnt(0)
    v_max3_u32 v5, v44, v45, v5
    v_max3_u32 v5, v46, v47, v5
    v_cmp_eq_u32 vcc, -1, v5
    s_nop 0
    s_cbranch_vccz G_d1_ok
    s_sleep 2
    s_sub_u32 s54, s54, 1
    s_cmp_lg_u32 s54, 0
    s_cbranch_scc1 G_d1_top
G_d1_ok:
    s_mov_b32 s54, 32768
G_d2_top:
    s_add_u32 s6, s59, 4096
    buffer_load_dwordx4 v[48:51], v13, s[44:47], s6 offen offset:0 sc1
    s_add_u32 s6, s6, 8192
    buffer_load_dwordx4 v[52:55], v13, s[44:47], s6 offen offset:0 sc1
    s_add_u32 s6, s6, 8192
    buffer_load_dwordx4 v[56:59], v13, s[44:47], s6 offen offset:0 sc1
    s_add_u32 s6, s6, 8192
    buffer_load_dwordx4 v[60:63], v13, s[44:47], s6 offen offset:0 sc1
    s_add_u32 s6, s6, 8192
    buffer_load_dwordx4 v[112:115], v13, s[44:47], s6 offen offset:0 sc1
    s_add_u32 s6, s6, 8192
    buffer_load_dwordx4 v[116:119], v13, s[44:47], s6 offen offset:0 sc1
    s_add_u32 s6, s6, 8192
    buffer_load_dwordx4 v[120:123], v13, s[44:47], s6 offen offset:0 sc1
    s_add_u32 s6, s6, 8192
    buffer_load_dwordx4 v[124:127], v13, s[44:47], s6 offen offset:0 sc1
    s_waitcnt vmcnt(7)
    v_max3_u32 v5, v48, v49, v50
    v_max_u32 v5, v5, v51
    s_waitcnt vmcnt(6)
    v_max3_u32 v5, v52, v53, v5
    v_max3_u32 v5, v54, v55, v5
    s_waitcnt vmcnt(5)
    v_max3_u32 v5, v56, v57, v5
    v_max3_u32 v5, v58, v59, v5
    s_waitcnt vmcnt(4)
    v_max3_u32 v5, v60, v61, v5
    v_max3_u32 v5, v62, v63, v5
    s_waitcnt vmcnt(3)
    v_max3_u32 v5, v112, v113, v5
    v_max3_u32 v5, v114, v115, v5
    s_waitcnt vmcnt(2)
    v_max3_u32 v5, v116, v117, v5
    v_max3_u32 v5, v118, v119, v5
    s_waitcnt vmcnt(1)
    v_max3_u32 v5, v120, v121, v5
    v_max3_u32 v5, v122, v123, v5
    s_waitcnt vmcnt(0)
    v_max3_u32 v5, v124, v125, v5
    v_max3_u32 v5, v126, v127, v5
    v_cmp_eq_u32 vcc, -1, v5
    s_nop 0
    s_cbranch_vccz G_d2_ok
    s_sleep 2
    s_sub_u32 s54, s54, 1
    s_cmp_lg_u32 s54, 0
    s_cbranch_scc1 G_d2_top
G_d2_ok:
    s_branch G_b1
G_s2:
    s_mov_b32 s54, 32768
G_c2_top:
    s_add_u32 s6, s59, 4096
    buffer_load_dwordx4 v[16:19], v13, s[44:47], s6 offen offset:0 sc1
    s_add_u32 s6, s6, 8192
    buffer_load_dwordx4 v[20:23], v13, s[44:47], s6 offen offset:0 sc1
    s_add_u32 s6, s6, 8192
    buffer_load_dwordx4 v[24:27], v13, s[44:47], s6 offen offset:0 sc1
    s_add_u32 s6, s6, 8192
    buffer_load_dwordx4 v[28:31], v13, s[44:47], s6 offen offset:0 sc1
    s_add_u32 s6, s6, 8192
    buffer_load_dwordx4 v[32:35], v13, s[44:47], s6 offen offset:0 sc1
    s_add_u32 s6, s6, 8192
    buffer_load_dwordx4 v[36:39], v13, s[44:47], s6 offen offset:0 sc1
    s_add_u32 s6, s6, 8192
    buffer_load_dwordx4 v[40:43], v13, s[44:47], s6 offen offset:0 sc1
    s_add_u32 s6, s6, 8192
    buffer_load_dwordx4 v[44:47], v13, s[44:47], s6 offen offset:0 sc1
    s_waitcnt vmcnt(7)
    v_max3_u32 v52, v16, v17, v18
    v_max_u32 v52, v52, v19
    s_waitcnt vmcnt(6)
    v_max3_u32 v52, v20, v21, v52
    v_max3_u32 v52, v22, v23, v52
    s_waitcnt vmcnt(5)
    v_max3_u32 v52, v24, v25, v52
    v_max3_u32 v52, v26, v27, v52
    s_waitcnt vmcnt(4)
    v_max3_u32 v52, v28, v29, v52
    v_max3_u32 v52, v30, v31, v52
    s_waitcnt vmcnt(3)
    v_max3_u32 v52, v32, v33, v52
    v_max3_u32 v52, v34, v35, v52
    s_waitcnt vmcnt(2)
    v_max3_u32 v52, v36, v37, v52
    v_max3_u32 v52, v38, v39, v52
    s_waitcnt vmcnt(1)
    v_max3_u32 v52, v40, v41, v52
    v_max3_u32 v52, v42, v43, v52
    s_waitcnt vmcnt(0)
    v_max3_u32 v52, v44, v45, v52
    v_max3_u32 v52, v46, v47, v52
    v_cmp_eq_u32 vcc, -1, v52
    s_nop 0
    s_cbranch_vccz G_c2_ok
    s_sleep 2
    s_sub_u32 s54, s54, 1
    s_cmp_lg_u32 s54, 0
    s_cbranch_scc1 G_c2_top
G_c2_ok:
    v_mfma_f32_32x32x16_bf16 v[64:79], v[224:227], v[16:19], v[64:79]
    v_mfma_f32_32x32x16_bf16 v[64:79], v[228:231], v[20:23], v[64:79]
    v_mfma_f32_32x32x16_bf16 v[64:79], v[232:235], v[24:27], v[64:79]
    v_mfma_f32_32x32x16_bf16 v[64:79], v[236:239], v[28:31], v[64:79]
    v_mfma_f32_32x32x16_bf16 v[64:79], v[240:243], v[32:35], v[64:79]
    v_mfma_f32_32x32x16_bf16 v[64:79], v[244:247], v[36:39], v[64:79]
    v_mfma_f32_32x32x16_bf16 v[64:79], v[248:251], v[40:43], v[64:79]
    v_mfma_f32_32x32x16_bf16 v[64:79], v[252:255], v[44:47], v[64:79]
    s_branch G_k3
G_fb:
    s_lshl_b32 s7, s64, 10
    s_add_u32 s7, s7, 148480
    v_add_u32 v124, s7, v13
    ds_read_b128 v[124:127], v124
    s_waitcnt lgkmcnt(0)
    v_mov_b32 v56, 0xdddddddd
    v_mov_b32 v96, 0xff800000
    s_mov_b32 s6, 3145728
G_fb1:
    buffer_load_dwordx4 v[112:115], v13, s[44:47], s6 offen sc1
    s_waitcnt vmcnt(0)
    v_mfma_f32_32x32x16_bf16 v[80:95], v[112:115], v[124:127], 0
    s_nop 11
    v_maximum3_f32 v96, v96, v80, v81
    v_maximum3_f32 v96, v96, v82, v83
    v_maximum3_f32 v96, v96, v84, v85
    v_maximum3_f32 v96, v96, v86, v87
    v_maximum3_f32 v96, v96, v88, v89
    v_maximum3_f32 v96, v96, v90, v91
    v_maximum3_f32 v96, v96, v92, v93
    v_maximum3_f32 v96, v96, v94, v95
    s_add_u32 s6, s6, 1024
    s_cmp_lt_u32 s6, 3211264
    s_cbranch_scc1 G_fb1
    v_mov_b32 v97, v96
    s_nop 1
    v_permlane32_swap_b32 v96, v97
    v_and_b32 v57, 31, v1
    v_cmp_eq_u32 vcc, 16, v57
    v_maximum3_f32 v96, v96, v97, v97
    v_mov_b32 v116, 0x3f803f80
    v_cndmask_b32 v116, 0, v116, vcc
    v_sub_f32 v96, 0, v96
    v_mov_b32 v117, v116
    v_mov_b32 v118, v116
    v_mov_b32 v119, v116
    v_mov_b32 v120, v116
    v_mov_b32 v121, v116
    v_mov_b32 v122, v116
    v_mov_b32 v123, v116
    v_mov_b32 v97, v96
    v_mov_b32 v98, v96
    v_mov_b32 v99, v96
    v_mov_b32 v100, v96
    v_mov_b32 v101, v96
    v_mov_b32 v102, v96
    v_mov_b32 v103, v96
    v_mov_b32 v104, v96
    v_mov_b32 v105, v96
    v_mov_b32 v106, v96
    v_mov_b32 v107, v96
    v_mov_b32 v108, v96
    v_mov_b32 v109, v96
    v_mov_b32 v110, v96
    v_mov_b32 v111, v96
    v_mov_b32 v16, 0
    v_mov_b32 v17, 0
    v_mov_b32 v18, 0
    v_mov_b32 v19, 0
    v_mov_b32 v20, 0
    v_mov_b32 v21, 0
    v_mov_b32 v22, 0
    v_mov_b32 v23, 0
    v_mov_b32 v24, 0
    v_mov_b32 v25, 0
    v_mov_b32 v26, 0
    v_mov_b32 v27, 0
    v_mov_b32 v28, 0
    v_mov_b32 v29, 0
    v_mov_b32 v30, 0
    v_mov_b32 v31, 0
    v_and_b32 v57, 15, v1
    v_lshrrev_b32 v80, 5, v1
    v_lshlrev_b32 v57, 4, v57
    v_lshl_add_u32 v57, v80, 8, v57
    s_mov_b32 s6, 3145728
G_fb2:
    s_add_u32 s7, s6, 65536
    buffer_load_dwordx4 v[112:115], v13, s[44:47], s6 offen sc1
    s_mov_b32 exec_lo, 0xffff
    s_mov_b32 exec_hi, 0xffff
    buffer_load_dwordx4 v[116:119], v57, s[44:47], s7 offen sc1
    buffer_load_dwordx4 v[120:123], v57, s[44:47], s7 offen offset:512 sc1
    s_mov_b64 exec, -1
    s_waitcnt vmcnt(0)
    v_mfma_f32_32x32x16_bf16 v[80:95], v[112:115], v[124:127], v[96:111]
    s_nop 11
    v_exp_f32 v80, v80
    v_exp_f32 v81, v81
    v_exp_f32 v82, v82
    v_exp_f32 v83, v83
    v_exp_f32 v84, v84
    v_exp_f32 v85, v85
    v_exp_f32 v86, v86
    v_exp_f32 v87, v87
    v_exp_f32 v88, v88
    v_exp_f32 v89, v89
    v_exp_f32 v90, v90
    v_exp_f32 v91, v91
    v_exp_f32 v92, v92
    v_exp_f32 v93, v93
    v_exp_f32 v94, v94
    v_exp_f32 v95, v95
    s_nop 1
    v_smfmac_f32_32x32x32_bf16 v[16:31], v[116:119], v[80:87], v56
    v_smfmac_f32_32x32x32_bf16 v[16:31], v[120:123], v[88:95], v56
    s_nop 15
    s_add_u32 s6, s6, 1024
    s_cmp_lt_u32 s6, 3211264
    s_cbranch_scc1 G_fb2
    v_mov_b32 v25, v24
    s_nop 1
    v_permlane32_swap_b32 v24, v25
    s_nop 1
    v_rcp_f32 v50, v24
    s_cmp_lt_u32 s64, 4
    s_cbranch_scc1 G_ret0
    s_branch G_ret1
G_idle:
    s_waitcnt vmcnt(0) lgkmcnt(0)
    s_mov_b64 exec, 1
    ds_add_u32 v2, v3 offset:4
    s_mov_b64 exec, -1
    s_add_u32 s52, s52, 1
    s_addc_u32 s53, s53, 0
    s_mov_b64 exec, 1
    ds_add_u32 v2, v3 offset:16
    s_mov_b64 exec, -1
    s_mov_b32 s64, 2
    s_branch G_hpub
.section .rodata,"a"
.p2align 6
.amdhsa_kernel parallel_sum__grouped_kv_mqa__dense_activation_relu__prompt_kernel
  .amdhsa_next_free_vgpr 256
  .amdhsa_next_free_sgpr 102
  .amdhsa_accum_offset 256
  .amdhsa_group_segment_fixed_size 0
  .amdhsa_kernarg_size 88
  .amdhsa_user_sgpr_count 2
  .amdhsa_user_sgpr_kernarg_segment_ptr 1
  .amdhsa_system_sgpr_workgroup_id_x 1
.end_amdhsa_kernel
```
